```python
import torch

def _softmax(x, axis=-1):
    return torch.softmax(x, dim=axis)

def _gelu(x):
    return torch.nn.functional.gelu(x, approximate='tanh')

def _silu(x):
    return torch.nn.functional.silu(x)

def _sigmoid(x):
    return torch.sigmoid(x)

def _layernorm(x, axis=-1, eps=1e-05):
    m = x.mean(dim=axis, keepdim=True)
    v = x.var(dim=axis, keepdim=True, unbiased=False)
    return (x - m) / torch.sqrt(v + eps)

def _scatter_add(tgt, idx, src, axis=0):
    return tgt.clone().index_add_(axis, idx, src)

def _segment_sum(src, seg, n):
    out = torch.zeros((n,) + src.shape[1:], dtype=src.dtype)
    return out.index_add_(0, seg, src)

def _pad(x, pw):
    flat = tuple((v for pair in reversed(pw) for v in pair))
    return torch.nn.functional.pad(x, flat)
kernel_name = 'parallel_sum__linear_attn_block__mixer_gmlp__prompt'

def setup_inputs():

    _w = lambda a: (lambda t: t.to(torch.bfloat16) if t.is_floating_point() else t)(torch.as_tensor(a))

    def _A_setup():
        B, S, D = (1, 2048, 576)
        return {'x': _w((lambda *s: torch.randn(*s, dtype=torch.bfloat16) * 0.05)(B, S, D)), 'wqkv': _w((lambda *s: torch.randn(*s, dtype=torch.bfloat16) * 1.6)(D, 3 * D)), 'wo': _w((lambda *s: torch.randn(*s, dtype=torch.bfloat16) * 0.2)(D, D))}
    _A_in = _A_setup()

    def _B_setup():
        B, S, D, F = (1, 2048, 576, 4608)
        Fh = F // 2
        return {'x': _w((lambda *s: torch.randn(*s, dtype=torch.bfloat16) * 0.05)(B, S, D)), 'w_in': _w((lambda *s: torch.randn(*s, dtype=torch.bfloat16) * 0.4)(D, 2 * Fh)), 'w_sp': _w(0.01 * (lambda *s: torch.randn(*s, dtype=torch.bfloat16) * 0.4)(S, S)), 'b_sp': _w(1.0 + 0.01 * (lambda *s: torch.randn(*s, dtype=torch.bfloat16) * 0.05)(S)), 'w_out': _w((lambda *s: torch.randn(*s, dtype=torch.bfloat16) * 0.05)(Fh, D))}
    _B_in = _B_setup()
    return {'A_x': _A_in['x'], 'A_wqkv': _A_in['wqkv'], 'A_wo': _A_in['wo'], 'B_x': _B_in['x'], 'B_w_in': _B_in['w_in'], 'B_w_sp': _B_in['w_sp'], 'B_b_sp': _B_in['b_sp'], 'B_w_out': _B_in['w_out']}

def reference(A_x, A_wqkv, A_wo, B_x, B_w_in, B_w_sp, B_b_sp, B_w_out):

    def _A_ref(x, wqkv, wo):
        B, S, D = x.shape
        H = 32
        Dh = D // H
        qkv = (lambda x, *d: x.permute(*d))((x @ wqkv).reshape(B, S, 3, H, Dh), 2, 0, 3, 1, 4)
        q, k, v = (qkv[0], qkv[1], qkv[2])
        phi = lambda t: torch.where(t > 0, t + 1, torch.exp(t)) + 1e-06
        pq, pk = (phi(q), phi(k))
        kv = torch.einsum('bhsd,bhse->bhde', pk, v)
        z = torch.einsum('bhsd->bhd', pk)
        num = torch.einsum('bhqd,bhde->bhqe', pq, kv)
        den = torch.einsum('bhqd,bhd->bhq', pq, z)[..., None] + 1e-06
        o = num / den
        return (lambda x, *d: x.permute(*d))(o, 0, 2, 1, 3).reshape(B, S, D) @ wo

    def _B_ref(x, w_in, w_sp, b_sp, w_out):
        B, S, D = x.shape
        F = w_in.shape[-1]
        Fh = F // 2
        z = _gelu(torch.einsum('bsd,df->bsf', x, w_in))
        z1 = z[..., :Fh].clone()
        z2 = _layernorm(z[..., Fh:], axis=-1)
        g = torch.einsum('ts,bsf->btf', w_sp, z2) + b_sp[None, :, None]
        return torch.einsum('bsf,fd->bsd', z1 * g, w_out)
    x = A_x
    xn = _layernorm(x, axis=-1)
    return x + _A_ref(xn, A_wqkv, A_wo) + _B_ref(xn, B_w_in, B_w_sp, B_b_sp, B_w_out)
```

```asm
; @launch kernel=k1_kernel grid=(256,1,1) block=(512,1,1) lds=161856
; @launch kernel=k2_kernel grid=(256,1,1) block=(384,1,1) lds=139264
.amdgcn_target "amdgcn-amd-amdhsa--gfx950"
.text
.globl k1_kernel
.p2align 8
.type k1_kernel,@function
k1_kernel:
    s_cmp_ge_u32 s2, 256
    s_cbranch_scc1 k1_kernel_end
    s_load_dwordx4 s[84:87], s[0:1], 0
    s_load_dwordx4 s[88:91], s[0:1], 32
    s_load_dwordx4 s[92:95], s[0:1], 72
    s_load_dwordx2 s[60:61], s[0:1], 56
    s_load_dwordx2 s[62:63], s[0:1], 16
    v_lshrrev_b32 v252, 6, v0
    v_and_b32 v255, 63, v0
    v_readfirstlane_b32 s23, v252
    v_lshlrev_b32 v251, 4, v255
    s_and_b32 s33, s2, 7
    s_lshr_b32 s34, s2, 3
    s_and_b32 s20, s33, 1
    s_lshl_b32 s20, s20, 3
    s_and_b32 s35, s34, 7
    s_add_u32 s20, s20, s35
    s_lshr_b32 s21, s33, 1
    s_lshr_b32 s22, s34, 3
    s_lshr_b32 s35, s22, 1
    s_xor_b32 s35, s35, 1
    s_xor_b32 s22, s22, s35
    s_and_b32 s24, s23, 3
    s_lshr_b32 s25, s23, 2
    s_mul_i32 s43, s24, 5120
    s_mov_b32 s46, 0xc09d30fc
    s_cmp_eq_u32 s22, 0
    s_cselect_b32 s47, 1.0, 0x3eeff558
    s_mov_b32 s48, 0x3fb8aa3b
    s_mov_b32 s49, 0x358637bd
    s_mov_b32 s42, 0x3f803f80
    s_mov_b32 s45, 0
    s_xor_b32 s98, s25, 1
    s_mov_b32 s96, 0
    v_lshrrev_b32 v252, 3, v255
    v_and_b32 v253, 7, v255
    v_xor_b32 v253, v253, v252
    v_lshlrev_b32 v253, 4, v253
    s_lshl_b32 s35, s20, 7
    v_add_u32 v252, s35, v252
    v_mul_u32_u24 v252, 1152, v252
    v_add_u32 v252, v252, v253
    s_lshl_b32 s35, s21, 2
    s_add_u32 s35, s35, s22
    s_mul_i32 s35, s35, 9
    s_add_u32 s35, s35, s23
    s_waitcnt lgkmcnt(0)
    s_mov_b32 s4, s84
    s_and_b32 s5, s85, 0xffff
    s_mov_b32 s6, 2359296
    s_mov_b32 s7, 0x00020000
    s_cmp_ge_u32 s35, 144
    s_cselect_b32 s36, 144, 0
    s_sub_u32 s35, s35, s36
    s_mul_hi_u32 s36, s35, 477218589
    s_lshl_b32 m0, s35, 10
    s_mul_i32 s37, s36, 8064
    s_lshl_b32 s36, s35, 7
    s_add_u32 s36, s36, s37
    buffer_load_dwordx4 v252, s[4:7], s36 offen lds
    s_add_u32 s35, s35, 8
    s_cmp_ge_u32 s35, 144
    s_cselect_b32 s36, 144, 0
    s_sub_u32 s35, s35, s36
    s_mul_hi_u32 s36, s35, 477218589
    s_lshl_b32 m0, s35, 10
    s_mul_i32 s37, s36, 8064
    s_lshl_b32 s36, s35, 7
    s_add_u32 s36, s36, s37
    buffer_load_dwordx4 v252, s[4:7], s36 offen lds
    s_add_u32 s35, s35, 8
    s_cmp_ge_u32 s35, 144
    s_cselect_b32 s36, 144, 0
    s_sub_u32 s35, s35, s36
    s_mul_hi_u32 s36, s35, 477218589
    s_lshl_b32 m0, s35, 10
    s_mul_i32 s37, s36, 8064
    s_lshl_b32 s36, s35, 7
    s_add_u32 s36, s36, s37
    buffer_load_dwordx4 v252, s[4:7], s36 offen lds
    s_add_u32 s35, s35, 8
    s_cmp_ge_u32 s35, 144
    s_cselect_b32 s36, 144, 0
    s_sub_u32 s35, s35, s36
    s_mul_hi_u32 s36, s35, 477218589
    s_lshl_b32 m0, s35, 10
    s_mul_i32 s37, s36, 8064
    s_lshl_b32 s36, s35, 7
    s_add_u32 s36, s36, s37
    buffer_load_dwordx4 v252, s[4:7], s36 offen lds
    s_add_u32 s35, s35, 8
    s_cmp_ge_u32 s35, 144
    s_cselect_b32 s36, 144, 0
    s_sub_u32 s35, s35, s36
    s_mul_hi_u32 s36, s35, 477218589
    s_lshl_b32 m0, s35, 10
    s_mul_i32 s37, s36, 8064
    s_lshl_b32 s36, s35, 7
    s_add_u32 s36, s36, s37
    buffer_load_dwordx4 v252, s[4:7], s36 offen lds
    s_add_u32 s35, s35, 8
    s_cmp_ge_u32 s35, 144
    s_cselect_b32 s36, 144, 0
    s_sub_u32 s35, s35, s36
    s_mul_hi_u32 s36, s35, 477218589
    s_lshl_b32 m0, s35, 10
    s_mul_i32 s37, s36, 8064
    s_lshl_b32 s36, s35, 7
    s_add_u32 s36, s36, s37
    buffer_load_dwordx4 v252, s[4:7], s36 offen lds
    s_add_u32 s35, s35, 8
    s_cmp_ge_u32 s35, 144
    s_cselect_b32 s36, 144, 0
    s_sub_u32 s35, s35, s36
    s_mul_hi_u32 s36, s35, 477218589
    s_lshl_b32 m0, s35, 10
    s_mul_i32 s37, s36, 8064
    s_lshl_b32 s36, s35, 7
    s_add_u32 s36, s36, s37
    buffer_load_dwordx4 v252, s[4:7], s36 offen lds
    s_add_u32 s35, s35, 8
    s_cmp_ge_u32 s35, 144
    s_cselect_b32 s36, 144, 0
    s_sub_u32 s35, s35, s36
    s_mul_hi_u32 s36, s35, 477218589
    s_lshl_b32 m0, s35, 10
    s_mul_i32 s37, s36, 8064
    s_lshl_b32 s36, s35, 7
    s_add_u32 s36, s36, s37
    buffer_load_dwordx4 v252, s[4:7], s36 offen lds
    s_add_u32 s35, s35, 8
    s_cmp_ge_u32 s35, 144
    s_cselect_b32 s36, 144, 0
    s_sub_u32 s35, s35, s36
    s_mul_hi_u32 s36, s35, 477218589
    s_lshl_b32 m0, s35, 10
    s_mul_i32 s37, s36, 8064
    s_lshl_b32 s36, s35, 7
    s_add_u32 s36, s36, s37
    buffer_load_dwordx4 v252, s[4:7], s36 offen lds
    s_add_u32 s35, s35, 8
    s_cmp_ge_u32 s35, 144
    s_cselect_b32 s36, 144, 0
    s_sub_u32 s35, s35, s36
    s_mul_hi_u32 s36, s35, 477218589
    s_lshl_b32 m0, s35, 10
    s_mul_i32 s37, s36, 8064
    s_lshl_b32 s36, s35, 7
    s_add_u32 s36, s36, s37
    buffer_load_dwordx4 v252, s[4:7], s36 offen lds
    s_add_u32 s35, s35, 8
    s_cmp_ge_u32 s35, 144
    s_cselect_b32 s36, 144, 0
    s_sub_u32 s35, s35, s36
    s_mul_hi_u32 s36, s35, 477218589
    s_lshl_b32 m0, s35, 10
    s_mul_i32 s37, s36, 8064
    s_lshl_b32 s36, s35, 7
    s_add_u32 s36, s36, s37
    buffer_load_dwordx4 v252, s[4:7], s36 offen lds
    s_add_u32 s35, s35, 8
    s_cmp_ge_u32 s35, 144
    s_cselect_b32 s36, 144, 0
    s_sub_u32 s35, s35, s36
    s_mul_hi_u32 s36, s35, 477218589
    s_lshl_b32 m0, s35, 10
    s_mul_i32 s37, s36, 8064
    s_lshl_b32 s36, s35, 7
    s_add_u32 s36, s36, s37
    buffer_load_dwordx4 v252, s[4:7], s36 offen lds
    s_add_u32 s35, s35, 8
    s_cmp_ge_u32 s35, 144
    s_cselect_b32 s36, 144, 0
    s_sub_u32 s35, s35, s36
    s_mul_hi_u32 s36, s35, 477218589
    s_lshl_b32 m0, s35, 10
    s_mul_i32 s37, s36, 8064
    s_lshl_b32 s36, s35, 7
    s_add_u32 s36, s36, s37
    buffer_load_dwordx4 v252, s[4:7], s36 offen lds
    s_add_u32 s35, s35, 8
    s_cmp_ge_u32 s35, 144
    s_cselect_b32 s36, 144, 0
    s_sub_u32 s35, s35, s36
    s_mul_hi_u32 s36, s35, 477218589
    s_lshl_b32 m0, s35, 10
    s_mul_i32 s37, s36, 8064
    s_lshl_b32 s36, s35, 7
    s_add_u32 s36, s36, s37
    buffer_load_dwordx4 v252, s[4:7], s36 offen lds
    s_add_u32 s35, s35, 8
    s_cmp_ge_u32 s35, 144
    s_cselect_b32 s36, 144, 0
    s_sub_u32 s35, s35, s36
    s_mul_hi_u32 s36, s35, 477218589
    s_lshl_b32 m0, s35, 10
    s_mul_i32 s37, s36, 8064
    s_lshl_b32 s36, s35, 7
    s_add_u32 s36, s36, s37
    buffer_load_dwordx4 v252, s[4:7], s36 offen lds
    s_add_u32 s35, s35, 8
    s_cmp_ge_u32 s35, 144
    s_cselect_b32 s36, 144, 0
    s_sub_u32 s35, s35, s36
    s_mul_hi_u32 s36, s35, 477218589
    s_lshl_b32 m0, s35, 10
    s_mul_i32 s37, s36, 8064
    s_lshl_b32 s36, s35, 7
    s_add_u32 s36, s36, s37
    buffer_load_dwordx4 v252, s[4:7], s36 offen lds
    s_add_u32 s35, s35, 8
    s_cmp_ge_u32 s35, 144
    s_cselect_b32 s36, 144, 0
    s_sub_u32 s35, s35, s36
    s_mul_hi_u32 s36, s35, 477218589
    s_lshl_b32 m0, s35, 10
    s_mul_i32 s37, s36, 8064
    s_lshl_b32 s36, s35, 7
    s_add_u32 s36, s36, s37
    buffer_load_dwordx4 v252, s[4:7], s36 offen lds
    s_add_u32 s35, s35, 8
    s_cmp_ge_u32 s35, 144
    s_cselect_b32 s36, 144, 0
    s_sub_u32 s35, s35, s36
    s_mul_hi_u32 s36, s35, 477218589
    s_lshl_b32 m0, s35, 10
    s_mul_i32 s37, s36, 8064
    s_lshl_b32 s36, s35, 7
    s_add_u32 s36, s36, s37
    buffer_load_dwordx4 v252, s[4:7], s36 offen lds
    s_add_u32 s35, s35, 8
    s_mov_b32 s12, s94
    s_and_b32 s13, s95, 0xffff
    s_mov_b32 s14, 41263360
    s_mov_b32 s15, 0x00020000
    s_mov_b32 s16, s92
    s_and_b32 s17, s93, 0xffff
    s_mov_b32 s18, 256
    s_mov_b32 s19, 0x00020000
    s_mov_b32 s56, s90
    s_and_b32 s57, s91, 0xffff
    s_mov_b32 s58, 8388608
    s_mov_b32 s59, 0x00020000
    s_cmp_lg_u32 s23, 7
    s_cbranch_scc1 k1_kernel_nocpf
    s_getpc_b64 s[84:85]
k1_kernel_pc:
    s_lshr_b32 s33, s2, 3
    s_mul_i32 s33, s33, 3072
    v_add_u32 v216, s33, v251
    v_mov_b32 v217, (code_end - k1_kernel_pc - 16)
    v_min_u32 v218, v216, v217
    global_load_dwordx4 v[220:223], v218, s[84:85]
    v_add_u32 v216, 1024, v216
    v_min_u32 v218, v216, v217
    global_load_dwordx4 v[220:223], v218, s[84:85]
    v_add_u32 v216, 1024, v216
    v_min_u32 v218, v216, v217
    global_load_dwordx4 v[220:223], v218, s[84:85]
    v_add_u32 v216, 1024, v216
k1_kernel_nocpf:
    s_mov_b32 s3, 0
    s_or_b32 s33, s2, s23
    s_cmp_eq_u32 s33, 0
    s_cbranch_scc1 k1_kernel_nonce
k1_kernel_nonceback:
    s_mov_b32 s36, 5312512
    s_movk_i32 s35, 9216
    s_cmp_eq_u32 s22, 0
    s_cselect_b32 s8, s86, s88
    s_cselect_b32 s9, s87, s89
    s_cselect_b32 s10, 1994752, s36
    s_cselect_b32 s37, 3456, s35
    s_and_b32 s9, s9, 0xffff
    s_sub_u32 s8, s8, 4096
    s_subb_u32 s9, s9, 0
    s_mov_b32 s11, 0x00020000
    s_lshl_b32 s26, s37, 6
    s_mul_i32 s33, s21, 288
    s_lshl_b32 s34, s21, 2
    s_cmp_eq_u32 s22, 0
    s_cbranch_scc0 k1_kernel_rz
    s_add_u32 s27, s33, 1152
    s_add_u32 s28, s33, 2304
    s_mov_b32 s29, s33
    s_mov_b32 s52, s21
    s_mov_b32 s53, s21
    s_mov_b32 s54, s21
    s_branch k1_kernel_rdone
k1_kernel_rz:
    s_cmp_eq_u32 s22, 1
    s_cbranch_scc0 k1_kernel_rc
    s_mov_b32 s52, s34
    s_add_u32 s53, s34, 1
    s_mov_b32 s54, 0
    s_mul_i32 s27, s52, 288
    s_add_u32 s27, s27, 4608
    s_add_u32 s28, s27, 288
    s_mov_b32 s29, 2130706432
    s_branch k1_kernel_rdone
k1_kernel_rc:
    s_add_u32 s52, s34, s22
    s_sub_u32 s35, s22, 2
    s_lshl_b32 s35, s35, 1
    s_add_u32 s53, s34, s35
    s_add_u32 s54, s53, 1
    s_mul_i32 s27, s52, 288
    s_add_u32 s27, s27, 4608
    s_mul_i32 s28, s53, 288
    s_add_u32 s29, s28, 288
k1_kernel_rdone:
    s_mul_i32 s33, s24, 320
    v_mov_b32 v219, 2130706432
    v_add_u32 v216, s33, v255
    v_mul_u32_u24 v217, 3277, v216
    v_lshrrev_b32 v217, 16, v217
    v_mul_u32_u24 v218, 20, v217
    v_sub_u32 v216, v216, v218
    v_bfe_u32 v218, v217, 3, 1
    v_lshlrev_b32 v218, 1, v218
    v_sub_u32 v216, v216, v218
    v_cmp_gt_u32 vcc, 18, v216
    v_mul_lo_u32 v217, v217, s37
    v_lshl_add_u32 v217, v216, 4, v217
    v_add_u32 v217, 4096, v217
    v_cndmask_b32 v244, v219, v217, vcc
    v_add_u32 v216, s33, v255
    v_add_u32 v216, 64, v216
    v_mul_u32_u24 v217, 3277, v216
    v_lshrrev_b32 v217, 16, v217
    v_mul_u32_u24 v218, 20, v217
    v_sub_u32 v216, v216, v218
    v_bfe_u32 v218, v217, 3, 1
    v_lshlrev_b32 v218, 1, v218
    v_sub_u32 v216, v216, v218
    v_cmp_gt_u32 vcc, 18, v216
    v_mul_lo_u32 v217, v217, s37
    v_lshl_add_u32 v217, v216, 4, v217
    v_add_u32 v217, 3072, v217
    v_cndmask_b32 v245, v219, v217, vcc
    v_add_u32 v216, s33, v255
    v_add_u32 v216, 128, v216
    v_mul_u32_u24 v217, 3277, v216
    v_lshrrev_b32 v217, 16, v217
    v_mul_u32_u24 v218, 20, v217
    v_sub_u32 v216, v216, v218
    v_bfe_u32 v218, v217, 3, 1
    v_lshlrev_b32 v218, 1, v218
    v_sub_u32 v216, v216, v218
    v_cmp_gt_u32 vcc, 18, v216
    v_mul_lo_u32 v217, v217, s37
    v_lshl_add_u32 v217, v216, 4, v217
    v_add_u32 v217, 2048, v217
    v_cndmask_b32 v246, v219, v217, vcc
    v_add_u32 v216, s33, v255
    v_add_u32 v216, 192, v216
    v_mul_u32_u24 v217, 3277, v216
    v_lshrrev_b32 v217, 16, v217
    v_mul_u32_u24 v218, 20, v217
    v_sub_u32 v216, v216, v218
    v_bfe_u32 v218, v217, 3, 1
    v_lshlrev_b32 v218, 1, v218
    v_sub_u32 v216, v216, v218
    v_cmp_gt_u32 vcc, 18, v216
    v_mul_lo_u32 v217, v217, s37
    v_lshl_add_u32 v217, v216, 4, v217
    v_add_u32 v217, 1024, v217
    v_cndmask_b32 v247, v219, v217, vcc
    v_add_u32 v216, s33, v255
    v_add_u32 v216, 256, v216
    v_mul_u32_u24 v217, 3277, v216
    v_lshrrev_b32 v217, 16, v217
    v_mul_u32_u24 v218, 20, v217
    v_sub_u32 v216, v216, v218
    v_bfe_u32 v218, v217, 3, 1
    v_lshlrev_b32 v218, 1, v218
    v_sub_u32 v216, v216, v218
    v_cmp_gt_u32 vcc, 18, v216
    v_mul_lo_u32 v217, v217, s37
    v_lshl_add_u32 v217, v216, 4, v217
    v_add_u32 v217, 4096, v217
    v_cndmask_b32 v248, v219, v217, vcc
    s_mul_i32 s30, s25, s26
    s_add_u32 s30, s30, s27
    s_and_b32 s33, s20, 7
    s_mul_i32 s34, s33, s26
    s_add_u32 s35, s27, s34
    s_add_u32 s83, s28, s34
    s_add_u32 s39, s29, s34
    s_mov_b32 s36, 2130706432
    s_cmp_eq_u32 s33, 0
    s_cselect_b32 s36, s27, s36
    s_cmp_eq_u32 s33, 1
    s_cselect_b32 s36, s28, s36
    s_cmp_eq_u32 s33, 2
    s_cselect_b32 s36, s29, s36
    s_lshl_b32 s34, s26, 3
    s_add_u32 s36, s36, s34
    s_cmp_eq_u32 s25, 0
    s_cselect_b32 s82, s35, s36
    v_bfe_u32 v216, v251, 4, 4
    v_lshrrev_b32 v217, 8, v251
    v_lshrrev_b32 v218, 2, v216
    v_lshl_add_u32 v218, v217, 3, v218
    v_mul_u32_u24 v218, 320, v218
    v_and_b32 v219, 1, v217
    v_lshl_add_u32 v218, v219, 5, v218
    v_and_b32 v219, 3, v216
    v_lshl_add_u32 v250, v219, 3, v218
    v_lshrrev_b32 v218, 3, v216
    v_mul_u32_u24 v218, 9216, v218
    v_and_b32 v219, 7, v216
    v_lshl_add_u32 v218, v219, 7, v218
    v_xor_b32 v219, v219, v217
    v_lshl_add_u32 v218, v219, 4, v218
    s_mul_i32 s33, s24, 36864
    v_add_u32 v218, s33, v218
    v_xor_b32 v219, 64, v218
    v_mov_b32 v253, 157696
    v_mov_b32 v254, 0
    v_mov_b32 v255, 0
    ds_write_b64 v253, v[254:255]
    s_waitcnt vmcnt(0) lgkmcnt(0)
    s_barrier
    s_cmp_eq_u32 s25, 1
    s_cbranch_scc1 k1_kernel_g1
    ds_read_b128 v[0:3], v218 offset:0
    ds_read_b128 v[8:11], v219 offset:0
    ds_read_b128 v[16:19], v218 offset:1024
    ds_read_b128 v[24:27], v219 offset:1024
    ds_read_b128 v[32:35], v218 offset:2048
    ds_read_b128 v[40:43], v219 offset:2048
    ds_read_b128 v[48:51], v218 offset:3072
    ds_read_b128 v[56:59], v219 offset:3072
    ds_read_b128 v[64:67], v218 offset:4096
    ds_read_b128 v[72:75], v219 offset:4096
    ds_read_b128 v[80:83], v218 offset:5120
    ds_read_b128 v[88:91], v219 offset:5120
    s_waitcnt lgkmcnt(6)
    ds_read_b128 v[96:99], v218 offset:6144
    ds_read_b128 v[104:107], v219 offset:6144
    ds_read_b128 v[112:115], v218 offset:7168
    ds_read_b128 v[120:123], v219 offset:7168
    ds_read_b128 v[128:131], v218 offset:8192
    ds_read_b128 v[136:139], v219 offset:8192
    s_mov_b32 m0, 157760
    v_mov_b32 v253, 0
    v_mov_b32 v168, 0
    v_mov_b32 v169, 0
    v_mov_b32 v170, 0
    v_mov_b32 v171, 0
    buffer_load_dwordx4 v[144:147], v244, s[8:11], s30 offen offset:0
    s_waitcnt lgkmcnt(12)
    v_dot2c_f32_bf16 v168, s42, v0
    v_dot2c_f32_bf16 v169, v0, v0
    v_dot2c_f32_bf16 v170, s42, v1
    v_dot2c_f32_bf16 v171, v1, v1
    v_dot2c_f32_bf16 v168, s42, v2
    v_dot2c_f32_bf16 v169, v2, v2
    v_dot2c_f32_bf16 v170, s42, v3
    v_dot2c_f32_bf16 v171, v3, v3
    buffer_load_dwordx4 v[148:151], v245, s[8:11], s30 offen offset:1024
    v_dot2c_f32_bf16 v168, s42, v8
    v_dot2c_f32_bf16 v169, v8, v8
    v_dot2c_f32_bf16 v170, s42, v9
    v_dot2c_f32_bf16 v171, v9, v9
    v_dot2c_f32_bf16 v168, s42, v10
    v_dot2c_f32_bf16 v169, v10, v10
    v_dot2c_f32_bf16 v170, s42, v11
    v_dot2c_f32_bf16 v171, v11, v11
    buffer_load_dwordx4 v[152:155], v246, s[8:11], s30 offen offset:2048
    v_dot2c_f32_bf16 v168, s42, v16
    v_dot2c_f32_bf16 v169, v16, v16
    v_dot2c_f32_bf16 v170, s42, v17
    v_dot2c_f32_bf16 v171, v17, v17
    v_dot2c_f32_bf16 v168, s42, v18
    v_dot2c_f32_bf16 v169, v18, v18
    v_dot2c_f32_bf16 v170, s42, v19
    v_dot2c_f32_bf16 v171, v19, v19
    buffer_load_dwordx4 v[156:159], v247, s[8:11], s30 offen offset:3072
    v_dot2c_f32_bf16 v168, s42, v24
    v_dot2c_f32_bf16 v169, v24, v24
    v_dot2c_f32_bf16 v170, s42, v25
    v_dot2c_f32_bf16 v171, v25, v25
    v_dot2c_f32_bf16 v168, s42, v26
    v_dot2c_f32_bf16 v169, v26, v26
    v_dot2c_f32_bf16 v170, s42, v27
    v_dot2c_f32_bf16 v171, v27, v27
    buffer_load_dwordx4 v[160:163], v248, s[8:11], s30 offen offset:0
    v_dot2c_f32_bf16 v168, s42, v32
    v_dot2c_f32_bf16 v169, v32, v32
    v_dot2c_f32_bf16 v170, s42, v33
    v_dot2c_f32_bf16 v171, v33, v33
    v_dot2c_f32_bf16 v168, s42, v34
    v_dot2c_f32_bf16 v169, v34, v34
    v_dot2c_f32_bf16 v170, s42, v35
    v_dot2c_f32_bf16 v171, v35, v35
    buffer_load_dwordx4 v244, s[8:11], s82 offen offset:0 lds
    v_dot2c_f32_bf16 v168, s42, v40
    v_dot2c_f32_bf16 v169, v40, v40
    v_dot2c_f32_bf16 v170, s42, v41
    v_dot2c_f32_bf16 v171, v41, v41
    v_dot2c_f32_bf16 v168, s42, v42
    v_dot2c_f32_bf16 v169, v42, v42
    v_dot2c_f32_bf16 v170, s42, v43
    v_dot2c_f32_bf16 v171, v43, v43
    s_waitcnt lgkmcnt(6)
    v_dot2c_f32_bf16 v168, s42, v48
    v_dot2c_f32_bf16 v169, v48, v48
    v_dot2c_f32_bf16 v170, s42, v49
    v_dot2c_f32_bf16 v171, v49, v49
    v_dot2c_f32_bf16 v168, s42, v50
    v_dot2c_f32_bf16 v169, v50, v50
    v_dot2c_f32_bf16 v170, s42, v51
    v_dot2c_f32_bf16 v171, v51, v51
    v_dot2c_f32_bf16 v168, s42, v56
    v_dot2c_f32_bf16 v169, v56, v56
    v_dot2c_f32_bf16 v170, s42, v57
    v_dot2c_f32_bf16 v171, v57, v57
    v_dot2c_f32_bf16 v168, s42, v58
    v_dot2c_f32_bf16 v169, v58, v58
    v_dot2c_f32_bf16 v170, s42, v59
    v_dot2c_f32_bf16 v171, v59, v59
    v_dot2c_f32_bf16 v168, s42, v64
    v_dot2c_f32_bf16 v169, v64, v64
    v_dot2c_f32_bf16 v170, s42, v65
    v_dot2c_f32_bf16 v171, v65, v65
    v_dot2c_f32_bf16 v168, s42, v66
    v_dot2c_f32_bf16 v169, v66, v66
    v_dot2c_f32_bf16 v170, s42, v67
    v_dot2c_f32_bf16 v171, v67, v67
    buffer_load_dwordx4 v245, s[8:11], s82 offen offset:1024 lds
    v_dot2c_f32_bf16 v168, s42, v72
    v_dot2c_f32_bf16 v169, v72, v72
    v_dot2c_f32_bf16 v170, s42, v73
    v_dot2c_f32_bf16 v171, v73, v73
    v_dot2c_f32_bf16 v168, s42, v74
    v_dot2c_f32_bf16 v169, v74, v74
    v_dot2c_f32_bf16 v170, s42, v75
    v_dot2c_f32_bf16 v171, v75, v75
    v_dot2c_f32_bf16 v168, s42, v80
    v_dot2c_f32_bf16 v169, v80, v80
    v_dot2c_f32_bf16 v170, s42, v81
    v_dot2c_f32_bf16 v171, v81, v81
    v_dot2c_f32_bf16 v168, s42, v82
    v_dot2c_f32_bf16 v169, v82, v82
    v_dot2c_f32_bf16 v170, s42, v83
    v_dot2c_f32_bf16 v171, v83, v83
    v_dot2c_f32_bf16 v168, s42, v88
    v_dot2c_f32_bf16 v169, v88, v88
    v_dot2c_f32_bf16 v170, s42, v89
    v_dot2c_f32_bf16 v171, v89, v89
    v_dot2c_f32_bf16 v168, s42, v90
    v_dot2c_f32_bf16 v169, v90, v90
    v_dot2c_f32_bf16 v170, s42, v91
    v_dot2c_f32_bf16 v171, v91, v91
    s_waitcnt lgkmcnt(0)
    v_dot2c_f32_bf16 v168, s42, v96
    v_dot2c_f32_bf16 v169, v96, v96
    v_dot2c_f32_bf16 v170, s42, v97
    v_dot2c_f32_bf16 v171, v97, v97
    v_dot2c_f32_bf16 v168, s42, v98
    v_dot2c_f32_bf16 v169, v98, v98
    v_dot2c_f32_bf16 v170, s42, v99
    v_dot2c_f32_bf16 v171, v99, v99
    buffer_load_dwordx4 v246, s[8:11], s82 offen offset:2048 lds
    v_dot2c_f32_bf16 v168, s42, v104
    v_dot2c_f32_bf16 v169, v104, v104
    v_dot2c_f32_bf16 v170, s42, v105
    v_dot2c_f32_bf16 v171, v105, v105
    v_dot2c_f32_bf16 v168, s42, v106
    v_dot2c_f32_bf16 v169, v106, v106
    v_dot2c_f32_bf16 v170, s42, v107
    v_dot2c_f32_bf16 v171, v107, v107
    v_dot2c_f32_bf16 v168, s42, v112
    v_dot2c_f32_bf16 v169, v112, v112
    v_dot2c_f32_bf16 v170, s42, v113
    v_dot2c_f32_bf16 v171, v113, v113
    v_dot2c_f32_bf16 v168, s42, v114
    v_dot2c_f32_bf16 v169, v114, v114
    v_dot2c_f32_bf16 v170, s42, v115
    v_dot2c_f32_bf16 v171, v115, v115
    v_dot2c_f32_bf16 v168, s42, v120
    v_dot2c_f32_bf16 v169, v120, v120
    v_dot2c_f32_bf16 v170, s42, v121
    v_dot2c_f32_bf16 v171, v121, v121
    v_dot2c_f32_bf16 v168, s42, v122
    v_dot2c_f32_bf16 v169, v122, v122
    v_dot2c_f32_bf16 v170, s42, v123
    v_dot2c_f32_bf16 v171, v123, v123
    v_dot2c_f32_bf16 v168, s42, v128
    v_dot2c_f32_bf16 v169, v128, v128
    v_dot2c_f32_bf16 v170, s42, v129
    v_dot2c_f32_bf16 v171, v129, v129
    v_dot2c_f32_bf16 v168, s42, v130
    v_dot2c_f32_bf16 v169, v130, v130
    v_dot2c_f32_bf16 v170, s42, v131
    v_dot2c_f32_bf16 v171, v131, v131
    buffer_load_dwordx4 v247, s[8:11], s82 offen offset:3072 lds
    v_dot2c_f32_bf16 v168, s42, v136
    v_dot2c_f32_bf16 v169, v136, v136
    v_dot2c_f32_bf16 v170, s42, v137
    v_dot2c_f32_bf16 v171, v137, v137
    v_dot2c_f32_bf16 v168, s42, v138
    v_dot2c_f32_bf16 v169, v138, v138
    v_dot2c_f32_bf16 v170, s42, v139
    v_dot2c_f32_bf16 v171, v139, v139
    s_nop 3
    v_add_f32 v168, v168, v170
    v_add_f32 v169, v169, v171
    v_mov_b32 v170, v168
    v_mov_b32 v171, v169
    s_nop 1
    v_permlane32_swap_b32 v168, v170
    v_permlane32_swap_b32 v169, v171
    s_nop 1
    v_add_f32 v168, v168, v170
    v_add_f32 v169, v169, v171
    v_mov_b32 v170, v168
    v_mov_b32 v171, v169
    s_nop 1
    v_permlane16_swap_b32 v168, v170
    v_permlane16_swap_b32 v169, v171
    s_nop 1
    v_add_f32 v168, v168, v170
    v_add_f32 v169, v169, v171
    v_mul_f32 v168, 0x3ae38e39, v168
    v_mul_f32 v169, 0x3ae38e39, v169
    v_fma_f32 v169, -v168, v168, v169
    v_max_f32 v169, 0, v169
    v_add_f32 v169, 0x3727c5ac, v169
    v_rsq_f32 v176, v169
    s_nop 0
    v_mul_f32 v176, s47, v176
    v_mul_f32 v177, v168, v176
    v_sub_f32 v177, 0, v177
    v_lshlrev_b32 v224, 16, v0
    v_and_b32 v225, 0xffff0000, v0
    v_lshlrev_b32 v226, 16, v1
    v_and_b32 v227, 0xffff0000, v1
    v_lshlrev_b32 v228, 16, v2
    v_and_b32 v229, 0xffff0000, v2
    v_lshlrev_b32 v230, 16, v3
    v_and_b32 v231, 0xffff0000, v3
    v_pk_fma_f32 v[224:225], v[224:225], v[176:177], v[176:177] op_sel:[0,0,1] op_sel_hi:[1,0,1]
    v_pk_fma_f32 v[226:227], v[226:227], v[176:177], v[176:177] op_sel:[0,0,1] op_sel_hi:[1,0,1]
    v_pk_fma_f32 v[228:229], v[228:229], v[176:177], v[176:177] op_sel:[0,0,1] op_sel_hi:[1,0,1]
    v_pk_fma_f32 v[230:231], v[230:231], v[176:177], v[176:177] op_sel:[0,0,1] op_sel_hi:[1,0,1]
    v_cvt_pk_bf16_f32 v0, v224, v225
    v_cvt_pk_bf16_f32 v1, v226, v227
    v_cvt_pk_bf16_f32 v2, v228, v229
    v_cvt_pk_bf16_f32 v3, v230, v231
    ds_write_b128 v218, v[0:3] offset:0
    buffer_load_dwordx4 v248, s[8:11], s82 offen offset:0 lds
    v_lshlrev_b32 v224, 16, v8
    v_and_b32 v225, 0xffff0000, v8
    v_lshlrev_b32 v226, 16, v9
    v_and_b32 v227, 0xffff0000, v9
    v_lshlrev_b32 v228, 16, v10
    v_and_b32 v229, 0xffff0000, v10
    v_lshlrev_b32 v230, 16, v11
    v_and_b32 v231, 0xffff0000, v11
    v_pk_fma_f32 v[224:225], v[224:225], v[176:177], v[176:177] op_sel:[0,0,1] op_sel_hi:[1,0,1]
    v_pk_fma_f32 v[226:227], v[226:227], v[176:177], v[176:177] op_sel:[0,0,1] op_sel_hi:[1,0,1]
    v_pk_fma_f32 v[228:229], v[228:229], v[176:177], v[176:177] op_sel:[0,0,1] op_sel_hi:[1,0,1]
    v_pk_fma_f32 v[230:231], v[230:231], v[176:177], v[176:177] op_sel:[0,0,1] op_sel_hi:[1,0,1]
    v_cvt_pk_bf16_f32 v8, v224, v225
    v_cvt_pk_bf16_f32 v9, v226, v227
    v_cvt_pk_bf16_f32 v10, v228, v229
    v_cvt_pk_bf16_f32 v11, v230, v231
    ds_write_b128 v219, v[8:11] offset:0
    v_lshlrev_b32 v224, 16, v16
    v_and_b32 v225, 0xffff0000, v16
    v_lshlrev_b32 v226, 16, v17
    v_and_b32 v227, 0xffff0000, v17
    v_lshlrev_b32 v228, 16, v18
    v_and_b32 v229, 0xffff0000, v18
    v_lshlrev_b32 v230, 16, v19
    v_and_b32 v231, 0xffff0000, v19
    v_pk_fma_f32 v[224:225], v[224:225], v[176:177], v[176:177] op_sel:[0,0,1] op_sel_hi:[1,0,1]
    v_pk_fma_f32 v[226:227], v[226:227], v[176:177], v[176:177] op_sel:[0,0,1] op_sel_hi:[1,0,1]
    v_pk_fma_f32 v[228:229], v[228:229], v[176:177], v[176:177] op_sel:[0,0,1] op_sel_hi:[1,0,1]
    v_pk_fma_f32 v[230:231], v[230:231], v[176:177], v[176:177] op_sel:[0,0,1] op_sel_hi:[1,0,1]
    v_cvt_pk_bf16_f32 v16, v224, v225
    v_cvt_pk_bf16_f32 v17, v226, v227
    v_cvt_pk_bf16_f32 v18, v228, v229
    v_cvt_pk_bf16_f32 v19, v230, v231
    ds_write_b128 v218, v[16:19] offset:1024
    buffer_load_dwordx4 v244, s[8:11], s39 offen offset:0 lds
    v_lshlrev_b32 v224, 16, v24
    v_and_b32 v225, 0xffff0000, v24
    v_lshlrev_b32 v226, 16, v25
    v_and_b32 v227, 0xffff0000, v25
    v_lshlrev_b32 v228, 16, v26
    v_and_b32 v229, 0xffff0000, v26
    v_lshlrev_b32 v230, 16, v27
    v_and_b32 v231, 0xffff0000, v27
    v_pk_fma_f32 v[224:225], v[224:225], v[176:177], v[176:177] op_sel:[0,0,1] op_sel_hi:[1,0,1]
    v_pk_fma_f32 v[226:227], v[226:227], v[176:177], v[176:177] op_sel:[0,0,1] op_sel_hi:[1,0,1]
    v_pk_fma_f32 v[228:229], v[228:229], v[176:177], v[176:177] op_sel:[0,0,1] op_sel_hi:[1,0,1]
    v_pk_fma_f32 v[230:231], v[230:231], v[176:177], v[176:177] op_sel:[0,0,1] op_sel_hi:[1,0,1]
    v_cvt_pk_bf16_f32 v24, v224, v225
    v_cvt_pk_bf16_f32 v25, v226, v227
    v_cvt_pk_bf16_f32 v26, v228, v229
    v_cvt_pk_bf16_f32 v27, v230, v231
    ds_write_b128 v219, v[24:27] offset:1024
    v_lshlrev_b32 v224, 16, v32
    v_and_b32 v225, 0xffff0000, v32
    v_lshlrev_b32 v226, 16, v33
    v_and_b32 v227, 0xffff0000, v33
    v_lshlrev_b32 v228, 16, v34
    v_and_b32 v229, 0xffff0000, v34
    v_lshlrev_b32 v230, 16, v35
    v_and_b32 v231, 0xffff0000, v35
    v_pk_fma_f32 v[224:225], v[224:225], v[176:177], v[176:177] op_sel:[0,0,1] op_sel_hi:[1,0,1]
    v_pk_fma_f32 v[226:227], v[226:227], v[176:177], v[176:177] op_sel:[0,0,1] op_sel_hi:[1,0,1]
    v_pk_fma_f32 v[228:229], v[228:229], v[176:177], v[176:177] op_sel:[0,0,1] op_sel_hi:[1,0,1]
    v_pk_fma_f32 v[230:231], v[230:231], v[176:177], v[176:177] op_sel:[0,0,1] op_sel_hi:[1,0,1]
    v_cvt_pk_bf16_f32 v32, v224, v225
    v_cvt_pk_bf16_f32 v33, v226, v227
    v_cvt_pk_bf16_f32 v34, v228, v229
    v_cvt_pk_bf16_f32 v35, v230, v231
    ds_write_b128 v218, v[32:35] offset:2048
    buffer_load_dwordx4 v245, s[8:11], s39 offen offset:1024 lds
    v_lshlrev_b32 v224, 16, v40
    v_and_b32 v225, 0xffff0000, v40
    v_lshlrev_b32 v226, 16, v41
    v_and_b32 v227, 0xffff0000, v41
    v_lshlrev_b32 v228, 16, v42
    v_and_b32 v229, 0xffff0000, v42
    v_lshlrev_b32 v230, 16, v43
    v_and_b32 v231, 0xffff0000, v43
    v_pk_fma_f32 v[224:225], v[224:225], v[176:177], v[176:177] op_sel:[0,0,1] op_sel_hi:[1,0,1]
    v_pk_fma_f32 v[226:227], v[226:227], v[176:177], v[176:177] op_sel:[0,0,1] op_sel_hi:[1,0,1]
    v_pk_fma_f32 v[228:229], v[228:229], v[176:177], v[176:177] op_sel:[0,0,1] op_sel_hi:[1,0,1]
    v_pk_fma_f32 v[230:231], v[230:231], v[176:177], v[176:177] op_sel:[0,0,1] op_sel_hi:[1,0,1]
    v_cvt_pk_bf16_f32 v40, v224, v225
    v_cvt_pk_bf16_f32 v41, v226, v227
    v_cvt_pk_bf16_f32 v42, v228, v229
    v_cvt_pk_bf16_f32 v43, v230, v231
    ds_write_b128 v219, v[40:43] offset:2048
    v_lshlrev_b32 v224, 16, v48
    v_and_b32 v225, 0xffff0000, v48
    v_lshlrev_b32 v226, 16, v49
    v_and_b32 v227, 0xffff0000, v49
    v_lshlrev_b32 v228, 16, v50
    v_and_b32 v229, 0xffff0000, v50
    v_lshlrev_b32 v230, 16, v51
    v_and_b32 v231, 0xffff0000, v51
    v_pk_fma_f32 v[224:225], v[224:225], v[176:177], v[176:177] op_sel:[0,0,1] op_sel_hi:[1,0,1]
    v_pk_fma_f32 v[226:227], v[226:227], v[176:177], v[176:177] op_sel:[0,0,1] op_sel_hi:[1,0,1]
    v_pk_fma_f32 v[228:229], v[228:229], v[176:177], v[176:177] op_sel:[0,0,1] op_sel_hi:[1,0,1]
    v_pk_fma_f32 v[230:231], v[230:231], v[176:177], v[176:177] op_sel:[0,0,1] op_sel_hi:[1,0,1]
    v_cvt_pk_bf16_f32 v48, v224, v225
    v_cvt_pk_bf16_f32 v49, v226, v227
    v_cvt_pk_bf16_f32 v50, v228, v229
    v_cvt_pk_bf16_f32 v51, v230, v231
    ds_write_b128 v218, v[48:51] offset:3072
    buffer_load_dwordx4 v246, s[8:11], s39 offen offset:2048 lds
    v_lshlrev_b32 v224, 16, v56
    v_and_b32 v225, 0xffff0000, v56
    v_lshlrev_b32 v226, 16, v57
    v_and_b32 v227, 0xffff0000, v57
    v_lshlrev_b32 v228, 16, v58
    v_and_b32 v229, 0xffff0000, v58
    v_lshlrev_b32 v230, 16, v59
    v_and_b32 v231, 0xffff0000, v59
    v_pk_fma_f32 v[224:225], v[224:225], v[176:177], v[176:177] op_sel:[0,0,1] op_sel_hi:[1,0,1]
    v_pk_fma_f32 v[226:227], v[226:227], v[176:177], v[176:177] op_sel:[0,0,1] op_sel_hi:[1,0,1]
    v_pk_fma_f32 v[228:229], v[228:229], v[176:177], v[176:177] op_sel:[0,0,1] op_sel_hi:[1,0,1]
    v_pk_fma_f32 v[230:231], v[230:231], v[176:177], v[176:177] op_sel:[0,0,1] op_sel_hi:[1,0,1]
    v_cvt_pk_bf16_f32 v56, v224, v225
    v_cvt_pk_bf16_f32 v57, v226, v227
    v_cvt_pk_bf16_f32 v58, v228, v229
    v_cvt_pk_bf16_f32 v59, v230, v231
    ds_write_b128 v219, v[56:59] offset:3072
    v_lshlrev_b32 v224, 16, v64
    v_and_b32 v225, 0xffff0000, v64
    v_lshlrev_b32 v226, 16, v65
    v_and_b32 v227, 0xffff0000, v65
    v_lshlrev_b32 v228, 16, v66
    v_and_b32 v229, 0xffff0000, v66
    v_lshlrev_b32 v230, 16, v67
    v_and_b32 v231, 0xffff0000, v67
    v_pk_fma_f32 v[224:225], v[224:225], v[176:177], v[176:177] op_sel:[0,0,1] op_sel_hi:[1,0,1]
    v_pk_fma_f32 v[226:227], v[226:227], v[176:177], v[176:177] op_sel:[0,0,1] op_sel_hi:[1,0,1]
    v_pk_fma_f32 v[228:229], v[228:229], v[176:177], v[176:177] op_sel:[0,0,1] op_sel_hi:[1,0,1]
    v_pk_fma_f32 v[230:231], v[230:231], v[176:177], v[176:177] op_sel:[0,0,1] op_sel_hi:[1,0,1]
    v_cvt_pk_bf16_f32 v64, v224, v225
    v_cvt_pk_bf16_f32 v65, v226, v227
    v_cvt_pk_bf16_f32 v66, v228, v229
    v_cvt_pk_bf16_f32 v67, v230, v231
    ds_write_b128 v218, v[64:67] offset:4096
    buffer_load_dwordx4 v247, s[8:11], s39 offen offset:3072 lds
    v_lshlrev_b32 v224, 16, v72
    v_and_b32 v225, 0xffff0000, v72
    v_lshlrev_b32 v226, 16, v73
    v_and_b32 v227, 0xffff0000, v73
    v_lshlrev_b32 v228, 16, v74
    v_and_b32 v229, 0xffff0000, v74
    v_lshlrev_b32 v230, 16, v75
    v_and_b32 v231, 0xffff0000, v75
    v_pk_fma_f32 v[224:225], v[224:225], v[176:177], v[176:177] op_sel:[0,0,1] op_sel_hi:[1,0,1]
    v_pk_fma_f32 v[226:227], v[226:227], v[176:177], v[176:177] op_sel:[0,0,1] op_sel_hi:[1,0,1]
    v_pk_fma_f32 v[228:229], v[228:229], v[176:177], v[176:177] op_sel:[0,0,1] op_sel_hi:[1,0,1]
    v_pk_fma_f32 v[230:231], v[230:231], v[176:177], v[176:177] op_sel:[0,0,1] op_sel_hi:[1,0,1]
    v_cvt_pk_bf16_f32 v72, v224, v225
    v_cvt_pk_bf16_f32 v73, v226, v227
    v_cvt_pk_bf16_f32 v74, v228, v229
    v_cvt_pk_bf16_f32 v75, v230, v231
    ds_write_b128 v219, v[72:75] offset:4096
    v_lshlrev_b32 v224, 16, v80
    v_and_b32 v225, 0xffff0000, v80
    v_lshlrev_b32 v226, 16, v81
    v_and_b32 v227, 0xffff0000, v81
    v_lshlrev_b32 v228, 16, v82
    v_and_b32 v229, 0xffff0000, v82
    v_lshlrev_b32 v230, 16, v83
    v_and_b32 v231, 0xffff0000, v83
    v_pk_fma_f32 v[224:225], v[224:225], v[176:177], v[176:177] op_sel:[0,0,1] op_sel_hi:[1,0,1]
    v_pk_fma_f32 v[226:227], v[226:227], v[176:177], v[176:177] op_sel:[0,0,1] op_sel_hi:[1,0,1]
    v_pk_fma_f32 v[228:229], v[228:229], v[176:177], v[176:177] op_sel:[0,0,1] op_sel_hi:[1,0,1]
    v_pk_fma_f32 v[230:231], v[230:231], v[176:177], v[176:177] op_sel:[0,0,1] op_sel_hi:[1,0,1]
    v_cvt_pk_bf16_f32 v80, v224, v225
    v_cvt_pk_bf16_f32 v81, v226, v227
    v_cvt_pk_bf16_f32 v82, v228, v229
    v_cvt_pk_bf16_f32 v83, v230, v231
    ds_write_b128 v218, v[80:83] offset:5120
    buffer_load_dwordx4 v248, s[8:11], s39 offen offset:0 lds
    v_lshlrev_b32 v224, 16, v88
    v_and_b32 v225, 0xffff0000, v88
    v_lshlrev_b32 v226, 16, v89
    v_and_b32 v227, 0xffff0000, v89
    v_lshlrev_b32 v228, 16, v90
    v_and_b32 v229, 0xffff0000, v90
    v_lshlrev_b32 v230, 16, v91
    v_and_b32 v231, 0xffff0000, v91
    v_pk_fma_f32 v[224:225], v[224:225], v[176:177], v[176:177] op_sel:[0,0,1] op_sel_hi:[1,0,1]
    v_pk_fma_f32 v[226:227], v[226:227], v[176:177], v[176:177] op_sel:[0,0,1] op_sel_hi:[1,0,1]
    v_pk_fma_f32 v[228:229], v[228:229], v[176:177], v[176:177] op_sel:[0,0,1] op_sel_hi:[1,0,1]
    v_pk_fma_f32 v[230:231], v[230:231], v[176:177], v[176:177] op_sel:[0,0,1] op_sel_hi:[1,0,1]
    v_cvt_pk_bf16_f32 v88, v224, v225
    v_cvt_pk_bf16_f32 v89, v226, v227
    v_cvt_pk_bf16_f32 v90, v228, v229
    v_cvt_pk_bf16_f32 v91, v230, v231
    ds_write_b128 v219, v[88:91] offset:5120
    v_lshlrev_b32 v224, 16, v96
    v_and_b32 v225, 0xffff0000, v96
    v_lshlrev_b32 v226, 16, v97
    v_and_b32 v227, 0xffff0000, v97
    v_lshlrev_b32 v228, 16, v98
    v_and_b32 v229, 0xffff0000, v98
    v_lshlrev_b32 v230, 16, v99
    v_and_b32 v231, 0xffff0000, v99
    v_pk_fma_f32 v[224:225], v[224:225], v[176:177], v[176:177] op_sel:[0,0,1] op_sel_hi:[1,0,1]
    v_pk_fma_f32 v[226:227], v[226:227], v[176:177], v[176:177] op_sel:[0,0,1] op_sel_hi:[1,0,1]
    v_pk_fma_f32 v[228:229], v[228:229], v[176:177], v[176:177] op_sel:[0,0,1] op_sel_hi:[1,0,1]
    v_pk_fma_f32 v[230:231], v[230:231], v[176:177], v[176:177] op_sel:[0,0,1] op_sel_hi:[1,0,1]
    v_cvt_pk_bf16_f32 v96, v224, v225
    v_cvt_pk_bf16_f32 v97, v226, v227
    v_cvt_pk_bf16_f32 v98, v228, v229
    v_cvt_pk_bf16_f32 v99, v230, v231
    ds_write_b128 v218, v[96:99] offset:6144
    buffer_load_dword v252, v253, s[16:19], s3 offen sc1
    v_lshlrev_b32 v224, 16, v104
    v_and_b32 v225, 0xffff0000, v104
    v_lshlrev_b32 v226, 16, v105
    v_and_b32 v227, 0xffff0000, v105
    v_lshlrev_b32 v228, 16, v106
    v_and_b32 v229, 0xffff0000, v106
    v_lshlrev_b32 v230, 16, v107
    v_and_b32 v231, 0xffff0000, v107
    v_pk_fma_f32 v[224:225], v[224:225], v[176:177], v[176:177] op_sel:[0,0,1] op_sel_hi:[1,0,1]
    v_pk_fma_f32 v[226:227], v[226:227], v[176:177], v[176:177] op_sel:[0,0,1] op_sel_hi:[1,0,1]
    v_pk_fma_f32 v[228:229], v[228:229], v[176:177], v[176:177] op_sel:[0,0,1] op_sel_hi:[1,0,1]
    v_pk_fma_f32 v[230:231], v[230:231], v[176:177], v[176:177] op_sel:[0,0,1] op_sel_hi:[1,0,1]
    v_cvt_pk_bf16_f32 v104, v224, v225
    v_cvt_pk_bf16_f32 v105, v226, v227
    v_cvt_pk_bf16_f32 v106, v228, v229
    v_cvt_pk_bf16_f32 v107, v230, v231
    ds_write_b128 v219, v[104:107] offset:6144
    v_lshlrev_b32 v224, 16, v112
    v_and_b32 v225, 0xffff0000, v112
    v_lshlrev_b32 v226, 16, v113
    v_and_b32 v227, 0xffff0000, v113
    v_lshlrev_b32 v228, 16, v114
    v_and_b32 v229, 0xffff0000, v114
    v_lshlrev_b32 v230, 16, v115
    v_and_b32 v231, 0xffff0000, v115
    v_pk_fma_f32 v[224:225], v[224:225], v[176:177], v[176:177] op_sel:[0,0,1] op_sel_hi:[1,0,1]
    v_pk_fma_f32 v[226:227], v[226:227], v[176:177], v[176:177] op_sel:[0,0,1] op_sel_hi:[1,0,1]
    v_pk_fma_f32 v[228:229], v[228:229], v[176:177], v[176:177] op_sel:[0,0,1] op_sel_hi:[1,0,1]
    v_pk_fma_f32 v[230:231], v[230:231], v[176:177], v[176:177] op_sel:[0,0,1] op_sel_hi:[1,0,1]
    v_cvt_pk_bf16_f32 v112, v224, v225
    v_cvt_pk_bf16_f32 v113, v226, v227
    v_cvt_pk_bf16_f32 v114, v228, v229
    v_cvt_pk_bf16_f32 v115, v230, v231
    ds_write_b128 v218, v[112:115] offset:7168
    v_lshlrev_b32 v224, 16, v120
    v_and_b32 v225, 0xffff0000, v120
    v_lshlrev_b32 v226, 16, v121
    v_and_b32 v227, 0xffff0000, v121
    v_lshlrev_b32 v228, 16, v122
    v_and_b32 v229, 0xffff0000, v122
    v_lshlrev_b32 v230, 16, v123
    v_and_b32 v231, 0xffff0000, v123
    v_pk_fma_f32 v[224:225], v[224:225], v[176:177], v[176:177] op_sel:[0,0,1] op_sel_hi:[1,0,1]
    v_pk_fma_f32 v[226:227], v[226:227], v[176:177], v[176:177] op_sel:[0,0,1] op_sel_hi:[1,0,1]
    v_pk_fma_f32 v[228:229], v[228:229], v[176:177], v[176:177] op_sel:[0,0,1] op_sel_hi:[1,0,1]
    v_pk_fma_f32 v[230:231], v[230:231], v[176:177], v[176:177] op_sel:[0,0,1] op_sel_hi:[1,0,1]
    v_cvt_pk_bf16_f32 v120, v224, v225
    v_cvt_pk_bf16_f32 v121, v226, v227
    v_cvt_pk_bf16_f32 v122, v228, v229
    v_cvt_pk_bf16_f32 v123, v230, v231
    ds_write_b128 v219, v[120:123] offset:7168
    v_lshlrev_b32 v224, 16, v128
    v_and_b32 v225, 0xffff0000, v128
    v_lshlrev_b32 v226, 16, v129
    v_and_b32 v227, 0xffff0000, v129
    v_lshlrev_b32 v228, 16, v130
    v_and_b32 v229, 0xffff0000, v130
    v_lshlrev_b32 v230, 16, v131
    v_and_b32 v231, 0xffff0000, v131
    v_pk_fma_f32 v[224:225], v[224:225], v[176:177], v[176:177] op_sel:[0,0,1] op_sel_hi:[1,0,1]
    v_pk_fma_f32 v[226:227], v[226:227], v[176:177], v[176:177] op_sel:[0,0,1] op_sel_hi:[1,0,1]
    v_pk_fma_f32 v[228:229], v[228:229], v[176:177], v[176:177] op_sel:[0,0,1] op_sel_hi:[1,0,1]
    v_pk_fma_f32 v[230:231], v[230:231], v[176:177], v[176:177] op_sel:[0,0,1] op_sel_hi:[1,0,1]
    v_cvt_pk_bf16_f32 v128, v224, v225
    v_cvt_pk_bf16_f32 v129, v226, v227
    v_cvt_pk_bf16_f32 v130, v228, v229
    v_cvt_pk_bf16_f32 v131, v230, v231
    ds_write_b128 v218, v[128:131] offset:8192
    v_lshlrev_b32 v224, 16, v136
    v_and_b32 v225, 0xffff0000, v136
    v_lshlrev_b32 v226, 16, v137
    v_and_b32 v227, 0xffff0000, v137
    v_lshlrev_b32 v228, 16, v138
    v_and_b32 v229, 0xffff0000, v138
    v_lshlrev_b32 v230, 16, v139
    v_and_b32 v231, 0xffff0000, v139
    v_pk_fma_f32 v[224:225], v[224:225], v[176:177], v[176:177] op_sel:[0,0,1] op_sel_hi:[1,0,1]
    v_pk_fma_f32 v[226:227], v[226:227], v[176:177], v[176:177] op_sel:[0,0,1] op_sel_hi:[1,0,1]
    v_pk_fma_f32 v[228:229], v[228:229], v[176:177], v[176:177] op_sel:[0,0,1] op_sel_hi:[1,0,1]
    v_pk_fma_f32 v[230:231], v[230:231], v[176:177], v[176:177] op_sel:[0,0,1] op_sel_hi:[1,0,1]
    v_cvt_pk_bf16_f32 v136, v224, v225
    v_cvt_pk_bf16_f32 v137, v226, v227
    v_cvt_pk_bf16_f32 v138, v228, v229
    v_cvt_pk_bf16_f32 v139, v230, v231
    ds_write_b128 v219, v[136:139] offset:8192
    s_waitcnt lgkmcnt(0)
    s_barrier
    ds_read_b128 v[4:7], v218 offset:18432
    ds_read_b128 v[12:15], v219 offset:18432
    ds_read_b128 v[20:23], v218 offset:19456
    ds_read_b128 v[28:31], v219 offset:19456
    ds_read_b128 v[36:39], v218 offset:20480
    ds_read_b128 v[44:47], v219 offset:20480
    ds_read_b128 v[52:55], v218 offset:21504
    ds_read_b128 v[60:63], v219 offset:21504
    ds_read_b128 v[68:71], v218 offset:22528
    ds_read_b128 v[76:79], v219 offset:22528
    ds_read_b128 v[84:87], v218 offset:23552
    ds_read_b128 v[92:95], v219 offset:23552
    s_waitcnt lgkmcnt(4)
    ds_read_b128 v[100:103], v218 offset:24576
    ds_read_b128 v[108:111], v219 offset:24576
    ds_read_b128 v[116:119], v218 offset:25600
    ds_read_b128 v[124:127], v219 offset:25600
    ds_read_b128 v[132:135], v218 offset:26624
    ds_read_b128 v[140:143], v219 offset:26624
    s_add_u32 s33, s43, 0
    v_add_u32 v249, s33, v251
    s_waitcnt vmcnt(11) lgkmcnt(0)
    s_barrier
    ds_write_b128 v249, v[144:147] offset:0
    ds_write_b128 v249, v[148:151] offset:1024
    ds_write_b128 v249, v[152:155] offset:2048
    ds_write_b128 v249, v[156:159] offset:3072
    ds_write_b128 v249, v[160:163] offset:4096
    s_setprio 2
    s_waitcnt lgkmcnt(0)
    s_barrier
    s_mov_b32 s32, 0
    s_cmp_eq_u32 s22, 0
    s_cbranch_scc1 k1_kernel_g0a
    s_call_b64 s[50:51], k1_kernel_main1
    s_branch k1_kernel_g0b
k1_kernel_g0a:
    s_call_b64 s[50:51], k1_kernel_main0
k1_kernel_g0b:
    s_mov_b32 s98, 0
    s_cmp_eq_u32 s24, 1
    s_cbranch_scc1 k1_kernel_nonce2
k1_kernel_nonce2back:
    s_setprio 0
    s_mov_b32 s31, 0
    s_mul_i32 s30, s26, 3
    s_add_u32 s30, s30, s28
    s_mov_b32 s38, s29
    s_mov_b32 s40, s52
    s_mov_b32 s41, 81920
    s_mov_b32 s56, s60
    s_and_b32 s57, s61, 0xffff
    s_mov_b32 s58, 2654208
    s_mov_b32 s59, 0x00020000
    s_mul_i32 s39, s2, 12288
    s_lshl_b32 s33, s24, 10
    s_add_u32 s39, s39, s33
    s_cmp_eq_u32 s22, 0
    s_cbranch_scc1 k1_kernel_g0q
    s_call_b64 s[50:51], k1_kernel_epi_z2_side
    s_cmp_eq_u32 s22, 1
    s_cbranch_scc0 k1_kernel_g0t2
    s_call_b64 s[50:51], k1_kernel_final
    s_branch k1_kernel_done
k1_kernel_g0q:
    s_call_b64 s[50:51], k1_kernel_epi_k_side
    v_mov_b32 v255, 157696
    ds_read_b32 v255, v255
    s_waitcnt lgkmcnt(0)
    v_readfirstlane_b32 s84, v255
    s_mul_i32 s85, s84, 0x9e3779b1
    s_xor_b32 s85, s85, 0x5bd1e995
k1_kernel_g0t2:
    s_setprio 2
    s_mov_b32 s32, 40960
    s_or_b32 s33, s24, s22
    s_cmp_eq_u32 s33, 0
    s_cselect_b32 s45, 1, 0
    s_call_b64 s[50:51], k1_kernel_main1
    s_mov_b32 s40, s54
    s_cmp_eq_u32 s22, 0
    s_cbranch_scc1 k1_kernel_g0q2
    s_call_b64 s[50:51], k1_kernel_epi_z1_solo
    s_branch k1_kernel_done
k1_kernel_g0q2:
    s_call_b64 s[50:51], k1_kernel_epi_q
    s_branch k1_kernel_done
k1_kernel_g1:
    ds_read_b128 v[4:7], v218 offset:18432
    ds_read_b128 v[12:15], v219 offset:18432
    ds_read_b128 v[20:23], v218 offset:19456
    ds_read_b128 v[28:31], v219 offset:19456
    ds_read_b128 v[36:39], v218 offset:20480
    ds_read_b128 v[44:47], v219 offset:20480
    ds_read_b128 v[52:55], v218 offset:21504
    ds_read_b128 v[60:63], v219 offset:21504
    ds_read_b128 v[68:71], v218 offset:22528
    ds_read_b128 v[76:79], v219 offset:22528
    ds_read_b128 v[84:87], v218 offset:23552
    ds_read_b128 v[92:95], v219 offset:23552
    s_waitcnt lgkmcnt(6)
    ds_read_b128 v[100:103], v218 offset:24576
    ds_read_b128 v[108:111], v219 offset:24576
    ds_read_b128 v[116:119], v218 offset:25600
    ds_read_b128 v[124:127], v219 offset:25600
    ds_read_b128 v[132:135], v218 offset:26624
    ds_read_b128 v[140:143], v219 offset:26624
    s_mov_b32 m0, 157760
    v_mov_b32 v168, 0
    v_mov_b32 v169, 0
    v_mov_b32 v170, 0
    v_mov_b32 v171, 0
    buffer_load_dwordx4 v[144:147], v244, s[8:11], s30 offen offset:0
    s_waitcnt lgkmcnt(12)
    v_dot2c_f32_bf16 v168, s42, v4
    v_dot2c_f32_bf16 v169, v4, v4
    v_dot2c_f32_bf16 v170, s42, v5
    v_dot2c_f32_bf16 v171, v5, v5
    v_dot2c_f32_bf16 v168, s42, v6
    v_dot2c_f32_bf16 v169, v6, v6
    v_dot2c_f32_bf16 v170, s42, v7
    v_dot2c_f32_bf16 v171, v7, v7
    buffer_load_dwordx4 v[148:151], v245, s[8:11], s30 offen offset:1024
    v_dot2c_f32_bf16 v168, s42, v12
    v_dot2c_f32_bf16 v169, v12, v12
    v_dot2c_f32_bf16 v170, s42, v13
    v_dot2c_f32_bf16 v171, v13, v13
    v_dot2c_f32_bf16 v168, s42, v14
    v_dot2c_f32_bf16 v169, v14, v14
    v_dot2c_f32_bf16 v170, s42, v15
    v_dot2c_f32_bf16 v171, v15, v15
    buffer_load_dwordx4 v[152:155], v246, s[8:11], s30 offen offset:2048
    v_dot2c_f32_bf16 v168, s42, v20
    v_dot2c_f32_bf16 v169, v20, v20
    v_dot2c_f32_bf16 v170, s42, v21
    v_dot2c_f32_bf16 v171, v21, v21
    v_dot2c_f32_bf16 v168, s42, v22
    v_dot2c_f32_bf16 v169, v22, v22
    v_dot2c_f32_bf16 v170, s42, v23
    v_dot2c_f32_bf16 v171, v23, v23
    buffer_load_dwordx4 v[156:159], v247, s[8:11], s30 offen offset:3072
    v_dot2c_f32_bf16 v168, s42, v28
    v_dot2c_f32_bf16 v169, v28, v28
    v_dot2c_f32_bf16 v170, s42, v29
    v_dot2c_f32_bf16 v171, v29, v29
    v_dot2c_f32_bf16 v168, s42, v30
    v_dot2c_f32_bf16 v169, v30, v30
    v_dot2c_f32_bf16 v170, s42, v31
    v_dot2c_f32_bf16 v171, v31, v31
    buffer_load_dwordx4 v[160:163], v248, s[8:11], s30 offen offset:0
    v_dot2c_f32_bf16 v168, s42, v36
    v_dot2c_f32_bf16 v169, v36, v36
    v_dot2c_f32_bf16 v170, s42, v37
    v_dot2c_f32_bf16 v171, v37, v37
    v_dot2c_f32_bf16 v168, s42, v38
    v_dot2c_f32_bf16 v169, v38, v38
    v_dot2c_f32_bf16 v170, s42, v39
    v_dot2c_f32_bf16 v171, v39, v39
    buffer_load_dwordx4 v244, s[8:11], s83 offen offset:0 lds
    v_dot2c_f32_bf16 v168, s42, v44
    v_dot2c_f32_bf16 v169, v44, v44
    v_dot2c_f32_bf16 v170, s42, v45
    v_dot2c_f32_bf16 v171, v45, v45
    v_dot2c_f32_bf16 v168, s42, v46
    v_dot2c_f32_bf16 v169, v46, v46
    v_dot2c_f32_bf16 v170, s42, v47
    v_dot2c_f32_bf16 v171, v47, v47
    s_waitcnt lgkmcnt(6)
    v_dot2c_f32_bf16 v168, s42, v52
    v_dot2c_f32_bf16 v169, v52, v52
    v_dot2c_f32_bf16 v170, s42, v53
    v_dot2c_f32_bf16 v171, v53, v53
    v_dot2c_f32_bf16 v168, s42, v54
    v_dot2c_f32_bf16 v169, v54, v54
    v_dot2c_f32_bf16 v170, s42, v55
    v_dot2c_f32_bf16 v171, v55, v55
    v_dot2c_f32_bf16 v168, s42, v60
    v_dot2c_f32_bf16 v169, v60, v60
    v_dot2c_f32_bf16 v170, s42, v61
    v_dot2c_f32_bf16 v171, v61, v61
    v_dot2c_f32_bf16 v168, s42, v62
    v_dot2c_f32_bf16 v169, v62, v62
    v_dot2c_f32_bf16 v170, s42, v63
    v_dot2c_f32_bf16 v171, v63, v63
    v_dot2c_f32_bf16 v168, s42, v68
    v_dot2c_f32_bf16 v169, v68, v68
    v_dot2c_f32_bf16 v170, s42, v69
    v_dot2c_f32_bf16 v171, v69, v69
    v_dot2c_f32_bf16 v168, s42, v70
    v_dot2c_f32_bf16 v169, v70, v70
    v_dot2c_f32_bf16 v170, s42, v71
    v_dot2c_f32_bf16 v171, v71, v71
    buffer_load_dwordx4 v245, s[8:11], s83 offen offset:1024 lds
    v_dot2c_f32_bf16 v168, s42, v76
    v_dot2c_f32_bf16 v169, v76, v76
    v_dot2c_f32_bf16 v170, s42, v77
    v_dot2c_f32_bf16 v171, v77, v77
    v_dot2c_f32_bf16 v168, s42, v78
    v_dot2c_f32_bf16 v169, v78, v78
    v_dot2c_f32_bf16 v170, s42, v79
    v_dot2c_f32_bf16 v171, v79, v79
    v_dot2c_f32_bf16 v168, s42, v84
    v_dot2c_f32_bf16 v169, v84, v84
    v_dot2c_f32_bf16 v170, s42, v85
    v_dot2c_f32_bf16 v171, v85, v85
    v_dot2c_f32_bf16 v168, s42, v86
    v_dot2c_f32_bf16 v169, v86, v86
    v_dot2c_f32_bf16 v170, s42, v87
    v_dot2c_f32_bf16 v171, v87, v87
    v_dot2c_f32_bf16 v168, s42, v92
    v_dot2c_f32_bf16 v169, v92, v92
    v_dot2c_f32_bf16 v170, s42, v93
    v_dot2c_f32_bf16 v171, v93, v93
    v_dot2c_f32_bf16 v168, s42, v94
    v_dot2c_f32_bf16 v169, v94, v94
    v_dot2c_f32_bf16 v170, s42, v95
    v_dot2c_f32_bf16 v171, v95, v95
    s_waitcnt lgkmcnt(0)
    v_dot2c_f32_bf16 v168, s42, v100
    v_dot2c_f32_bf16 v169, v100, v100
    v_dot2c_f32_bf16 v170, s42, v101
    v_dot2c_f32_bf16 v171, v101, v101
    v_dot2c_f32_bf16 v168, s42, v102
    v_dot2c_f32_bf16 v169, v102, v102
    v_dot2c_f32_bf16 v170, s42, v103
    v_dot2c_f32_bf16 v171, v103, v103
    buffer_load_dwordx4 v246, s[8:11], s83 offen offset:2048 lds
    v_dot2c_f32_bf16 v168, s42, v108
    v_dot2c_f32_bf16 v169, v108, v108
    v_dot2c_f32_bf16 v170, s42, v109
    v_dot2c_f32_bf16 v171, v109, v109
    v_dot2c_f32_bf16 v168, s42, v110
    v_dot2c_f32_bf16 v169, v110, v110
    v_dot2c_f32_bf16 v170, s42, v111
    v_dot2c_f32_bf16 v171, v111, v111
    v_dot2c_f32_bf16 v168, s42, v116
    v_dot2c_f32_bf16 v169, v116, v116
    v_dot2c_f32_bf16 v170, s42, v117
    v_dot2c_f32_bf16 v171, v117, v117
    v_dot2c_f32_bf16 v168, s42, v118
    v_dot2c_f32_bf16 v169, v118, v118
    v_dot2c_f32_bf16 v170, s42, v119
    v_dot2c_f32_bf16 v171, v119, v119
    v_dot2c_f32_bf16 v168, s42, v124
    v_dot2c_f32_bf16 v169, v124, v124
    v_dot2c_f32_bf16 v170, s42, v125
    v_dot2c_f32_bf16 v171, v125, v125
    v_dot2c_f32_bf16 v168, s42, v126
    v_dot2c_f32_bf16 v169, v126, v126
    v_dot2c_f32_bf16 v170, s42, v127
    v_dot2c_f32_bf16 v171, v127, v127
    v_dot2c_f32_bf16 v168, s42, v132
    v_dot2c_f32_bf16 v169, v132, v132
    v_dot2c_f32_bf16 v170, s42, v133
    v_dot2c_f32_bf16 v171, v133, v133
    v_dot2c_f32_bf16 v168, s42, v134
    v_dot2c_f32_bf16 v169, v134, v134
    v_dot2c_f32_bf16 v170, s42, v135
    v_dot2c_f32_bf16 v171, v135, v135
    buffer_load_dwordx4 v247, s[8:11], s83 offen offset:3072 lds
    v_dot2c_f32_bf16 v168, s42, v140
    v_dot2c_f32_bf16 v169, v140, v140
    v_dot2c_f32_bf16 v170, s42, v141
    v_dot2c_f32_bf16 v171, v141, v141
    v_dot2c_f32_bf16 v168, s42, v142
    v_dot2c_f32_bf16 v169, v142, v142
    v_dot2c_f32_bf16 v170, s42, v143
    v_dot2c_f32_bf16 v171, v143, v143
    s_nop 3
    v_add_f32 v168, v168, v170
    v_add_f32 v169, v169, v171
    v_mov_b32 v170, v168
    v_mov_b32 v171, v169
    s_nop 1
    v_permlane32_swap_b32 v168, v170
    v_permlane32_swap_b32 v169, v171
    s_nop 1
    v_add_f32 v168, v168, v170
    v_add_f32 v169, v169, v171
    v_mov_b32 v170, v168
    v_mov_b32 v171, v169
    s_nop 1
    v_permlane16_swap_b32 v168, v170
    v_permlane16_swap_b32 v169, v171
    s_nop 1
    v_add_f32 v168, v168, v170
    v_add_f32 v169, v169, v171
    v_mul_f32 v168, 0x3ae38e39, v168
    v_mul_f32 v169, 0x3ae38e39, v169
    v_fma_f32 v169, -v168, v168, v169
    v_max_f32 v169, 0, v169
    v_add_f32 v169, 0x3727c5ac, v169
    v_rsq_f32 v176, v169
    s_nop 0
    v_mul_f32 v176, s47, v176
    v_mul_f32 v177, v168, v176
    v_sub_f32 v177, 0, v177
    v_lshlrev_b32 v224, 16, v4
    v_and_b32 v225, 0xffff0000, v4
    v_lshlrev_b32 v226, 16, v5
    v_and_b32 v227, 0xffff0000, v5
    v_lshlrev_b32 v228, 16, v6
    v_and_b32 v229, 0xffff0000, v6
    v_lshlrev_b32 v230, 16, v7
    v_and_b32 v231, 0xffff0000, v7
    v_pk_fma_f32 v[224:225], v[224:225], v[176:177], v[176:177] op_sel:[0,0,1] op_sel_hi:[1,0,1]
    v_pk_fma_f32 v[226:227], v[226:227], v[176:177], v[176:177] op_sel:[0,0,1] op_sel_hi:[1,0,1]
    v_pk_fma_f32 v[228:229], v[228:229], v[176:177], v[176:177] op_sel:[0,0,1] op_sel_hi:[1,0,1]
    v_pk_fma_f32 v[230:231], v[230:231], v[176:177], v[176:177] op_sel:[0,0,1] op_sel_hi:[1,0,1]
    v_cvt_pk_bf16_f32 v4, v224, v225
    v_cvt_pk_bf16_f32 v5, v226, v227
    v_cvt_pk_bf16_f32 v6, v228, v229
    v_cvt_pk_bf16_f32 v7, v230, v231
    ds_write_b128 v218, v[4:7] offset:18432
    buffer_load_dwordx4 v248, s[8:11], s83 offen offset:0 lds
    v_lshlrev_b32 v224, 16, v12
    v_and_b32 v225, 0xffff0000, v12
    v_lshlrev_b32 v226, 16, v13
    v_and_b32 v227, 0xffff0000, v13
    v_lshlrev_b32 v228, 16, v14
    v_and_b32 v229, 0xffff0000, v14
    v_lshlrev_b32 v230, 16, v15
    v_and_b32 v231, 0xffff0000, v15
    v_pk_fma_f32 v[224:225], v[224:225], v[176:177], v[176:177] op_sel:[0,0,1] op_sel_hi:[1,0,1]
    v_pk_fma_f32 v[226:227], v[226:227], v[176:177], v[176:177] op_sel:[0,0,1] op_sel_hi:[1,0,1]
    v_pk_fma_f32 v[228:229], v[228:229], v[176:177], v[176:177] op_sel:[0,0,1] op_sel_hi:[1,0,1]
    v_pk_fma_f32 v[230:231], v[230:231], v[176:177], v[176:177] op_sel:[0,0,1] op_sel_hi:[1,0,1]
    v_cvt_pk_bf16_f32 v12, v224, v225
    v_cvt_pk_bf16_f32 v13, v226, v227
    v_cvt_pk_bf16_f32 v14, v228, v229
    v_cvt_pk_bf16_f32 v15, v230, v231
    ds_write_b128 v219, v[12:15] offset:18432
    v_lshlrev_b32 v224, 16, v20
    v_and_b32 v225, 0xffff0000, v20
    v_lshlrev_b32 v226, 16, v21
    v_and_b32 v227, 0xffff0000, v21
    v_lshlrev_b32 v228, 16, v22
    v_and_b32 v229, 0xffff0000, v22
    v_lshlrev_b32 v230, 16, v23
    v_and_b32 v231, 0xffff0000, v23
    v_pk_fma_f32 v[224:225], v[224:225], v[176:177], v[176:177] op_sel:[0,0,1] op_sel_hi:[1,0,1]
    v_pk_fma_f32 v[226:227], v[226:227], v[176:177], v[176:177] op_sel:[0,0,1] op_sel_hi:[1,0,1]
    v_pk_fma_f32 v[228:229], v[228:229], v[176:177], v[176:177] op_sel:[0,0,1] op_sel_hi:[1,0,1]
    v_pk_fma_f32 v[230:231], v[230:231], v[176:177], v[176:177] op_sel:[0,0,1] op_sel_hi:[1,0,1]
    v_cvt_pk_bf16_f32 v20, v224, v225
    v_cvt_pk_bf16_f32 v21, v226, v227
    v_cvt_pk_bf16_f32 v22, v228, v229
    v_cvt_pk_bf16_f32 v23, v230, v231
    ds_write_b128 v218, v[20:23] offset:19456
    buffer_load_dwordx4 v244, s[8:11], s82 offen offset:0 lds
    v_lshlrev_b32 v224, 16, v28
    v_and_b32 v225, 0xffff0000, v28
    v_lshlrev_b32 v226, 16, v29
    v_and_b32 v227, 0xffff0000, v29
    v_lshlrev_b32 v228, 16, v30
    v_and_b32 v229, 0xffff0000, v30
    v_lshlrev_b32 v230, 16, v31
    v_and_b32 v231, 0xffff0000, v31
    v_pk_fma_f32 v[224:225], v[224:225], v[176:177], v[176:177] op_sel:[0,0,1] op_sel_hi:[1,0,1]
    v_pk_fma_f32 v[226:227], v[226:227], v[176:177], v[176:177] op_sel:[0,0,1] op_sel_hi:[1,0,1]
    v_pk_fma_f32 v[228:229], v[228:229], v[176:177], v[176:177] op_sel:[0,0,1] op_sel_hi:[1,0,1]
    v_pk_fma_f32 v[230:231], v[230:231], v[176:177], v[176:177] op_sel:[0,0,1] op_sel_hi:[1,0,1]
    v_cvt_pk_bf16_f32 v28, v224, v225
    v_cvt_pk_bf16_f32 v29, v226, v227
    v_cvt_pk_bf16_f32 v30, v228, v229
    v_cvt_pk_bf16_f32 v31, v230, v231
    ds_write_b128 v219, v[28:31] offset:19456
    v_lshlrev_b32 v224, 16, v36
    v_and_b32 v225, 0xffff0000, v36
    v_lshlrev_b32 v226, 16, v37
    v_and_b32 v227, 0xffff0000, v37
    v_lshlrev_b32 v228, 16, v38
    v_and_b32 v229, 0xffff0000, v38
    v_lshlrev_b32 v230, 16, v39
    v_and_b32 v231, 0xffff0000, v39
    v_pk_fma_f32 v[224:225], v[224:225], v[176:177], v[176:177] op_sel:[0,0,1] op_sel_hi:[1,0,1]
    v_pk_fma_f32 v[226:227], v[226:227], v[176:177], v[176:177] op_sel:[0,0,1] op_sel_hi:[1,0,1]
    v_pk_fma_f32 v[228:229], v[228:229], v[176:177], v[176:177] op_sel:[0,0,1] op_sel_hi:[1,0,1]
    v_pk_fma_f32 v[230:231], v[230:231], v[176:177], v[176:177] op_sel:[0,0,1] op_sel_hi:[1,0,1]
    v_cvt_pk_bf16_f32 v36, v224, v225
    v_cvt_pk_bf16_f32 v37, v226, v227
    v_cvt_pk_bf16_f32 v38, v228, v229
    v_cvt_pk_bf16_f32 v39, v230, v231
    ds_write_b128 v218, v[36:39] offset:20480
    buffer_load_dwordx4 v245, s[8:11], s82 offen offset:1024 lds
    v_lshlrev_b32 v224, 16, v44
    v_and_b32 v225, 0xffff0000, v44
    v_lshlrev_b32 v226, 16, v45
    v_and_b32 v227, 0xffff0000, v45
    v_lshlrev_b32 v228, 16, v46
    v_and_b32 v229, 0xffff0000, v46
    v_lshlrev_b32 v230, 16, v47
    v_and_b32 v231, 0xffff0000, v47
    v_pk_fma_f32 v[224:225], v[224:225], v[176:177], v[176:177] op_sel:[0,0,1] op_sel_hi:[1,0,1]
    v_pk_fma_f32 v[226:227], v[226:227], v[176:177], v[176:177] op_sel:[0,0,1] op_sel_hi:[1,0,1]
    v_pk_fma_f32 v[228:229], v[228:229], v[176:177], v[176:177] op_sel:[0,0,1] op_sel_hi:[1,0,1]
    v_pk_fma_f32 v[230:231], v[230:231], v[176:177], v[176:177] op_sel:[0,0,1] op_sel_hi:[1,0,1]
    v_cvt_pk_bf16_f32 v44, v224, v225
    v_cvt_pk_bf16_f32 v45, v226, v227
    v_cvt_pk_bf16_f32 v46, v228, v229
    v_cvt_pk_bf16_f32 v47, v230, v231
    ds_write_b128 v219, v[44:47] offset:20480
    v_lshlrev_b32 v224, 16, v52
    v_and_b32 v225, 0xffff0000, v52
    v_lshlrev_b32 v226, 16, v53
    v_and_b32 v227, 0xffff0000, v53
    v_lshlrev_b32 v228, 16, v54
    v_and_b32 v229, 0xffff0000, v54
    v_lshlrev_b32 v230, 16, v55
    v_and_b32 v231, 0xffff0000, v55
    v_pk_fma_f32 v[224:225], v[224:225], v[176:177], v[176:177] op_sel:[0,0,1] op_sel_hi:[1,0,1]
    v_pk_fma_f32 v[226:227], v[226:227], v[176:177], v[176:177] op_sel:[0,0,1] op_sel_hi:[1,0,1]
    v_pk_fma_f32 v[228:229], v[228:229], v[176:177], v[176:177] op_sel:[0,0,1] op_sel_hi:[1,0,1]
    v_pk_fma_f32 v[230:231], v[230:231], v[176:177], v[176:177] op_sel:[0,0,1] op_sel_hi:[1,0,1]
    v_cvt_pk_bf16_f32 v52, v224, v225
    v_cvt_pk_bf16_f32 v53, v226, v227
    v_cvt_pk_bf16_f32 v54, v228, v229
    v_cvt_pk_bf16_f32 v55, v230, v231
    ds_write_b128 v218, v[52:55] offset:21504
    buffer_load_dwordx4 v246, s[8:11], s82 offen offset:2048 lds
    v_lshlrev_b32 v224, 16, v60
    v_and_b32 v225, 0xffff0000, v60
    v_lshlrev_b32 v226, 16, v61
    v_and_b32 v227, 0xffff0000, v61
    v_lshlrev_b32 v228, 16, v62
    v_and_b32 v229, 0xffff0000, v62
    v_lshlrev_b32 v230, 16, v63
    v_and_b32 v231, 0xffff0000, v63
    v_pk_fma_f32 v[224:225], v[224:225], v[176:177], v[176:177] op_sel:[0,0,1] op_sel_hi:[1,0,1]
    v_pk_fma_f32 v[226:227], v[226:227], v[176:177], v[176:177] op_sel:[0,0,1] op_sel_hi:[1,0,1]
    v_pk_fma_f32 v[228:229], v[228:229], v[176:177], v[176:177] op_sel:[0,0,1] op_sel_hi:[1,0,1]
    v_pk_fma_f32 v[230:231], v[230:231], v[176:177], v[176:177] op_sel:[0,0,1] op_sel_hi:[1,0,1]
    v_cvt_pk_bf16_f32 v60, v224, v225
    v_cvt_pk_bf16_f32 v61, v226, v227
    v_cvt_pk_bf16_f32 v62, v228, v229
    v_cvt_pk_bf16_f32 v63, v230, v231
    ds_write_b128 v219, v[60:63] offset:21504
    v_lshlrev_b32 v224, 16, v68
    v_and_b32 v225, 0xffff0000, v68
    v_lshlrev_b32 v226, 16, v69
    v_and_b32 v227, 0xffff0000, v69
    v_lshlrev_b32 v228, 16, v70
    v_and_b32 v229, 0xffff0000, v70
    v_lshlrev_b32 v230, 16, v71
    v_and_b32 v231, 0xffff0000, v71
    v_pk_fma_f32 v[224:225], v[224:225], v[176:177], v[176:177] op_sel:[0,0,1] op_sel_hi:[1,0,1]
    v_pk_fma_f32 v[226:227], v[226:227], v[176:177], v[176:177] op_sel:[0,0,1] op_sel_hi:[1,0,1]
    v_pk_fma_f32 v[228:229], v[228:229], v[176:177], v[176:177] op_sel:[0,0,1] op_sel_hi:[1,0,1]
    v_pk_fma_f32 v[230:231], v[230:231], v[176:177], v[176:177] op_sel:[0,0,1] op_sel_hi:[1,0,1]
    v_cvt_pk_bf16_f32 v68, v224, v225
    v_cvt_pk_bf16_f32 v69, v226, v227
    v_cvt_pk_bf16_f32 v70, v228, v229
    v_cvt_pk_bf16_f32 v71, v230, v231
    ds_write_b128 v218, v[68:71] offset:22528
    buffer_load_dwordx4 v247, s[8:11], s82 offen offset:3072 lds
    v_lshlrev_b32 v224, 16, v76
    v_and_b32 v225, 0xffff0000, v76
    v_lshlrev_b32 v226, 16, v77
    v_and_b32 v227, 0xffff0000, v77
    v_lshlrev_b32 v228, 16, v78
    v_and_b32 v229, 0xffff0000, v78
    v_lshlrev_b32 v230, 16, v79
    v_and_b32 v231, 0xffff0000, v79
    v_pk_fma_f32 v[224:225], v[224:225], v[176:177], v[176:177] op_sel:[0,0,1] op_sel_hi:[1,0,1]
    v_pk_fma_f32 v[226:227], v[226:227], v[176:177], v[176:177] op_sel:[0,0,1] op_sel_hi:[1,0,1]
    v_pk_fma_f32 v[228:229], v[228:229], v[176:177], v[176:177] op_sel:[0,0,1] op_sel_hi:[1,0,1]
    v_pk_fma_f32 v[230:231], v[230:231], v[176:177], v[176:177] op_sel:[0,0,1] op_sel_hi:[1,0,1]
    v_cvt_pk_bf16_f32 v76, v224, v225
    v_cvt_pk_bf16_f32 v77, v226, v227
    v_cvt_pk_bf16_f32 v78, v228, v229
    v_cvt_pk_bf16_f32 v79, v230, v231
    ds_write_b128 v219, v[76:79] offset:22528
    v_lshlrev_b32 v224, 16, v84
    v_and_b32 v225, 0xffff0000, v84
    v_lshlrev_b32 v226, 16, v85
    v_and_b32 v227, 0xffff0000, v85
    v_lshlrev_b32 v228, 16, v86
    v_and_b32 v229, 0xffff0000, v86
    v_lshlrev_b32 v230, 16, v87
    v_and_b32 v231, 0xffff0000, v87
    v_pk_fma_f32 v[224:225], v[224:225], v[176:177], v[176:177] op_sel:[0,0,1] op_sel_hi:[1,0,1]
    v_pk_fma_f32 v[226:227], v[226:227], v[176:177], v[176:177] op_sel:[0,0,1] op_sel_hi:[1,0,1]
    v_pk_fma_f32 v[228:229], v[228:229], v[176:177], v[176:177] op_sel:[0,0,1] op_sel_hi:[1,0,1]
    v_pk_fma_f32 v[230:231], v[230:231], v[176:177], v[176:177] op_sel:[0,0,1] op_sel_hi:[1,0,1]
    v_cvt_pk_bf16_f32 v84, v224, v225
    v_cvt_pk_bf16_f32 v85, v226, v227
    v_cvt_pk_bf16_f32 v86, v228, v229
    v_cvt_pk_bf16_f32 v87, v230, v231
    ds_write_b128 v218, v[84:87] offset:23552
    buffer_load_dwordx4 v248, s[8:11], s82 offen offset:0 lds
    v_lshlrev_b32 v224, 16, v92
    v_and_b32 v225, 0xffff0000, v92
    v_lshlrev_b32 v226, 16, v93
    v_and_b32 v227, 0xffff0000, v93
    v_lshlrev_b32 v228, 16, v94
    v_and_b32 v229, 0xffff0000, v94
    v_lshlrev_b32 v230, 16, v95
    v_and_b32 v231, 0xffff0000, v95
    v_pk_fma_f32 v[224:225], v[224:225], v[176:177], v[176:177] op_sel:[0,0,1] op_sel_hi:[1,0,1]
    v_pk_fma_f32 v[226:227], v[226:227], v[176:177], v[176:177] op_sel:[0,0,1] op_sel_hi:[1,0,1]
    v_pk_fma_f32 v[228:229], v[228:229], v[176:177], v[176:177] op_sel:[0,0,1] op_sel_hi:[1,0,1]
    v_pk_fma_f32 v[230:231], v[230:231], v[176:177], v[176:177] op_sel:[0,0,1] op_sel_hi:[1,0,1]
    v_cvt_pk_bf16_f32 v92, v224, v225
    v_cvt_pk_bf16_f32 v93, v226, v227
    v_cvt_pk_bf16_f32 v94, v228, v229
    v_cvt_pk_bf16_f32 v95, v230, v231
    ds_write_b128 v219, v[92:95] offset:23552
    v_lshlrev_b32 v224, 16, v100
    v_and_b32 v225, 0xffff0000, v100
    v_lshlrev_b32 v226, 16, v101
    v_and_b32 v227, 0xffff0000, v101
    v_lshlrev_b32 v228, 16, v102
    v_and_b32 v229, 0xffff0000, v102
    v_lshlrev_b32 v230, 16, v103
    v_and_b32 v231, 0xffff0000, v103
    v_pk_fma_f32 v[224:225], v[224:225], v[176:177], v[176:177] op_sel:[0,0,1] op_sel_hi:[1,0,1]
    v_pk_fma_f32 v[226:227], v[226:227], v[176:177], v[176:177] op_sel:[0,0,1] op_sel_hi:[1,0,1]
    v_pk_fma_f32 v[228:229], v[228:229], v[176:177], v[176:177] op_sel:[0,0,1] op_sel_hi:[1,0,1]
    v_pk_fma_f32 v[230:231], v[230:231], v[176:177], v[176:177] op_sel:[0,0,1] op_sel_hi:[1,0,1]
    v_cvt_pk_bf16_f32 v100, v224, v225
    v_cvt_pk_bf16_f32 v101, v226, v227
    v_cvt_pk_bf16_f32 v102, v228, v229
    v_cvt_pk_bf16_f32 v103, v230, v231
    ds_write_b128 v218, v[100:103] offset:24576
    v_lshlrev_b32 v224, 16, v108
    v_and_b32 v225, 0xffff0000, v108
    v_lshlrev_b32 v226, 16, v109
    v_and_b32 v227, 0xffff0000, v109
    v_lshlrev_b32 v228, 16, v110
    v_and_b32 v229, 0xffff0000, v110
    v_lshlrev_b32 v230, 16, v111
    v_and_b32 v231, 0xffff0000, v111
    v_pk_fma_f32 v[224:225], v[224:225], v[176:177], v[176:177] op_sel:[0,0,1] op_sel_hi:[1,0,1]
    v_pk_fma_f32 v[226:227], v[226:227], v[176:177], v[176:177] op_sel:[0,0,1] op_sel_hi:[1,0,1]
    v_pk_fma_f32 v[228:229], v[228:229], v[176:177], v[176:177] op_sel:[0,0,1] op_sel_hi:[1,0,1]
    v_pk_fma_f32 v[230:231], v[230:231], v[176:177], v[176:177] op_sel:[0,0,1] op_sel_hi:[1,0,1]
    v_cvt_pk_bf16_f32 v108, v224, v225
    v_cvt_pk_bf16_f32 v109, v226, v227
    v_cvt_pk_bf16_f32 v110, v228, v229
    v_cvt_pk_bf16_f32 v111, v230, v231
    ds_write_b128 v219, v[108:111] offset:24576
    v_lshlrev_b32 v224, 16, v116
    v_and_b32 v225, 0xffff0000, v116
    v_lshlrev_b32 v226, 16, v117
    v_and_b32 v227, 0xffff0000, v117
    v_lshlrev_b32 v228, 16, v118
    v_and_b32 v229, 0xffff0000, v118
    v_lshlrev_b32 v230, 16, v119
    v_and_b32 v231, 0xffff0000, v119
    v_pk_fma_f32 v[224:225], v[224:225], v[176:177], v[176:177] op_sel:[0,0,1] op_sel_hi:[1,0,1]
    v_pk_fma_f32 v[226:227], v[226:227], v[176:177], v[176:177] op_sel:[0,0,1] op_sel_hi:[1,0,1]
    v_pk_fma_f32 v[228:229], v[228:229], v[176:177], v[176:177] op_sel:[0,0,1] op_sel_hi:[1,0,1]
    v_pk_fma_f32 v[230:231], v[230:231], v[176:177], v[176:177] op_sel:[0,0,1] op_sel_hi:[1,0,1]
    v_cvt_pk_bf16_f32 v116, v224, v225
    v_cvt_pk_bf16_f32 v117, v226, v227
    v_cvt_pk_bf16_f32 v118, v228, v229
    v_cvt_pk_bf16_f32 v119, v230, v231
    ds_write_b128 v218, v[116:119] offset:25600
    v_lshlrev_b32 v224, 16, v124
    v_and_b32 v225, 0xffff0000, v124
    v_lshlrev_b32 v226, 16, v125
    v_and_b32 v227, 0xffff0000, v125
    v_lshlrev_b32 v228, 16, v126
    v_and_b32 v229, 0xffff0000, v126
    v_lshlrev_b32 v230, 16, v127
    v_and_b32 v231, 0xffff0000, v127
    v_pk_fma_f32 v[224:225], v[224:225], v[176:177], v[176:177] op_sel:[0,0,1] op_sel_hi:[1,0,1]
    v_pk_fma_f32 v[226:227], v[226:227], v[176:177], v[176:177] op_sel:[0,0,1] op_sel_hi:[1,0,1]
    v_pk_fma_f32 v[228:229], v[228:229], v[176:177], v[176:177] op_sel:[0,0,1] op_sel_hi:[1,0,1]
    v_pk_fma_f32 v[230:231], v[230:231], v[176:177], v[176:177] op_sel:[0,0,1] op_sel_hi:[1,0,1]
    v_cvt_pk_bf16_f32 v124, v224, v225
    v_cvt_pk_bf16_f32 v125, v226, v227
    v_cvt_pk_bf16_f32 v126, v228, v229
    v_cvt_pk_bf16_f32 v127, v230, v231
    ds_write_b128 v219, v[124:127] offset:25600
    v_lshlrev_b32 v224, 16, v132
    v_and_b32 v225, 0xffff0000, v132
    v_lshlrev_b32 v226, 16, v133
    v_and_b32 v227, 0xffff0000, v133
    v_lshlrev_b32 v228, 16, v134
    v_and_b32 v229, 0xffff0000, v134
    v_lshlrev_b32 v230, 16, v135
    v_and_b32 v231, 0xffff0000, v135
    v_pk_fma_f32 v[224:225], v[224:225], v[176:177], v[176:177] op_sel:[0,0,1] op_sel_hi:[1,0,1]
    v_pk_fma_f32 v[226:227], v[226:227], v[176:177], v[176:177] op_sel:[0,0,1] op_sel_hi:[1,0,1]
    v_pk_fma_f32 v[228:229], v[228:229], v[176:177], v[176:177] op_sel:[0,0,1] op_sel_hi:[1,0,1]
    v_pk_fma_f32 v[230:231], v[230:231], v[176:177], v[176:177] op_sel:[0,0,1] op_sel_hi:[1,0,1]
    v_cvt_pk_bf16_f32 v132, v224, v225
    v_cvt_pk_bf16_f32 v133, v226, v227
    v_cvt_pk_bf16_f32 v134, v228, v229
    v_cvt_pk_bf16_f32 v135, v230, v231
    ds_write_b128 v218, v[132:135] offset:26624
    v_lshlrev_b32 v224, 16, v140
    v_and_b32 v225, 0xffff0000, v140
    v_lshlrev_b32 v226, 16, v141
    v_and_b32 v227, 0xffff0000, v141
    v_lshlrev_b32 v228, 16, v142
    v_and_b32 v229, 0xffff0000, v142
    v_lshlrev_b32 v230, 16, v143
    v_and_b32 v231, 0xffff0000, v143
    v_pk_fma_f32 v[224:225], v[224:225], v[176:177], v[176:177] op_sel:[0,0,1] op_sel_hi:[1,0,1]
    v_pk_fma_f32 v[226:227], v[226:227], v[176:177], v[176:177] op_sel:[0,0,1] op_sel_hi:[1,0,1]
    v_pk_fma_f32 v[228:229], v[228:229], v[176:177], v[176:177] op_sel:[0,0,1] op_sel_hi:[1,0,1]
    v_pk_fma_f32 v[230:231], v[230:231], v[176:177], v[176:177] op_sel:[0,0,1] op_sel_hi:[1,0,1]
    v_cvt_pk_bf16_f32 v140, v224, v225
    v_cvt_pk_bf16_f32 v141, v226, v227
    v_cvt_pk_bf16_f32 v142, v228, v229
    v_cvt_pk_bf16_f32 v143, v230, v231
    ds_write_b128 v219, v[140:143] offset:26624
    s_waitcnt lgkmcnt(0)
    s_barrier
    ds_read_b128 v[0:3], v218 offset:0
    ds_read_b128 v[8:11], v219 offset:0
    ds_read_b128 v[16:19], v218 offset:1024
    ds_read_b128 v[24:27], v219 offset:1024
    ds_read_b128 v[32:35], v218 offset:2048
    ds_read_b128 v[40:43], v219 offset:2048
    ds_read_b128 v[48:51], v218 offset:3072
    ds_read_b128 v[56:59], v219 offset:3072
    ds_read_b128 v[64:67], v218 offset:4096
    ds_read_b128 v[72:75], v219 offset:4096
    ds_read_b128 v[80:83], v218 offset:5120
    ds_read_b128 v[88:91], v219 offset:5120
    s_waitcnt lgkmcnt(4)
    ds_read_b128 v[96:99], v218 offset:6144
    ds_read_b128 v[104:107], v219 offset:6144
    ds_read_b128 v[112:115], v218 offset:7168
    ds_read_b128 v[120:123], v219 offset:7168
    ds_read_b128 v[128:131], v218 offset:8192
    ds_read_b128 v[136:139], v219 offset:8192
    s_add_u32 s33, s43, 20480
    v_add_u32 v249, s33, v251
    s_waitcnt vmcnt(10) lgkmcnt(0)
    s_barrier
    ds_write_b128 v249, v[144:147] offset:0
    ds_write_b128 v249, v[148:151] offset:1024
    ds_write_b128 v249, v[152:155] offset:2048
    ds_write_b128 v249, v[156:159] offset:3072
    ds_write_b128 v249, v[160:163] offset:4096
    s_mov_b32 s31, 40960
    s_add_u32 s30, s30, s26
    s_mov_b32 s38, s28
    s_add_u32 m0, s31, s43
    s_add_u32 s31, s31, 20480
    buffer_load_dwordx4 v244, s[8:11], s30 offen lds
    buffer_load_dwordx4 v245, s[8:11], s30 offen offset:1024 lds
    buffer_load_dwordx4 v246, s[8:11], s30 offen offset:2048 lds
    buffer_load_dwordx4 v247, s[8:11], s30 offen offset:3072 lds
    s_add_u32 m0, m0, 4096
    s_cmp_ge_u32 s31, 81920
    s_cselect_b32 s31, 0, s31
    buffer_load_dwordx4 v248, s[8:11], s30 offen lds
    s_add_u32 s30, s30, s26
    s_waitcnt lgkmcnt(0)
    s_barrier
    s_lshl_b32 s39, s2, 15
    s_lshl_b32 s33, s24, 10
    s_add_u32 s39, s39, s33
    s_barrier
    s_add_u32 m0, s31, s43
    s_add_u32 s31, s31, 20480
    buffer_load_dwordx4 v244, s[8:11], s30 offen lds
    buffer_load_dwordx4 v245, s[8:11], s30 offen offset:1024 lds
    buffer_load_dwordx4 v246, s[8:11], s30 offen offset:2048 lds
    buffer_load_dwordx4 v247, s[8:11], s30 offen offset:3072 lds
    s_add_u32 m0, m0, 4096
    s_cmp_ge_u32 s31, 81920
    s_cselect_b32 s31, 0, s31
    buffer_load_dwordx4 v248, s[8:11], s30 offen lds
    s_add_u32 s30, s30, s26
    buffer_load_dwordx4 v[252:255], v251, s[56:59], s39 offen
    s_add_u32 s39, s39, 4096
    s_waitcnt vmcnt(6)
    s_barrier
    s_add_u32 m0, s31, s43
    s_add_u32 s31, s31, 20480
    buffer_load_dwordx4 v244, s[8:11], s30 offen lds
    buffer_load_dwordx4 v245, s[8:11], s30 offen offset:1024 lds
    buffer_load_dwordx4 v246, s[8:11], s30 offen offset:2048 lds
    buffer_load_dwordx4 v247, s[8:11], s30 offen offset:3072 lds
    s_add_u32 m0, m0, 4096
    s_cmp_ge_u32 s31, 81920
    s_cselect_b32 s31, 0, s31
    buffer_load_dwordx4 v248, s[8:11], s30 offen lds
    s_add_u32 s30, s30, s26
    buffer_load_dwordx4 v[252:255], v251, s[56:59], s39 offen
    s_add_u32 s39, s39, 4096
    s_waitcnt vmcnt(7)
    s_barrier
    s_add_u32 m0, s31, s43
    s_add_u32 s31, s31, 20480
    buffer_load_dwordx4 v244, s[8:11], s30 offen lds
    buffer_load_dwordx4 v245, s[8:11], s30 offen offset:1024 lds
    buffer_load_dwordx4 v246, s[8:11], s30 offen offset:2048 lds
    buffer_load_dwordx4 v247, s[8:11], s30 offen offset:3072 lds
    s_add_u32 m0, m0, 4096
    s_cmp_ge_u32 s31, 81920
    s_cselect_b32 s31, 0, s31
    buffer_load_dwordx4 v248, s[8:11], s30 offen lds
    s_add_u32 s30, s30, s26
    buffer_load_dwordx4 v[252:255], v251, s[56:59], s39 offen
    s_add_u32 s39, s39, 4096
    s_waitcnt vmcnt(7)
    s_barrier
    s_add_u32 m0, s31, s43
    s_add_u32 s31, s31, 20480
    buffer_load_dwordx4 v244, s[8:11], s30 offen lds
    buffer_load_dwordx4 v245, s[8:11], s30 offen offset:1024 lds
    buffer_load_dwordx4 v246, s[8:11], s30 offen offset:2048 lds
    buffer_load_dwordx4 v247, s[8:11], s30 offen offset:3072 lds
    s_add_u32 m0, m0, 4096
    s_cmp_ge_u32 s31, 81920
    s_cselect_b32 s31, 0, s31
    buffer_load_dwordx4 v248, s[8:11], s30 offen lds
    s_add_u32 s30, s30, s26
    buffer_load_dwordx4 v[252:255], v251, s[56:59], s39 offen
    s_add_u32 s39, s39, 4096
    s_waitcnt vmcnt(7)
    s_barrier
    s_add_u32 m0, s31, s43
    s_add_u32 s31, s31, 20480
    buffer_load_dwordx4 v244, s[8:11], s30 offen lds
    buffer_load_dwordx4 v245, s[8:11], s30 offen offset:1024 lds
    buffer_load_dwordx4 v246, s[8:11], s30 offen offset:2048 lds
    buffer_load_dwordx4 v247, s[8:11], s30 offen offset:3072 lds
    s_add_u32 m0, m0, 4096
    s_cmp_ge_u32 s31, 81920
    s_cselect_b32 s31, 0, s31
    buffer_load_dwordx4 v248, s[8:11], s30 offen lds
    s_add_u32 s30, s30, s26
    buffer_load_dwordx4 v[252:255], v251, s[56:59], s39 offen
    s_add_u32 s39, s39, 4096
    s_waitcnt vmcnt(7)
    s_barrier
    s_add_u32 m0, s31, s43
    s_add_u32 s31, s31, 20480
    buffer_load_dwordx4 v244, s[8:11], s30 offen lds
    buffer_load_dwordx4 v245, s[8:11], s30 offen offset:1024 lds
    buffer_load_dwordx4 v246, s[8:11], s30 offen offset:2048 lds
    buffer_load_dwordx4 v247, s[8:11], s30 offen offset:3072 lds
    s_add_u32 m0, m0, 4096
    s_cmp_ge_u32 s31, 81920
    s_cselect_b32 s31, 0, s31
    buffer_load_dwordx4 v248, s[8:11], s30 offen lds
    s_add_u32 s30, s30, s26
    buffer_load_dwordx4 v[252:255], v251, s[56:59], s39 offen
    s_add_u32 s39, s39, 4096
    s_waitcnt vmcnt(7)
    s_barrier
    s_mov_b32 s30, s38
    s_add_u32 m0, s31, s43
    s_add_u32 s31, s31, 20480
    buffer_load_dwordx4 v244, s[8:11], s30 offen lds
    buffer_load_dwordx4 v245, s[8:11], s30 offen offset:1024 lds
    buffer_load_dwordx4 v246, s[8:11], s30 offen offset:2048 lds
    buffer_load_dwordx4 v247, s[8:11], s30 offen offset:3072 lds
    s_add_u32 m0, m0, 4096
    s_cmp_ge_u32 s31, 81920
    s_cselect_b32 s31, 0, s31
    buffer_load_dwordx4 v248, s[8:11], s30 offen lds
    s_add_u32 s30, s30, s26
    buffer_load_dwordx4 v[252:255], v251, s[56:59], s39 offen
    s_add_u32 s39, s39, 4096
    s_waitcnt vmcnt(7)
    s_barrier
    s_add_u32 m0, s31, s43
    s_add_u32 s31, s31, 20480
    buffer_load_dwordx4 v244, s[8:11], s30 offen lds
    buffer_load_dwordx4 v245, s[8:11], s30 offen offset:1024 lds
    buffer_load_dwordx4 v246, s[8:11], s30 offen offset:2048 lds
    buffer_load_dwordx4 v247, s[8:11], s30 offen offset:3072 lds
    s_add_u32 m0, m0, 4096
    s_cmp_ge_u32 s31, 81920
    s_cselect_b32 s31, 0, s31
    buffer_load_dwordx4 v248, s[8:11], s30 offen lds
    s_add_u32 s30, s30, s26
    buffer_load_dwordx4 v[252:255], v251, s[56:59], s39 offen
    s_add_u32 s39, s39, 4096
    s_waitcnt vmcnt(7)
    s_barrier
    s_add_u32 m0, s31, s43
    s_add_u32 s31, s31, 20480
    buffer_load_dwordx4 v244, s[8:11], s30 offen lds
    buffer_load_dwordx4 v245, s[8:11], s30 offen offset:1024 lds
    buffer_load_dwordx4 v246, s[8:11], s30 offen offset:2048 lds
    buffer_load_dwordx4 v247, s[8:11], s30 offen offset:3072 lds
    s_add_u32 m0, m0, 4096
    s_cmp_ge_u32 s31, 81920
    s_cselect_b32 s31, 0, s31
    buffer_load_dwordx4 v248, s[8:11], s30 offen lds
    s_add_u32 s30, s30, s26
    s_mov_b32 s33, 2130706432
    buffer_load_dword v252, v251, s[12:15], s33 offen
    s_setprio 2
    s_mov_b32 s32, 20480
    s_cmp_eq_u32 s22, 0
    s_cbranch_scc1 k1_kernel_g1a
    s_call_b64 s[50:51], k1_kernel_main1
    s_branch k1_kernel_g1b
k1_kernel_g1a:
    s_call_b64 s[50:51], k1_kernel_main0
k1_kernel_g1b:
    s_setprio 0
    s_mov_b32 s31, 20480
    s_mul_i32 s30, s26, 3
    s_add_u32 s30, s30, s29
    s_mov_b32 s38, 2130706432
    s_mov_b32 s40, s53
    s_mov_b32 s41, 119808
    s_cmp_eq_u32 s22, 0
    s_cbranch_scc1 k1_kernel_epi_v
    s_cmp_eq_u32 s22, 1
    s_cbranch_scc0 k1_kernel_g1z1
    s_call_b64 s[50:51], k1_kernel_epi_z2_solo
    s_call_b64 s[50:51], k1_kernel_final
    s_branch k1_kernel_kvred
k1_kernel_g1z1:
    s_call_b64 s[50:51], k1_kernel_epi_z1_side
    s_mov_b32 s40, s52
    s_mov_b32 s41, 81920
    s_call_b64 s[50:51], k1_kernel_final
k1_kernel_done:
k1_kernel_end:
    s_endpgm
.p2align 6
k1_kernel_main0:
    v_add_u32 v249, s32, v250
    ds_read_b64_tr_b16 v[216:217], v249 offset:0
    ds_read_b64_tr_b16 v[218:219], v249 offset:1280
    ds_read_b64_tr_b16 v[220:221], v249 offset:32
    ds_read_b64_tr_b16 v[222:223], v249 offset:1312
    ds_read_b64_tr_b16 v[224:225], v249 offset:64
    ds_read_b64_tr_b16 v[226:227], v249 offset:1344
    ds_read_b64_tr_b16 v[228:229], v249 offset:96
    ds_read_b64_tr_b16 v[230:231], v249 offset:1376
    ds_read_b64_tr_b16 v[232:233], v249 offset:128
    ds_read_b64_tr_b16 v[234:235], v249 offset:1408
    ds_read_b64_tr_b16 v[236:237], v249 offset:160
    ds_read_b64_tr_b16 v[238:239], v249 offset:1440
    s_waitcnt lgkmcnt(10)
    v_mfma_f32_16x16x32_bf16 v[144:147], v[0:3], v[216:219], 0
    ds_read_b64_tr_b16 v[240:241], v249 offset:192
    v_mfma_f32_16x16x32_bf16 v[148:151], v[4:7], v[216:219], 0
    ds_read_b64_tr_b16 v[242:243], v249 offset:1472
    s_waitcnt lgkmcnt(10)
    v_mfma_f32_16x16x32_bf16 v[152:155], v[0:3], v[220:223], 0
    ds_read_b64_tr_b16 v[216:217], v249 offset:224
    v_mfma_f32_16x16x32_bf16 v[156:159], v[4:7], v[220:223], 0
    ds_read_b64_tr_b16 v[218:219], v249 offset:1504
    s_waitcnt lgkmcnt(10)
    v_mfma_f32_16x16x32_bf16 v[160:163], v[0:3], v[224:227], 0
    ds_read_b64_tr_b16 v[220:221], v249 offset:256
    v_mfma_f32_16x16x32_bf16 v[164:167], v[4:7], v[224:227], 0
    ds_read_b64_tr_b16 v[222:223], v249 offset:1536
    s_waitcnt lgkmcnt(10)
    v_mfma_f32_16x16x32_bf16 v[168:171], v[0:3], v[228:231], 0
    ds_read_b64_tr_b16 v[224:225], v249 offset:10240
    v_mfma_f32_16x16x32_bf16 v[172:175], v[4:7], v[228:231], 0
    ds_read_b64_tr_b16 v[226:227], v249 offset:11520
    s_waitcnt lgkmcnt(10)
    v_mfma_f32_16x16x32_bf16 v[176:179], v[0:3], v[232:235], 0
    ds_read_b64_tr_b16 v[228:229], v249 offset:10272
    v_mfma_f32_16x16x32_bf16 v[180:183], v[4:7], v[232:235], 0
    ds_read_b64_tr_b16 v[230:231], v249 offset:11552
    s_waitcnt lgkmcnt(10)
    v_mfma_f32_16x16x32_bf16 v[184:187], v[0:3], v[236:239], 0
    ds_read_b64_tr_b16 v[232:233], v249 offset:10304
    v_mfma_f32_16x16x32_bf16 v[188:191], v[4:7], v[236:239], 0
    ds_read_b64_tr_b16 v[234:235], v249 offset:11584
    s_waitcnt lgkmcnt(10)
    v_mfma_f32_16x16x32_bf16 v[192:195], v[0:3], v[240:243], 0
    ds_read_b64_tr_b16 v[236:237], v249 offset:10336
    v_mfma_f32_16x16x32_bf16 v[196:199], v[4:7], v[240:243], 0
    ds_read_b64_tr_b16 v[238:239], v249 offset:11616
    s_waitcnt lgkmcnt(10)
    v_mfma_f32_16x16x32_bf16 v[200:203], v[0:3], v[216:219], 0
    ds_read_b64_tr_b16 v[240:241], v249 offset:10368
    v_mfma_f32_16x16x32_bf16 v[204:207], v[4:7], v[216:219], 0
    ds_read_b64_tr_b16 v[242:243], v249 offset:11648
    s_waitcnt lgkmcnt(10)
    v_mfma_f32_16x16x32_bf16 v[208:211], v[0:3], v[220:223], 0
    ds_read_b64_tr_b16 v[216:217], v249 offset:10400
    v_mfma_f32_16x16x32_bf16 v[212:215], v[4:7], v[220:223], 0
    ds_read_b64_tr_b16 v[218:219], v249 offset:11680
    s_waitcnt lgkmcnt(10)
    v_mfma_f32_16x16x32_bf16 v[144:147], v[8:11], v[224:227], v[144:147]
    ds_read_b64_tr_b16 v[220:221], v249 offset:10432
    v_mfma_f32_16x16x32_bf16 v[148:151], v[12:15], v[224:227], v[148:151]
    ds_read_b64_tr_b16 v[222:223], v249 offset:11712
    s_waitcnt lgkmcnt(10)
    v_mfma_f32_16x16x32_bf16 v[152:155], v[8:11], v[228:231], v[152:155]
    ds_read_b64_tr_b16 v[224:225], v249 offset:10464
    v_mfma_f32_16x16x32_bf16 v[156:159], v[12:15], v[228:231], v[156:159]
    ds_read_b64_tr_b16 v[226:227], v249 offset:11744
    s_waitcnt lgkmcnt(10)
    v_mfma_f32_16x16x32_bf16 v[160:163], v[8:11], v[232:235], v[160:163]
    ds_read_b64_tr_b16 v[228:229], v249 offset:10496
    v_mfma_f32_16x16x32_bf16 v[164:167], v[12:15], v[232:235], v[164:167]
    ds_read_b64_tr_b16 v[230:231], v249 offset:11776
    s_add_u32 s32, s32, 20480
    s_cmp_ge_u32 s32, 81920
    s_cselect_b32 s32, 0, s32
    s_cmp_eq_u32 s98, 1
    s_cbranch_scc1 k1_kernel_nw00
    s_waitcnt vmcnt(6)
k1_kernel_nw00:
    s_barrier
    v_add_u32 v249, s32, v250
    s_waitcnt lgkmcnt(10)
    v_mfma_f32_16x16x32_bf16 v[168:171], v[8:11], v[236:239], v[168:171]
    ds_read_b64_tr_b16 v[232:233], v249 offset:0
    v_mfma_f32_16x16x32_bf16 v[172:175], v[12:15], v[236:239], v[172:175]
    ds_read_b64_tr_b16 v[234:235], v249 offset:1280
    s_waitcnt lgkmcnt(10)
    v_mfma_f32_16x16x32_bf16 v[176:179], v[8:11], v[240:243], v[176:179]
    ds_read_b64_tr_b16 v[236:237], v249 offset:32
    v_mfma_f32_16x16x32_bf16 v[180:183], v[12:15], v[240:243], v[180:183]
    ds_read_b64_tr_b16 v[238:239], v249 offset:1312
    s_waitcnt lgkmcnt(10)
    v_mfma_f32_16x16x32_bf16 v[184:187], v[8:11], v[216:219], v[184:187]
    ds_read_b64_tr_b16 v[240:241], v249 offset:64
    v_mfma_f32_16x16x32_bf16 v[188:191], v[12:15], v[216:219], v[188:191]
    ds_read_b64_tr_b16 v[242:243], v249 offset:1344
    s_waitcnt lgkmcnt(10)
    v_mfma_f32_16x16x32_bf16 v[192:195], v[8:11], v[220:223], v[192:195]
    ds_read_b64_tr_b16 v[216:217], v249 offset:96
    v_mfma_f32_16x16x32_bf16 v[196:199], v[12:15], v[220:223], v[196:199]
    ds_read_b64_tr_b16 v[218:219], v249 offset:1376
    s_waitcnt lgkmcnt(10)
    v_mfma_f32_16x16x32_bf16 v[200:203], v[8:11], v[224:227], v[200:203]
    ds_read_b64_tr_b16 v[220:221], v249 offset:128
    v_mfma_f32_16x16x32_bf16 v[204:207], v[12:15], v[224:227], v[204:207]
    ds_read_b64_tr_b16 v[222:223], v249 offset:1408
    s_waitcnt lgkmcnt(10)
    v_mfma_f32_16x16x32_bf16 v[208:211], v[8:11], v[228:231], v[208:211]
    ds_read_b64_tr_b16 v[224:225], v249 offset:160
    v_mfma_f32_16x16x32_bf16 v[212:215], v[12:15], v[228:231], v[212:215]
    ds_read_b64_tr_b16 v[226:227], v249 offset:1440
    s_waitcnt lgkmcnt(10)
    v_mfma_f32_16x16x32_bf16 v[144:147], v[16:19], v[232:235], v[144:147]
    ds_read_b64_tr_b16 v[228:229], v249 offset:192
    v_mfma_f32_16x16x32_bf16 v[148:151], v[20:23], v[232:235], v[148:151]
    ds_read_b64_tr_b16 v[230:231], v249 offset:1472
    s_waitcnt lgkmcnt(10)
    v_mfma_f32_16x16x32_bf16 v[152:155], v[16:19], v[236:239], v[152:155]
    ds_read_b64_tr_b16 v[232:233], v249 offset:224
    v_mfma_f32_16x16x32_bf16 v[156:159], v[20:23], v[236:239], v[156:159]
    ds_read_b64_tr_b16 v[234:235], v249 offset:1504
    s_waitcnt lgkmcnt(10)
    v_mfma_f32_16x16x32_bf16 v[160:163], v[16:19], v[240:243], v[160:163]
    ds_read_b64_tr_b16 v[236:237], v249 offset:256
    v_mfma_f32_16x16x32_bf16 v[164:167], v[20:23], v[240:243], v[164:167]
    ds_read_b64_tr_b16 v[238:239], v249 offset:1536
    s_waitcnt lgkmcnt(10)
    v_mfma_f32_16x16x32_bf16 v[168:171], v[16:19], v[216:219], v[168:171]
    ds_read_b64_tr_b16 v[240:241], v249 offset:10240
    v_mfma_f32_16x16x32_bf16 v[172:175], v[20:23], v[216:219], v[172:175]
    ds_read_b64_tr_b16 v[242:243], v249 offset:11520
    s_waitcnt lgkmcnt(10)
    v_mfma_f32_16x16x32_bf16 v[176:179], v[16:19], v[220:223], v[176:179]
    ds_read_b64_tr_b16 v[216:217], v249 offset:10272
    v_mfma_f32_16x16x32_bf16 v[180:183], v[20:23], v[220:223], v[180:183]
    ds_read_b64_tr_b16 v[218:219], v249 offset:11552
    s_waitcnt lgkmcnt(10)
    v_mfma_f32_16x16x32_bf16 v[184:187], v[16:19], v[224:227], v[184:187]
    ds_read_b64_tr_b16 v[220:221], v249 offset:10304
    v_mfma_f32_16x16x32_bf16 v[188:191], v[20:23], v[224:227], v[188:191]
    ds_read_b64_tr_b16 v[222:223], v249 offset:11584
    s_waitcnt lgkmcnt(10)
    v_mfma_f32_16x16x32_bf16 v[192:195], v[16:19], v[228:231], v[192:195]
    ds_read_b64_tr_b16 v[224:225], v249 offset:10336
    v_mfma_f32_16x16x32_bf16 v[196:199], v[20:23], v[228:231], v[196:199]
    ds_read_b64_tr_b16 v[226:227], v249 offset:11616
    s_waitcnt lgkmcnt(10)
    v_mfma_f32_16x16x32_bf16 v[200:203], v[16:19], v[232:235], v[200:203]
    ds_read_b64_tr_b16 v[228:229], v249 offset:10368
    v_mfma_f32_16x16x32_bf16 v[204:207], v[20:23], v[232:235], v[204:207]
    ds_read_b64_tr_b16 v[230:231], v249 offset:11648
    s_waitcnt lgkmcnt(10)
    v_mfma_f32_16x16x32_bf16 v[208:211], v[16:19], v[236:239], v[208:211]
    ds_read_b64_tr_b16 v[232:233], v249 offset:10400
    v_mfma_f32_16x16x32_bf16 v[212:215], v[20:23], v[236:239], v[212:215]
    ds_read_b64_tr_b16 v[234:235], v249 offset:11680
    s_waitcnt lgkmcnt(10)
    v_mfma_f32_16x16x32_bf16 v[144:147], v[24:27], v[240:243], v[144:147]
    ds_read_b64_tr_b16 v[236:237], v249 offset:10432
    v_mfma_f32_16x16x32_bf16 v[148:151], v[28:31], v[240:243], v[148:151]
    ds_read_b64_tr_b16 v[238:239], v249 offset:11712
    s_waitcnt lgkmcnt(10)
    v_mfma_f32_16x16x32_bf16 v[152:155], v[24:27], v[216:219], v[152:155]
    ds_read_b64_tr_b16 v[240:241], v249 offset:10464
    v_mfma_f32_16x16x32_bf16 v[156:159], v[28:31], v[216:219], v[156:159]
    ds_read_b64_tr_b16 v[242:243], v249 offset:11744
    s_waitcnt lgkmcnt(10)
    v_mfma_f32_16x16x32_bf16 v[160:163], v[24:27], v[220:223], v[160:163]
    ds_read_b64_tr_b16 v[216:217], v249 offset:10496
    v_mfma_f32_16x16x32_bf16 v[164:167], v[28:31], v[220:223], v[164:167]
    ds_read_b64_tr_b16 v[218:219], v249 offset:11776
    s_add_u32 s32, s32, 20480
    s_cmp_ge_u32 s32, 81920
    s_cselect_b32 s32, 0, s32
    s_cmp_eq_u32 s98, 1
    s_cbranch_scc1 k1_kernel_nw01
    s_waitcnt vmcnt(1)
k1_kernel_nw01:
    s_barrier
    v_add_u32 v249, s32, v250
    s_waitcnt lgkmcnt(10)
    v_mfma_f32_16x16x32_bf16 v[168:171], v[24:27], v[224:227], v[168:171]
    ds_read_b64_tr_b16 v[220:221], v249 offset:0
    v_mfma_f32_16x16x32_bf16 v[172:175], v[28:31], v[224:227], v[172:175]
    ds_read_b64_tr_b16 v[222:223], v249 offset:1280
    s_waitcnt lgkmcnt(10)
    v_mfma_f32_16x16x32_bf16 v[176:179], v[24:27], v[228:231], v[176:179]
    ds_read_b64_tr_b16 v[224:225], v249 offset:32
    v_mfma_f32_16x16x32_bf16 v[180:183], v[28:31], v[228:231], v[180:183]
    ds_read_b64_tr_b16 v[226:227], v249 offset:1312
    s_waitcnt lgkmcnt(10)
    v_mfma_f32_16x16x32_bf16 v[184:187], v[24:27], v[232:235], v[184:187]
    ds_read_b64_tr_b16 v[228:229], v249 offset:64
    v_mfma_f32_16x16x32_bf16 v[188:191], v[28:31], v[232:235], v[188:191]
    ds_read_b64_tr_b16 v[230:231], v249 offset:1344
    s_waitcnt lgkmcnt(10)
    v_mfma_f32_16x16x32_bf16 v[192:195], v[24:27], v[236:239], v[192:195]
    ds_read_b64_tr_b16 v[232:233], v249 offset:96
    v_mfma_f32_16x16x32_bf16 v[196:199], v[28:31], v[236:239], v[196:199]
    ds_read_b64_tr_b16 v[234:235], v249 offset:1376
    s_waitcnt lgkmcnt(10)
    v_mfma_f32_16x16x32_bf16 v[200:203], v[24:27], v[240:243], v[200:203]
    ds_read_b64_tr_b16 v[236:237], v249 offset:128
    v_mfma_f32_16x16x32_bf16 v[204:207], v[28:31], v[240:243], v[204:207]
    ds_read_b64_tr_b16 v[238:239], v249 offset:1408
    s_waitcnt lgkmcnt(10)
    v_mfma_f32_16x16x32_bf16 v[208:211], v[24:27], v[216:219], v[208:211]
    ds_read_b64_tr_b16 v[240:241], v249 offset:160
    v_mfma_f32_16x16x32_bf16 v[212:215], v[28:31], v[216:219], v[212:215]
    ds_read_b64_tr_b16 v[242:243], v249 offset:1440
    s_waitcnt lgkmcnt(10)
    v_mfma_f32_16x16x32_bf16 v[144:147], v[32:35], v[220:223], v[144:147]
    ds_read_b64_tr_b16 v[216:217], v249 offset:192
    v_mfma_f32_16x16x32_bf16 v[148:151], v[36:39], v[220:223], v[148:151]
    ds_read_b64_tr_b16 v[218:219], v249 offset:1472
    s_waitcnt lgkmcnt(10)
    v_mfma_f32_16x16x32_bf16 v[152:155], v[32:35], v[224:227], v[152:155]
    ds_read_b64_tr_b16 v[220:221], v249 offset:224
    v_mfma_f32_16x16x32_bf16 v[156:159], v[36:39], v[224:227], v[156:159]
    ds_read_b64_tr_b16 v[222:223], v249 offset:1504
    s_waitcnt lgkmcnt(10)
    v_mfma_f32_16x16x32_bf16 v[160:163], v[32:35], v[228:231], v[160:163]
    ds_read_b64_tr_b16 v[224:225], v249 offset:256
    v_mfma_f32_16x16x32_bf16 v[164:167], v[36:39], v[228:231], v[164:167]
    ds_read_b64_tr_b16 v[226:227], v249 offset:1536
    s_waitcnt lgkmcnt(10)
    v_mfma_f32_16x16x32_bf16 v[168:171], v[32:35], v[232:235], v[168:171]
    ds_read_b64_tr_b16 v[228:229], v249 offset:10240
    v_mfma_f32_16x16x32_bf16 v[172:175], v[36:39], v[232:235], v[172:175]
    ds_read_b64_tr_b16 v[230:231], v249 offset:11520
    s_waitcnt lgkmcnt(10)
    v_mfma_f32_16x16x32_bf16 v[176:179], v[32:35], v[236:239], v[176:179]
    ds_read_b64_tr_b16 v[232:233], v249 offset:10272
    v_mfma_f32_16x16x32_bf16 v[180:183], v[36:39], v[236:239], v[180:183]
    ds_read_b64_tr_b16 v[234:235], v249 offset:11552
    s_waitcnt lgkmcnt(10)
    v_mfma_f32_16x16x32_bf16 v[184:187], v[32:35], v[240:243], v[184:187]
    ds_read_b64_tr_b16 v[236:237], v249 offset:10304
    v_mfma_f32_16x16x32_bf16 v[188:191], v[36:39], v[240:243], v[188:191]
    ds_read_b64_tr_b16 v[238:239], v249 offset:11584
    s_waitcnt lgkmcnt(10)
    v_mfma_f32_16x16x32_bf16 v[192:195], v[32:35], v[216:219], v[192:195]
    ds_read_b64_tr_b16 v[240:241], v249 offset:10336
    v_mfma_f32_16x16x32_bf16 v[196:199], v[36:39], v[216:219], v[196:199]
    ds_read_b64_tr_b16 v[242:243], v249 offset:11616
    s_waitcnt lgkmcnt(10)
    v_mfma_f32_16x16x32_bf16 v[200:203], v[32:35], v[220:223], v[200:203]
    ds_read_b64_tr_b16 v[216:217], v249 offset:10368
    v_mfma_f32_16x16x32_bf16 v[204:207], v[36:39], v[220:223], v[204:207]
    ds_read_b64_tr_b16 v[218:219], v249 offset:11648
    s_waitcnt lgkmcnt(10)
    v_mfma_f32_16x16x32_bf16 v[208:211], v[32:35], v[224:227], v[208:211]
    ds_read_b64_tr_b16 v[220:221], v249 offset:10400
    v_mfma_f32_16x16x32_bf16 v[212:215], v[36:39], v[224:227], v[212:215]
    ds_read_b64_tr_b16 v[222:223], v249 offset:11680
    s_waitcnt lgkmcnt(10)
    v_mfma_f32_16x16x32_bf16 v[144:147], v[40:43], v[228:231], v[144:147]
    ds_read_b64_tr_b16 v[224:225], v249 offset:10432
    v_mfma_f32_16x16x32_bf16 v[148:151], v[44:47], v[228:231], v[148:151]
    ds_read_b64_tr_b16 v[226:227], v249 offset:11712
    s_waitcnt lgkmcnt(10)
    v_mfma_f32_16x16x32_bf16 v[152:155], v[40:43], v[232:235], v[152:155]
    ds_read_b64_tr_b16 v[228:229], v249 offset:10464
    v_mfma_f32_16x16x32_bf16 v[156:159], v[44:47], v[232:235], v[156:159]
    ds_read_b64_tr_b16 v[230:231], v249 offset:11744
    s_waitcnt lgkmcnt(10)
    v_mfma_f32_16x16x32_bf16 v[160:163], v[40:43], v[236:239], v[160:163]
    ds_read_b64_tr_b16 v[232:233], v249 offset:10496
    v_mfma_f32_16x16x32_bf16 v[164:167], v[44:47], v[236:239], v[164:167]
    ds_read_b64_tr_b16 v[234:235], v249 offset:11776
    s_add_u32 s32, s32, 20480
    s_cmp_ge_u32 s32, 81920
    s_cselect_b32 s32, 0, s32
    s_barrier
    v_add_u32 v249, s32, v250
    s_waitcnt lgkmcnt(10)
    v_mfma_f32_16x16x32_bf16 v[168:171], v[40:43], v[240:243], v[168:171]
    ds_read_b64_tr_b16 v[236:237], v249 offset:0
    v_mfma_f32_16x16x32_bf16 v[172:175], v[44:47], v[240:243], v[172:175]
    ds_read_b64_tr_b16 v[238:239], v249 offset:1280
    s_waitcnt lgkmcnt(10)
    v_mfma_f32_16x16x32_bf16 v[176:179], v[40:43], v[216:219], v[176:179]
    ds_read_b64_tr_b16 v[240:241], v249 offset:32
    v_mfma_f32_16x16x32_bf16 v[180:183], v[44:47], v[216:219], v[180:183]
    ds_read_b64_tr_b16 v[242:243], v249 offset:1312
    s_waitcnt lgkmcnt(10)
    v_mfma_f32_16x16x32_bf16 v[184:187], v[40:43], v[220:223], v[184:187]
    ds_read_b64_tr_b16 v[216:217], v249 offset:64
    v_mfma_f32_16x16x32_bf16 v[188:191], v[44:47], v[220:223], v[188:191]
    ds_read_b64_tr_b16 v[218:219], v249 offset:1344
    s_waitcnt lgkmcnt(10)
    v_mfma_f32_16x16x32_bf16 v[192:195], v[40:43], v[224:227], v[192:195]
    ds_read_b64_tr_b16 v[220:221], v249 offset:96
    v_mfma_f32_16x16x32_bf16 v[196:199], v[44:47], v[224:227], v[196:199]
    ds_read_b64_tr_b16 v[222:223], v249 offset:1376
    s_waitcnt lgkmcnt(10)
    v_mfma_f32_16x16x32_bf16 v[200:203], v[40:43], v[228:231], v[200:203]
    ds_read_b64_tr_b16 v[224:225], v249 offset:128
    v_mfma_f32_16x16x32_bf16 v[204:207], v[44:47], v[228:231], v[204:207]
    ds_read_b64_tr_b16 v[226:227], v249 offset:1408
    s_waitcnt lgkmcnt(10)
    v_mfma_f32_16x16x32_bf16 v[208:211], v[40:43], v[232:235], v[208:211]
    ds_read_b64_tr_b16 v[228:229], v249 offset:160
    v_mfma_f32_16x16x32_bf16 v[212:215], v[44:47], v[232:235], v[212:215]
    ds_read_b64_tr_b16 v[230:231], v249 offset:1440
    s_waitcnt lgkmcnt(10)
    v_mfma_f32_16x16x32_bf16 v[144:147], v[48:51], v[236:239], v[144:147]
    ds_read_b64_tr_b16 v[232:233], v249 offset:192
    v_mfma_f32_16x16x32_bf16 v[148:151], v[52:55], v[236:239], v[148:151]
    ds_read_b64_tr_b16 v[234:235], v249 offset:1472
    s_waitcnt lgkmcnt(10)
    v_mfma_f32_16x16x32_bf16 v[152:155], v[48:51], v[240:243], v[152:155]
    ds_read_b64_tr_b16 v[236:237], v249 offset:224
    v_mfma_f32_16x16x32_bf16 v[156:159], v[52:55], v[240:243], v[156:159]
    ds_read_b64_tr_b16 v[238:239], v249 offset:1504
    s_waitcnt lgkmcnt(10)
    v_mfma_f32_16x16x32_bf16 v[160:163], v[48:51], v[216:219], v[160:163]
    ds_read_b64_tr_b16 v[240:241], v249 offset:256
    v_mfma_f32_16x16x32_bf16 v[164:167], v[52:55], v[216:219], v[164:167]
    ds_read_b64_tr_b16 v[242:243], v249 offset:1536
    s_waitcnt lgkmcnt(10)
    v_mfma_f32_16x16x32_bf16 v[168:171], v[48:51], v[220:223], v[168:171]
    ds_read_b64_tr_b16 v[216:217], v249 offset:10240
    v_mfma_f32_16x16x32_bf16 v[172:175], v[52:55], v[220:223], v[172:175]
    ds_read_b64_tr_b16 v[218:219], v249 offset:11520
    s_waitcnt lgkmcnt(10)
    v_mfma_f32_16x16x32_bf16 v[176:179], v[48:51], v[224:227], v[176:179]
    ds_read_b64_tr_b16 v[220:221], v249 offset:10272
    v_mfma_f32_16x16x32_bf16 v[180:183], v[52:55], v[224:227], v[180:183]
    ds_read_b64_tr_b16 v[222:223], v249 offset:11552
    s_waitcnt lgkmcnt(10)
    v_mfma_f32_16x16x32_bf16 v[184:187], v[48:51], v[228:231], v[184:187]
    ds_read_b64_tr_b16 v[224:225], v249 offset:10304
    v_mfma_f32_16x16x32_bf16 v[188:191], v[52:55], v[228:231], v[188:191]
    ds_read_b64_tr_b16 v[226:227], v249 offset:11584
    s_waitcnt lgkmcnt(10)
    v_mfma_f32_16x16x32_bf16 v[192:195], v[48:51], v[232:235], v[192:195]
    ds_read_b64_tr_b16 v[228:229], v249 offset:10336
    v_mfma_f32_16x16x32_bf16 v[196:199], v[52:55], v[232:235], v[196:199]
    ds_read_b64_tr_b16 v[230:231], v249 offset:11616
    s_waitcnt lgkmcnt(10)
    v_mfma_f32_16x16x32_bf16 v[200:203], v[48:51], v[236:239], v[200:203]
    ds_read_b64_tr_b16 v[232:233], v249 offset:10368
    v_mfma_f32_16x16x32_bf16 v[204:207], v[52:55], v[236:239], v[204:207]
    ds_read_b64_tr_b16 v[234:235], v249 offset:11648
    s_waitcnt lgkmcnt(10)
    v_mfma_f32_16x16x32_bf16 v[208:211], v[48:51], v[240:243], v[208:211]
    ds_read_b64_tr_b16 v[236:237], v249 offset:10400
    v_mfma_f32_16x16x32_bf16 v[212:215], v[52:55], v[240:243], v[212:215]
    ds_read_b64_tr_b16 v[238:239], v249 offset:11680
    s_waitcnt lgkmcnt(10)
    v_mfma_f32_16x16x32_bf16 v[144:147], v[56:59], v[216:219], v[144:147]
    ds_read_b64_tr_b16 v[240:241], v249 offset:10432
    v_mfma_f32_16x16x32_bf16 v[148:151], v[60:63], v[216:219], v[148:151]
    ds_read_b64_tr_b16 v[242:243], v249 offset:11712
    s_waitcnt lgkmcnt(10)
    v_mfma_f32_16x16x32_bf16 v[152:155], v[56:59], v[220:223], v[152:155]
    ds_read_b64_tr_b16 v[216:217], v249 offset:10464
    v_mfma_f32_16x16x32_bf16 v[156:159], v[60:63], v[220:223], v[156:159]
    ds_read_b64_tr_b16 v[218:219], v249 offset:11744
    s_waitcnt lgkmcnt(10)
    v_mfma_f32_16x16x32_bf16 v[160:163], v[56:59], v[224:227], v[160:163]
    ds_read_b64_tr_b16 v[220:221], v249 offset:10496
    v_mfma_f32_16x16x32_bf16 v[164:167], v[60:63], v[224:227], v[164:167]
    ds_read_b64_tr_b16 v[222:223], v249 offset:11776
    s_add_u32 s32, s32, 20480
    s_cmp_ge_u32 s32, 81920
    s_cselect_b32 s32, 0, s32
    s_barrier
    v_add_u32 v249, s32, v250
    s_waitcnt lgkmcnt(10)
    v_mfma_f32_16x16x32_bf16 v[168:171], v[56:59], v[228:231], v[168:171]
    ds_read_b64_tr_b16 v[224:225], v249 offset:0
    v_mfma_f32_16x16x32_bf16 v[172:175], v[60:63], v[228:231], v[172:175]
    ds_read_b64_tr_b16 v[226:227], v249 offset:1280
    s_waitcnt lgkmcnt(10)
    v_mfma_f32_16x16x32_bf16 v[176:179], v[56:59], v[232:235], v[176:179]
    ds_read_b64_tr_b16 v[228:229], v249 offset:32
    v_mfma_f32_16x16x32_bf16 v[180:183], v[60:63], v[232:235], v[180:183]
    ds_read_b64_tr_b16 v[230:231], v249 offset:1312
    s_waitcnt lgkmcnt(10)
    v_mfma_f32_16x16x32_bf16 v[184:187], v[56:59], v[236:239], v[184:187]
    ds_read_b64_tr_b16 v[232:233], v249 offset:64
    v_mfma_f32_16x16x32_bf16 v[188:191], v[60:63], v[236:239], v[188:191]
    ds_read_b64_tr_b16 v[234:235], v249 offset:1344
    s_waitcnt lgkmcnt(10)
    v_mfma_f32_16x16x32_bf16 v[192:195], v[56:59], v[240:243], v[192:195]
    ds_read_b64_tr_b16 v[236:237], v249 offset:96
    v_mfma_f32_16x16x32_bf16 v[196:199], v[60:63], v[240:243], v[196:199]
    ds_read_b64_tr_b16 v[238:239], v249 offset:1376
    s_waitcnt lgkmcnt(10)
    v_mfma_f32_16x16x32_bf16 v[200:203], v[56:59], v[216:219], v[200:203]
    ds_read_b64_tr_b16 v[240:241], v249 offset:128
    v_mfma_f32_16x16x32_bf16 v[204:207], v[60:63], v[216:219], v[204:207]
    ds_read_b64_tr_b16 v[242:243], v249 offset:1408
    s_waitcnt lgkmcnt(10)
    v_mfma_f32_16x16x32_bf16 v[208:211], v[56:59], v[220:223], v[208:211]
    ds_read_b64_tr_b16 v[216:217], v249 offset:160
    v_mfma_f32_16x16x32_bf16 v[212:215], v[60:63], v[220:223], v[212:215]
    ds_read_b64_tr_b16 v[218:219], v249 offset:1440
    s_waitcnt lgkmcnt(10)
    v_mfma_f32_16x16x32_bf16 v[144:147], v[64:67], v[224:227], v[144:147]
    ds_read_b64_tr_b16 v[220:221], v249 offset:192
    v_mfma_f32_16x16x32_bf16 v[148:151], v[68:71], v[224:227], v[148:151]
    ds_read_b64_tr_b16 v[222:223], v249 offset:1472
    s_waitcnt lgkmcnt(10)
    v_mfma_f32_16x16x32_bf16 v[152:155], v[64:67], v[228:231], v[152:155]
    ds_read_b64_tr_b16 v[224:225], v249 offset:224
    v_mfma_f32_16x16x32_bf16 v[156:159], v[68:71], v[228:231], v[156:159]
    ds_read_b64_tr_b16 v[226:227], v249 offset:1504
    s_waitcnt lgkmcnt(10)
    v_mfma_f32_16x16x32_bf16 v[160:163], v[64:67], v[232:235], v[160:163]
    ds_read_b64_tr_b16 v[228:229], v249 offset:256
    v_mfma_f32_16x16x32_bf16 v[164:167], v[68:71], v[232:235], v[164:167]
    ds_read_b64_tr_b16 v[230:231], v249 offset:1536
    s_waitcnt lgkmcnt(10)
    v_mfma_f32_16x16x32_bf16 v[168:171], v[64:67], v[236:239], v[168:171]
    ds_read_b64_tr_b16 v[232:233], v249 offset:10240
    v_mfma_f32_16x16x32_bf16 v[172:175], v[68:71], v[236:239], v[172:175]
    ds_read_b64_tr_b16 v[234:235], v249 offset:11520
    s_waitcnt lgkmcnt(10)
    v_mfma_f32_16x16x32_bf16 v[176:179], v[64:67], v[240:243], v[176:179]
    ds_read_b64_tr_b16 v[236:237], v249 offset:10272
    v_mfma_f32_16x16x32_bf16 v[180:183], v[68:71], v[240:243], v[180:183]
    ds_read_b64_tr_b16 v[238:239], v249 offset:11552
    s_waitcnt lgkmcnt(10)
    v_mfma_f32_16x16x32_bf16 v[184:187], v[64:67], v[216:219], v[184:187]
    ds_read_b64_tr_b16 v[240:241], v249 offset:10304
    v_mfma_f32_16x16x32_bf16 v[188:191], v[68:71], v[216:219], v[188:191]
    ds_read_b64_tr_b16 v[242:243], v249 offset:11584
    s_waitcnt lgkmcnt(10)
    v_mfma_f32_16x16x32_bf16 v[192:195], v[64:67], v[220:223], v[192:195]
    ds_read_b64_tr_b16 v[216:217], v249 offset:10336
    v_mfma_f32_16x16x32_bf16 v[196:199], v[68:71], v[220:223], v[196:199]
    ds_read_b64_tr_b16 v[218:219], v249 offset:11616
    s_waitcnt lgkmcnt(10)
    v_mfma_f32_16x16x32_bf16 v[200:203], v[64:67], v[224:227], v[200:203]
    ds_read_b64_tr_b16 v[220:221], v249 offset:10368
    v_mfma_f32_16x16x32_bf16 v[204:207], v[68:71], v[224:227], v[204:207]
    ds_read_b64_tr_b16 v[222:223], v249 offset:11648
    s_waitcnt lgkmcnt(10)
    v_mfma_f32_16x16x32_bf16 v[208:211], v[64:67], v[228:231], v[208:211]
    ds_read_b64_tr_b16 v[224:225], v249 offset:10400
    v_mfma_f32_16x16x32_bf16 v[212:215], v[68:71], v[228:231], v[212:215]
    ds_read_b64_tr_b16 v[226:227], v249 offset:11680
    s_waitcnt lgkmcnt(10)
    v_mfma_f32_16x16x32_bf16 v[144:147], v[72:75], v[232:235], v[144:147]
    ds_read_b64_tr_b16 v[228:229], v249 offset:10432
    v_mfma_f32_16x16x32_bf16 v[148:151], v[76:79], v[232:235], v[148:151]
    ds_read_b64_tr_b16 v[230:231], v249 offset:11712
    s_waitcnt lgkmcnt(10)
    v_mfma_f32_16x16x32_bf16 v[152:155], v[72:75], v[236:239], v[152:155]
    ds_read_b64_tr_b16 v[232:233], v249 offset:10464
    v_mfma_f32_16x16x32_bf16 v[156:159], v[76:79], v[236:239], v[156:159]
    ds_read_b64_tr_b16 v[234:235], v249 offset:11744
    s_waitcnt lgkmcnt(10)
    v_mfma_f32_16x16x32_bf16 v[160:163], v[72:75], v[240:243], v[160:163]
    ds_read_b64_tr_b16 v[236:237], v249 offset:10496
    v_mfma_f32_16x16x32_bf16 v[164:167], v[76:79], v[240:243], v[164:167]
    ds_read_b64_tr_b16 v[238:239], v249 offset:11776
    s_add_u32 s32, s32, 20480
    s_cmp_ge_u32 s32, 81920
    s_cselect_b32 s32, 0, s32
    s_barrier
    v_add_u32 v249, s32, v250
    s_waitcnt lgkmcnt(10)
    v_mfma_f32_16x16x32_bf16 v[168:171], v[72:75], v[216:219], v[168:171]
    ds_read_b64_tr_b16 v[240:241], v249 offset:0
    v_mfma_f32_16x16x32_bf16 v[172:175], v[76:79], v[216:219], v[172:175]
    ds_read_b64_tr_b16 v[242:243], v249 offset:1280
    s_waitcnt lgkmcnt(10)
    v_mfma_f32_16x16x32_bf16 v[176:179], v[72:75], v[220:223], v[176:179]
    ds_read_b64_tr_b16 v[216:217], v249 offset:32
    v_mfma_f32_16x16x32_bf16 v[180:183], v[76:79], v[220:223], v[180:183]
    ds_read_b64_tr_b16 v[218:219], v249 offset:1312
    s_waitcnt lgkmcnt(10)
    v_mfma_f32_16x16x32_bf16 v[184:187], v[72:75], v[224:227], v[184:187]
    ds_read_b64_tr_b16 v[220:221], v249 offset:64
    v_mfma_f32_16x16x32_bf16 v[188:191], v[76:79], v[224:227], v[188:191]
    ds_read_b64_tr_b16 v[222:223], v249 offset:1344
    s_waitcnt lgkmcnt(10)
    v_mfma_f32_16x16x32_bf16 v[192:195], v[72:75], v[228:231], v[192:195]
    ds_read_b64_tr_b16 v[224:225], v249 offset:96
    v_mfma_f32_16x16x32_bf16 v[196:199], v[76:79], v[228:231], v[196:199]
    ds_read_b64_tr_b16 v[226:227], v249 offset:1376
    s_waitcnt lgkmcnt(10)
    v_mfma_f32_16x16x32_bf16 v[200:203], v[72:75], v[232:235], v[200:203]
    ds_read_b64_tr_b16 v[228:229], v249 offset:128
    v_mfma_f32_16x16x32_bf16 v[204:207], v[76:79], v[232:235], v[204:207]
    ds_read_b64_tr_b16 v[230:231], v249 offset:1408
    s_waitcnt lgkmcnt(10)
    v_mfma_f32_16x16x32_bf16 v[208:211], v[72:75], v[236:239], v[208:211]
    ds_read_b64_tr_b16 v[232:233], v249 offset:160
    v_mfma_f32_16x16x32_bf16 v[212:215], v[76:79], v[236:239], v[212:215]
    ds_read_b64_tr_b16 v[234:235], v249 offset:1440
    s_waitcnt lgkmcnt(10)
    v_mfma_f32_16x16x32_bf16 v[144:147], v[80:83], v[240:243], v[144:147]
    ds_read_b64_tr_b16 v[236:237], v249 offset:192
    v_mfma_f32_16x16x32_bf16 v[148:151], v[84:87], v[240:243], v[148:151]
    ds_read_b64_tr_b16 v[238:239], v249 offset:1472
    s_waitcnt lgkmcnt(10)
    v_mfma_f32_16x16x32_bf16 v[152:155], v[80:83], v[216:219], v[152:155]
    ds_read_b64_tr_b16 v[240:241], v249 offset:224
    v_mfma_f32_16x16x32_bf16 v[156:159], v[84:87], v[216:219], v[156:159]
    ds_read_b64_tr_b16 v[242:243], v249 offset:1504
    s_waitcnt lgkmcnt(10)
    v_mfma_f32_16x16x32_bf16 v[160:163], v[80:83], v[220:223], v[160:163]
    ds_read_b64_tr_b16 v[216:217], v249 offset:256
    v_mfma_f32_16x16x32_bf16 v[164:167], v[84:87], v[220:223], v[164:167]
    ds_read_b64_tr_b16 v[218:219], v249 offset:1536
    s_waitcnt lgkmcnt(10)
    v_mfma_f32_16x16x32_bf16 v[168:171], v[80:83], v[224:227], v[168:171]
    ds_read_b64_tr_b16 v[220:221], v249 offset:10240
    v_mfma_f32_16x16x32_bf16 v[172:175], v[84:87], v[224:227], v[172:175]
    ds_read_b64_tr_b16 v[222:223], v249 offset:11520
    s_waitcnt lgkmcnt(10)
    v_mfma_f32_16x16x32_bf16 v[176:179], v[80:83], v[228:231], v[176:179]
    ds_read_b64_tr_b16 v[224:225], v249 offset:10272
    v_mfma_f32_16x16x32_bf16 v[180:183], v[84:87], v[228:231], v[180:183]
    ds_read_b64_tr_b16 v[226:227], v249 offset:11552
    s_waitcnt lgkmcnt(10)
    v_mfma_f32_16x16x32_bf16 v[184:187], v[80:83], v[232:235], v[184:187]
    ds_read_b64_tr_b16 v[228:229], v249 offset:10304
    v_mfma_f32_16x16x32_bf16 v[188:191], v[84:87], v[232:235], v[188:191]
    ds_read_b64_tr_b16 v[230:231], v249 offset:11584
    s_waitcnt lgkmcnt(10)
    v_mfma_f32_16x16x32_bf16 v[192:195], v[80:83], v[236:239], v[192:195]
    ds_read_b64_tr_b16 v[232:233], v249 offset:10336
    v_mfma_f32_16x16x32_bf16 v[196:199], v[84:87], v[236:239], v[196:199]
    ds_read_b64_tr_b16 v[234:235], v249 offset:11616
    s_waitcnt lgkmcnt(10)
    v_mfma_f32_16x16x32_bf16 v[200:203], v[80:83], v[240:243], v[200:203]
    ds_read_b64_tr_b16 v[236:237], v249 offset:10368
    v_mfma_f32_16x16x32_bf16 v[204:207], v[84:87], v[240:243], v[204:207]
    ds_read_b64_tr_b16 v[238:239], v249 offset:11648
    s_waitcnt lgkmcnt(10)
    v_mfma_f32_16x16x32_bf16 v[208:211], v[80:83], v[216:219], v[208:211]
    ds_read_b64_tr_b16 v[240:241], v249 offset:10400
    v_mfma_f32_16x16x32_bf16 v[212:215], v[84:87], v[216:219], v[212:215]
    ds_read_b64_tr_b16 v[242:243], v249 offset:11680
    s_waitcnt lgkmcnt(10)
    v_mfma_f32_16x16x32_bf16 v[144:147], v[88:91], v[220:223], v[144:147]
    ds_read_b64_tr_b16 v[216:217], v249 offset:10432
    v_mfma_f32_16x16x32_bf16 v[148:151], v[92:95], v[220:223], v[148:151]
    ds_read_b64_tr_b16 v[218:219], v249 offset:11712
    s_waitcnt lgkmcnt(10)
    v_mfma_f32_16x16x32_bf16 v[152:155], v[88:91], v[224:227], v[152:155]
    ds_read_b64_tr_b16 v[220:221], v249 offset:10464
    v_mfma_f32_16x16x32_bf16 v[156:159], v[92:95], v[224:227], v[156:159]
    ds_read_b64_tr_b16 v[222:223], v249 offset:11744
    s_waitcnt lgkmcnt(10)
    v_mfma_f32_16x16x32_bf16 v[160:163], v[88:91], v[228:231], v[160:163]
    ds_read_b64_tr_b16 v[224:225], v249 offset:10496
    v_mfma_f32_16x16x32_bf16 v[164:167], v[92:95], v[228:231], v[164:167]
    ds_read_b64_tr_b16 v[226:227], v249 offset:11776
    s_add_u32 s32, s32, 20480
    s_cmp_ge_u32 s32, 81920
    s_cselect_b32 s32, 0, s32
    s_barrier
    v_add_u32 v249, s32, v250
    s_waitcnt lgkmcnt(10)
    v_mfma_f32_16x16x32_bf16 v[168:171], v[88:91], v[232:235], v[168:171]
    ds_read_b64_tr_b16 v[228:229], v249 offset:0
    v_mfma_f32_16x16x32_bf16 v[172:175], v[92:95], v[232:235], v[172:175]
    ds_read_b64_tr_b16 v[230:231], v249 offset:1280
    s_waitcnt lgkmcnt(10)
    v_mfma_f32_16x16x32_bf16 v[176:179], v[88:91], v[236:239], v[176:179]
    ds_read_b64_tr_b16 v[232:233], v249 offset:32
    v_mfma_f32_16x16x32_bf16 v[180:183], v[92:95], v[236:239], v[180:183]
    ds_read_b64_tr_b16 v[234:235], v249 offset:1312
    s_waitcnt lgkmcnt(10)
    v_mfma_f32_16x16x32_bf16 v[184:187], v[88:91], v[240:243], v[184:187]
    ds_read_b64_tr_b16 v[236:237], v249 offset:64
    v_mfma_f32_16x16x32_bf16 v[188:191], v[92:95], v[240:243], v[188:191]
    ds_read_b64_tr_b16 v[238:239], v249 offset:1344
    s_waitcnt lgkmcnt(10)
    v_mfma_f32_16x16x32_bf16 v[192:195], v[88:91], v[216:219], v[192:195]
    ds_read_b64_tr_b16 v[240:241], v249 offset:96
    v_mfma_f32_16x16x32_bf16 v[196:199], v[92:95], v[216:219], v[196:199]
    ds_read_b64_tr_b16 v[242:243], v249 offset:1376
    s_waitcnt lgkmcnt(10)
    v_mfma_f32_16x16x32_bf16 v[200:203], v[88:91], v[220:223], v[200:203]
    ds_read_b64_tr_b16 v[216:217], v249 offset:128
    v_mfma_f32_16x16x32_bf16 v[204:207], v[92:95], v[220:223], v[204:207]
    ds_read_b64_tr_b16 v[218:219], v249 offset:1408
    s_waitcnt lgkmcnt(10)
    v_mfma_f32_16x16x32_bf16 v[208:211], v[88:91], v[224:227], v[208:211]
    ds_read_b64_tr_b16 v[220:221], v249 offset:160
    v_mfma_f32_16x16x32_bf16 v[212:215], v[92:95], v[224:227], v[212:215]
    ds_read_b64_tr_b16 v[222:223], v249 offset:1440
    s_waitcnt lgkmcnt(10)
    v_mfma_f32_16x16x32_bf16 v[144:147], v[96:99], v[228:231], v[144:147]
    ds_read_b64_tr_b16 v[224:225], v249 offset:192
    v_mfma_f32_16x16x32_bf16 v[148:151], v[100:103], v[228:231], v[148:151]
    ds_read_b64_tr_b16 v[226:227], v249 offset:1472
    s_waitcnt lgkmcnt(10)
    v_mfma_f32_16x16x32_bf16 v[152:155], v[96:99], v[232:235], v[152:155]
    ds_read_b64_tr_b16 v[228:229], v249 offset:224
    v_mfma_f32_16x16x32_bf16 v[156:159], v[100:103], v[232:235], v[156:159]
    ds_read_b64_tr_b16 v[230:231], v249 offset:1504
    s_waitcnt lgkmcnt(10)
    v_mfma_f32_16x16x32_bf16 v[160:163], v[96:99], v[236:239], v[160:163]
    ds_read_b64_tr_b16 v[232:233], v249 offset:256
    v_mfma_f32_16x16x32_bf16 v[164:167], v[100:103], v[236:239], v[164:167]
    ds_read_b64_tr_b16 v[234:235], v249 offset:1536
    s_waitcnt lgkmcnt(10)
    v_mfma_f32_16x16x32_bf16 v[168:171], v[96:99], v[240:243], v[168:171]
    ds_read_b64_tr_b16 v[236:237], v249 offset:10240
    v_mfma_f32_16x16x32_bf16 v[172:175], v[100:103], v[240:243], v[172:175]
    ds_read_b64_tr_b16 v[238:239], v249 offset:11520
    s_waitcnt lgkmcnt(10)
    v_mfma_f32_16x16x32_bf16 v[176:179], v[96:99], v[216:219], v[176:179]
    ds_read_b64_tr_b16 v[240:241], v249 offset:10272
    v_mfma_f32_16x16x32_bf16 v[180:183], v[100:103], v[216:219], v[180:183]
    ds_read_b64_tr_b16 v[242:243], v249 offset:11552
    s_waitcnt lgkmcnt(10)
    v_mfma_f32_16x16x32_bf16 v[184:187], v[96:99], v[220:223], v[184:187]
    ds_read_b64_tr_b16 v[216:217], v249 offset:10304
    v_mfma_f32_16x16x32_bf16 v[188:191], v[100:103], v[220:223], v[188:191]
    ds_read_b64_tr_b16 v[218:219], v249 offset:11584
    s_waitcnt lgkmcnt(10)
    v_mfma_f32_16x16x32_bf16 v[192:195], v[96:99], v[224:227], v[192:195]
    ds_read_b64_tr_b16 v[220:221], v249 offset:10336
    v_mfma_f32_16x16x32_bf16 v[196:199], v[100:103], v[224:227], v[196:199]
    ds_read_b64_tr_b16 v[222:223], v249 offset:11616
    s_waitcnt lgkmcnt(10)
    v_mfma_f32_16x16x32_bf16 v[200:203], v[96:99], v[228:231], v[200:203]
    ds_read_b64_tr_b16 v[224:225], v249 offset:10368
    v_mfma_f32_16x16x32_bf16 v[204:207], v[100:103], v[228:231], v[204:207]
    ds_read_b64_tr_b16 v[226:227], v249 offset:11648
    s_waitcnt lgkmcnt(10)
    v_mfma_f32_16x16x32_bf16 v[208:211], v[96:99], v[232:235], v[208:211]
    ds_read_b64_tr_b16 v[228:229], v249 offset:10400
    v_mfma_f32_16x16x32_bf16 v[212:215], v[100:103], v[232:235], v[212:215]
    ds_read_b64_tr_b16 v[230:231], v249 offset:11680
    s_waitcnt lgkmcnt(10)
    v_mfma_f32_16x16x32_bf16 v[144:147], v[104:107], v[236:239], v[144:147]
    ds_read_b64_tr_b16 v[232:233], v249 offset:10432
    v_mfma_f32_16x16x32_bf16 v[148:151], v[108:111], v[236:239], v[148:151]
    ds_read_b64_tr_b16 v[234:235], v249 offset:11712
    s_waitcnt lgkmcnt(10)
    v_mfma_f32_16x16x32_bf16 v[152:155], v[104:107], v[240:243], v[152:155]
    ds_read_b64_tr_b16 v[236:237], v249 offset:10464
    v_mfma_f32_16x16x32_bf16 v[156:159], v[108:111], v[240:243], v[156:159]
    ds_read_b64_tr_b16 v[238:239], v249 offset:11744
    s_waitcnt lgkmcnt(10)
    v_mfma_f32_16x16x32_bf16 v[160:163], v[104:107], v[216:219], v[160:163]
    ds_read_b64_tr_b16 v[240:241], v249 offset:10496
    v_mfma_f32_16x16x32_bf16 v[164:167], v[108:111], v[216:219], v[164:167]
    ds_read_b64_tr_b16 v[242:243], v249 offset:11776
    s_add_u32 s32, s32, 20480
    s_cmp_ge_u32 s32, 81920
    s_cselect_b32 s32, 0, s32
    s_barrier
    v_add_u32 v249, s32, v250
    s_waitcnt lgkmcnt(10)
    v_mfma_f32_16x16x32_bf16 v[168:171], v[104:107], v[220:223], v[168:171]
    ds_read_b64_tr_b16 v[216:217], v249 offset:0
    v_mfma_f32_16x16x32_bf16 v[172:175], v[108:111], v[220:223], v[172:175]
    ds_read_b64_tr_b16 v[218:219], v249 offset:1280
    s_waitcnt lgkmcnt(10)
    v_mfma_f32_16x16x32_bf16 v[176:179], v[104:107], v[224:227], v[176:179]
    ds_read_b64_tr_b16 v[220:221], v249 offset:32
    v_mfma_f32_16x16x32_bf16 v[180:183], v[108:111], v[224:227], v[180:183]
    ds_read_b64_tr_b16 v[222:223], v249 offset:1312
    s_waitcnt lgkmcnt(10)
    v_mfma_f32_16x16x32_bf16 v[184:187], v[104:107], v[228:231], v[184:187]
    ds_read_b64_tr_b16 v[224:225], v249 offset:64
    v_mfma_f32_16x16x32_bf16 v[188:191], v[108:111], v[228:231], v[188:191]
    ds_read_b64_tr_b16 v[226:227], v249 offset:1344
    s_waitcnt lgkmcnt(10)
    v_mfma_f32_16x16x32_bf16 v[192:195], v[104:107], v[232:235], v[192:195]
    ds_read_b64_tr_b16 v[228:229], v249 offset:96
    v_mfma_f32_16x16x32_bf16 v[196:199], v[108:111], v[232:235], v[196:199]
    ds_read_b64_tr_b16 v[230:231], v249 offset:1376
    s_waitcnt lgkmcnt(10)
    v_mfma_f32_16x16x32_bf16 v[200:203], v[104:107], v[236:239], v[200:203]
    ds_read_b64_tr_b16 v[232:233], v249 offset:128
    v_mfma_f32_16x16x32_bf16 v[204:207], v[108:111], v[236:239], v[204:207]
    ds_read_b64_tr_b16 v[234:235], v249 offset:1408
    s_waitcnt lgkmcnt(10)
    v_mfma_f32_16x16x32_bf16 v[208:211], v[104:107], v[240:243], v[208:211]
    ds_read_b64_tr_b16 v[236:237], v249 offset:160
    v_mfma_f32_16x16x32_bf16 v[212:215], v[108:111], v[240:243], v[212:215]
    ds_read_b64_tr_b16 v[238:239], v249 offset:1440
    s_waitcnt lgkmcnt(10)
    v_mfma_f32_16x16x32_bf16 v[144:147], v[112:115], v[216:219], v[144:147]
    ds_read_b64_tr_b16 v[240:241], v249 offset:192
    v_mfma_f32_16x16x32_bf16 v[148:151], v[116:119], v[216:219], v[148:151]
    ds_read_b64_tr_b16 v[242:243], v249 offset:1472
    s_waitcnt lgkmcnt(10)
    v_mfma_f32_16x16x32_bf16 v[152:155], v[112:115], v[220:223], v[152:155]
    ds_read_b64_tr_b16 v[216:217], v249 offset:224
    v_mfma_f32_16x16x32_bf16 v[156:159], v[116:119], v[220:223], v[156:159]
    ds_read_b64_tr_b16 v[218:219], v249 offset:1504
    s_waitcnt lgkmcnt(10)
    v_mfma_f32_16x16x32_bf16 v[160:163], v[112:115], v[224:227], v[160:163]
    ds_read_b64_tr_b16 v[220:221], v249 offset:256
    v_mfma_f32_16x16x32_bf16 v[164:167], v[116:119], v[224:227], v[164:167]
    ds_read_b64_tr_b16 v[222:223], v249 offset:1536
    s_waitcnt lgkmcnt(10)
    v_mfma_f32_16x16x32_bf16 v[168:171], v[112:115], v[228:231], v[168:171]
    ds_read_b64_tr_b16 v[224:225], v249 offset:10240
    v_mfma_f32_16x16x32_bf16 v[172:175], v[116:119], v[228:231], v[172:175]
    ds_read_b64_tr_b16 v[226:227], v249 offset:11520
    s_waitcnt lgkmcnt(10)
    v_mfma_f32_16x16x32_bf16 v[176:179], v[112:115], v[232:235], v[176:179]
    ds_read_b64_tr_b16 v[228:229], v249 offset:10272
    v_mfma_f32_16x16x32_bf16 v[180:183], v[116:119], v[232:235], v[180:183]
    ds_read_b64_tr_b16 v[230:231], v249 offset:11552
    s_waitcnt lgkmcnt(10)
    v_mfma_f32_16x16x32_bf16 v[184:187], v[112:115], v[236:239], v[184:187]
    ds_read_b64_tr_b16 v[232:233], v249 offset:10304
    v_mfma_f32_16x16x32_bf16 v[188:191], v[116:119], v[236:239], v[188:191]
    ds_read_b64_tr_b16 v[234:235], v249 offset:11584
    s_waitcnt lgkmcnt(10)
    v_mfma_f32_16x16x32_bf16 v[192:195], v[112:115], v[240:243], v[192:195]
    ds_read_b64_tr_b16 v[236:237], v249 offset:10336
    v_mfma_f32_16x16x32_bf16 v[196:199], v[116:119], v[240:243], v[196:199]
    ds_read_b64_tr_b16 v[238:239], v249 offset:11616
    s_waitcnt lgkmcnt(10)
    v_mfma_f32_16x16x32_bf16 v[200:203], v[112:115], v[216:219], v[200:203]
    ds_read_b64_tr_b16 v[240:241], v249 offset:10368
    v_mfma_f32_16x16x32_bf16 v[204:207], v[116:119], v[216:219], v[204:207]
    ds_read_b64_tr_b16 v[242:243], v249 offset:11648
    s_waitcnt lgkmcnt(10)
    v_mfma_f32_16x16x32_bf16 v[208:211], v[112:115], v[220:223], v[208:211]
    ds_read_b64_tr_b16 v[216:217], v249 offset:10400
    v_mfma_f32_16x16x32_bf16 v[212:215], v[116:119], v[220:223], v[212:215]
    ds_read_b64_tr_b16 v[218:219], v249 offset:11680
    s_waitcnt lgkmcnt(10)
    v_mfma_f32_16x16x32_bf16 v[144:147], v[120:123], v[224:227], v[144:147]
    ds_read_b64_tr_b16 v[220:221], v249 offset:10432
    v_mfma_f32_16x16x32_bf16 v[148:151], v[124:127], v[224:227], v[148:151]
    ds_read_b64_tr_b16 v[222:223], v249 offset:11712
    s_waitcnt lgkmcnt(10)
    v_mfma_f32_16x16x32_bf16 v[152:155], v[120:123], v[228:231], v[152:155]
    ds_read_b64_tr_b16 v[224:225], v249 offset:10464
    v_mfma_f32_16x16x32_bf16 v[156:159], v[124:127], v[228:231], v[156:159]
    ds_read_b64_tr_b16 v[226:227], v249 offset:11744
    s_waitcnt lgkmcnt(10)
    v_mfma_f32_16x16x32_bf16 v[160:163], v[120:123], v[232:235], v[160:163]
    ds_read_b64_tr_b16 v[228:229], v249 offset:10496
    v_mfma_f32_16x16x32_bf16 v[164:167], v[124:127], v[232:235], v[164:167]
    ds_read_b64_tr_b16 v[230:231], v249 offset:11776
    s_add_u32 s32, s32, 20480
    s_cmp_ge_u32 s32, 81920
    s_cselect_b32 s32, 0, s32
    s_barrier
    v_add_u32 v249, s32, v250
    s_waitcnt lgkmcnt(10)
    v_mfma_f32_16x16x32_bf16 v[168:171], v[120:123], v[236:239], v[168:171]
    ds_read_b64_tr_b16 v[232:233], v249 offset:0
    v_mfma_f32_16x16x32_bf16 v[172:175], v[124:127], v[236:239], v[172:175]
    ds_read_b64_tr_b16 v[234:235], v249 offset:1280
    s_waitcnt lgkmcnt(10)
    v_mfma_f32_16x16x32_bf16 v[176:179], v[120:123], v[240:243], v[176:179]
    ds_read_b64_tr_b16 v[236:237], v249 offset:32
    v_mfma_f32_16x16x32_bf16 v[180:183], v[124:127], v[240:243], v[180:183]
    ds_read_b64_tr_b16 v[238:239], v249 offset:1312
    s_waitcnt lgkmcnt(10)
    v_mfma_f32_16x16x32_bf16 v[184:187], v[120:123], v[216:219], v[184:187]
    ds_read_b64_tr_b16 v[240:241], v249 offset:64
    v_mfma_f32_16x16x32_bf16 v[188:191], v[124:127], v[216:219], v[188:191]
    ds_read_b64_tr_b16 v[242:243], v249 offset:1344
    s_waitcnt lgkmcnt(10)
    v_mfma_f32_16x16x32_bf16 v[192:195], v[120:123], v[220:223], v[192:195]
    ds_read_b64_tr_b16 v[216:217], v249 offset:96
    v_mfma_f32_16x16x32_bf16 v[196:199], v[124:127], v[220:223], v[196:199]
    ds_read_b64_tr_b16 v[218:219], v249 offset:1376
    s_waitcnt lgkmcnt(10)
    v_mfma_f32_16x16x32_bf16 v[200:203], v[120:123], v[224:227], v[200:203]
    ds_read_b64_tr_b16 v[220:221], v249 offset:128
    v_mfma_f32_16x16x32_bf16 v[204:207], v[124:127], v[224:227], v[204:207]
    ds_read_b64_tr_b16 v[222:223], v249 offset:1408
    s_waitcnt lgkmcnt(10)
    v_mfma_f32_16x16x32_bf16 v[208:211], v[120:123], v[228:231], v[208:211]
    ds_read_b64_tr_b16 v[224:225], v249 offset:160
    v_mfma_f32_16x16x32_bf16 v[212:215], v[124:127], v[228:231], v[212:215]
    ds_read_b64_tr_b16 v[226:227], v249 offset:1440
    s_waitcnt lgkmcnt(10)
    v_mfma_f32_16x16x32_bf16 v[144:147], v[128:131], v[232:235], v[144:147]
    ds_read_b64_tr_b16 v[228:229], v249 offset:192
    v_mfma_f32_16x16x32_bf16 v[148:151], v[132:135], v[232:235], v[148:151]
    ds_read_b64_tr_b16 v[230:231], v249 offset:1472
    s_waitcnt lgkmcnt(10)
    v_mfma_f32_16x16x32_bf16 v[152:155], v[128:131], v[236:239], v[152:155]
    ds_read_b64_tr_b16 v[232:233], v249 offset:224
    v_mfma_f32_16x16x32_bf16 v[156:159], v[132:135], v[236:239], v[156:159]
    ds_read_b64_tr_b16 v[234:235], v249 offset:1504
    s_waitcnt lgkmcnt(10)
    v_mfma_f32_16x16x32_bf16 v[160:163], v[128:131], v[240:243], v[160:163]
    ds_read_b64_tr_b16 v[236:237], v249 offset:256
    v_mfma_f32_16x16x32_bf16 v[164:167], v[132:135], v[240:243], v[164:167]
    ds_read_b64_tr_b16 v[238:239], v249 offset:1536
    s_waitcnt lgkmcnt(10)
    v_mfma_f32_16x16x32_bf16 v[168:171], v[128:131], v[216:219], v[168:171]
    ds_read_b64_tr_b16 v[240:241], v249 offset:10240
    v_mfma_f32_16x16x32_bf16 v[172:175], v[132:135], v[216:219], v[172:175]
    ds_read_b64_tr_b16 v[242:243], v249 offset:11520
    s_waitcnt lgkmcnt(10)
    v_mfma_f32_16x16x32_bf16 v[176:179], v[128:131], v[220:223], v[176:179]
    ds_read_b64_tr_b16 v[216:217], v249 offset:10272
    v_mfma_f32_16x16x32_bf16 v[180:183], v[132:135], v[220:223], v[180:183]
    ds_read_b64_tr_b16 v[218:219], v249 offset:11552
    s_waitcnt lgkmcnt(10)
    v_mfma_f32_16x16x32_bf16 v[184:187], v[128:131], v[224:227], v[184:187]
    ds_read_b64_tr_b16 v[220:221], v249 offset:10304
    v_mfma_f32_16x16x32_bf16 v[188:191], v[132:135], v[224:227], v[188:191]
    ds_read_b64_tr_b16 v[222:223], v249 offset:11584
    s_waitcnt lgkmcnt(10)
    v_mfma_f32_16x16x32_bf16 v[192:195], v[128:131], v[228:231], v[192:195]
    ds_read_b64_tr_b16 v[224:225], v249 offset:10336
    v_mfma_f32_16x16x32_bf16 v[196:199], v[132:135], v[228:231], v[196:199]
    ds_read_b64_tr_b16 v[226:227], v249 offset:11616
    s_waitcnt lgkmcnt(10)
    v_mfma_f32_16x16x32_bf16 v[200:203], v[128:131], v[232:235], v[200:203]
    ds_read_b64_tr_b16 v[228:229], v249 offset:10368
    v_mfma_f32_16x16x32_bf16 v[204:207], v[132:135], v[232:235], v[204:207]
    ds_read_b64_tr_b16 v[230:231], v249 offset:11648
    s_waitcnt lgkmcnt(10)
    v_mfma_f32_16x16x32_bf16 v[208:211], v[128:131], v[236:239], v[208:211]
    ds_read_b64_tr_b16 v[232:233], v249 offset:10400
    v_mfma_f32_16x16x32_bf16 v[212:215], v[132:135], v[236:239], v[212:215]
    ds_read_b64_tr_b16 v[234:235], v249 offset:11680
    s_waitcnt lgkmcnt(10)
    v_mfma_f32_16x16x32_bf16 v[144:147], v[136:139], v[240:243], v[144:147]
    ds_read_b64_tr_b16 v[236:237], v249 offset:10432
    v_mfma_f32_16x16x32_bf16 v[148:151], v[140:143], v[240:243], v[148:151]
    ds_read_b64_tr_b16 v[238:239], v249 offset:11712
    s_waitcnt lgkmcnt(10)
    v_mfma_f32_16x16x32_bf16 v[152:155], v[136:139], v[216:219], v[152:155]
    ds_read_b64_tr_b16 v[240:241], v249 offset:10464
    v_mfma_f32_16x16x32_bf16 v[156:159], v[140:143], v[216:219], v[156:159]
    ds_read_b64_tr_b16 v[242:243], v249 offset:11744
    s_waitcnt lgkmcnt(10)
    v_mfma_f32_16x16x32_bf16 v[160:163], v[136:139], v[220:223], v[160:163]
    ds_read_b64_tr_b16 v[216:217], v249 offset:10496
    v_mfma_f32_16x16x32_bf16 v[164:167], v[140:143], v[220:223], v[164:167]
    ds_read_b64_tr_b16 v[218:219], v249 offset:11776
    s_add_u32 s32, s32, 20480
    s_cmp_ge_u32 s32, 81920
    s_cselect_b32 s32, 0, s32
    s_barrier
    s_waitcnt lgkmcnt(10)
    v_mfma_f32_16x16x32_bf16 v[168:171], v[136:139], v[224:227], v[168:171]
    v_mfma_f32_16x16x32_bf16 v[172:175], v[140:143], v[224:227], v[172:175]
    s_waitcnt lgkmcnt(8)
    v_mfma_f32_16x16x32_bf16 v[176:179], v[136:139], v[228:231], v[176:179]
    v_mfma_f32_16x16x32_bf16 v[180:183], v[140:143], v[228:231], v[180:183]
    s_waitcnt lgkmcnt(6)
    v_mfma_f32_16x16x32_bf16 v[184:187], v[136:139], v[232:235], v[184:187]
    v_mfma_f32_16x16x32_bf16 v[188:191], v[140:143], v[232:235], v[188:191]
    s_waitcnt lgkmcnt(4)
    v_mfma_f32_16x16x32_bf16 v[192:195], v[136:139], v[236:239], v[192:195]
    v_mfma_f32_16x16x32_bf16 v[196:199], v[140:143], v[236:239], v[196:199]
    s_waitcnt lgkmcnt(2)
    v_mfma_f32_16x16x32_bf16 v[200:203], v[136:139], v[240:243], v[200:203]
    v_mfma_f32_16x16x32_bf16 v[204:207], v[140:143], v[240:243], v[204:207]
    s_waitcnt lgkmcnt(0)
    v_mfma_f32_16x16x32_bf16 v[208:211], v[136:139], v[216:219], v[208:211]
    v_mfma_f32_16x16x32_bf16 v[212:215], v[140:143], v[216:219], v[212:215]
    s_nop 7
    s_setpc_b64 s[50:51]
.p2align 6
k1_kernel_main1:
    v_add_u32 v249, s32, v250
    ds_read_b64_tr_b16 v[216:217], v249 offset:0
    ds_read_b64_tr_b16 v[218:219], v249 offset:1280
    ds_read_b64_tr_b16 v[220:221], v249 offset:32
    ds_read_b64_tr_b16 v[222:223], v249 offset:1312
    ds_read_b64_tr_b16 v[224:225], v249 offset:64
    ds_read_b64_tr_b16 v[226:227], v249 offset:1344
    ds_read_b64_tr_b16 v[228:229], v249 offset:96
    ds_read_b64_tr_b16 v[230:231], v249 offset:1376
    ds_read_b64_tr_b16 v[232:233], v249 offset:128
    ds_read_b64_tr_b16 v[234:235], v249 offset:1408
    ds_read_b64_tr_b16 v[236:237], v249 offset:160
    ds_read_b64_tr_b16 v[238:239], v249 offset:1440
    s_waitcnt lgkmcnt(10)
    v_mfma_f32_16x16x32_bf16 v[144:147], v[216:219], v[0:3], 0
    ds_read_b64_tr_b16 v[240:241], v249 offset:192
    v_mfma_f32_16x16x32_bf16 v[148:151], v[216:219], v[4:7], 0
    ds_read_b64_tr_b16 v[242:243], v249 offset:1472
    s_waitcnt lgkmcnt(10)
    v_mfma_f32_16x16x32_bf16 v[152:155], v[220:223], v[0:3], 0
    ds_read_b64_tr_b16 v[216:217], v249 offset:224
    v_mfma_f32_16x16x32_bf16 v[156:159], v[220:223], v[4:7], 0
    ds_read_b64_tr_b16 v[218:219], v249 offset:1504
    s_waitcnt lgkmcnt(10)
    v_mfma_f32_16x16x32_bf16 v[160:163], v[224:227], v[0:3], 0
    ds_read_b64_tr_b16 v[220:221], v249 offset:256
    v_mfma_f32_16x16x32_bf16 v[164:167], v[224:227], v[4:7], 0
    ds_read_b64_tr_b16 v[222:223], v249 offset:1536
    s_waitcnt lgkmcnt(10)
    v_mfma_f32_16x16x32_bf16 v[168:171], v[228:231], v[0:3], 0
    ds_read_b64_tr_b16 v[224:225], v249 offset:10240
    v_mfma_f32_16x16x32_bf16 v[172:175], v[228:231], v[4:7], 0
    ds_read_b64_tr_b16 v[226:227], v249 offset:11520
    s_waitcnt lgkmcnt(10)
    v_mfma_f32_16x16x32_bf16 v[176:179], v[232:235], v[0:3], 0
    ds_read_b64_tr_b16 v[228:229], v249 offset:10272
    v_mfma_f32_16x16x32_bf16 v[180:183], v[232:235], v[4:7], 0
    ds_read_b64_tr_b16 v[230:231], v249 offset:11552
    s_waitcnt lgkmcnt(10)
    v_mfma_f32_16x16x32_bf16 v[184:187], v[236:239], v[0:3], 0
    ds_read_b64_tr_b16 v[232:233], v249 offset:10304
    v_mfma_f32_16x16x32_bf16 v[188:191], v[236:239], v[4:7], 0
    ds_read_b64_tr_b16 v[234:235], v249 offset:11584
    s_waitcnt lgkmcnt(10)
    v_mfma_f32_16x16x32_bf16 v[192:195], v[240:243], v[0:3], 0
    ds_read_b64_tr_b16 v[236:237], v249 offset:10336
    v_mfma_f32_16x16x32_bf16 v[196:199], v[240:243], v[4:7], 0
    ds_read_b64_tr_b16 v[238:239], v249 offset:11616
    s_waitcnt lgkmcnt(10)
    v_mfma_f32_16x16x32_bf16 v[200:203], v[216:219], v[0:3], 0
    ds_read_b64_tr_b16 v[240:241], v249 offset:10368
    v_mfma_f32_16x16x32_bf16 v[204:207], v[216:219], v[4:7], 0
    ds_read_b64_tr_b16 v[242:243], v249 offset:11648
    s_waitcnt lgkmcnt(10)
    v_mfma_f32_16x16x32_bf16 v[208:211], v[220:223], v[0:3], 0
    ds_read_b64_tr_b16 v[216:217], v249 offset:10400
    v_mfma_f32_16x16x32_bf16 v[212:215], v[220:223], v[4:7], 0
    ds_read_b64_tr_b16 v[218:219], v249 offset:11680
    s_waitcnt lgkmcnt(10)
    v_mfma_f32_16x16x32_bf16 v[144:147], v[224:227], v[8:11], v[144:147]
    ds_read_b64_tr_b16 v[220:221], v249 offset:10432
    v_mfma_f32_16x16x32_bf16 v[148:151], v[224:227], v[12:15], v[148:151]
    ds_read_b64_tr_b16 v[222:223], v249 offset:11712
    s_waitcnt lgkmcnt(10)
    v_mfma_f32_16x16x32_bf16 v[152:155], v[228:231], v[8:11], v[152:155]
    ds_read_b64_tr_b16 v[224:225], v249 offset:10464
    v_mfma_f32_16x16x32_bf16 v[156:159], v[228:231], v[12:15], v[156:159]
    ds_read_b64_tr_b16 v[226:227], v249 offset:11744
    s_waitcnt lgkmcnt(10)
    v_mfma_f32_16x16x32_bf16 v[160:163], v[232:235], v[8:11], v[160:163]
    ds_read_b64_tr_b16 v[228:229], v249 offset:10496
    v_mfma_f32_16x16x32_bf16 v[164:167], v[232:235], v[12:15], v[164:167]
    ds_read_b64_tr_b16 v[230:231], v249 offset:11776
    s_add_u32 s32, s32, 20480
    s_cmp_ge_u32 s32, 81920
    s_cselect_b32 s32, 0, s32
    s_cmp_eq_u32 s98, 1
    s_cbranch_scc1 k1_kernel_nw10
    s_waitcnt vmcnt(6)
k1_kernel_nw10:
    s_barrier
    v_add_u32 v249, s32, v250
    s_waitcnt lgkmcnt(10)
    v_mfma_f32_16x16x32_bf16 v[168:171], v[236:239], v[8:11], v[168:171]
    ds_read_b64_tr_b16 v[232:233], v249 offset:0
    v_mfma_f32_16x16x32_bf16 v[172:175], v[236:239], v[12:15], v[172:175]
    ds_read_b64_tr_b16 v[234:235], v249 offset:1280
    s_waitcnt lgkmcnt(10)
    v_mfma_f32_16x16x32_bf16 v[176:179], v[240:243], v[8:11], v[176:179]
    ds_read_b64_tr_b16 v[236:237], v249 offset:32
    v_mfma_f32_16x16x32_bf16 v[180:183], v[240:243], v[12:15], v[180:183]
    ds_read_b64_tr_b16 v[238:239], v249 offset:1312
    s_waitcnt lgkmcnt(10)
    v_mfma_f32_16x16x32_bf16 v[184:187], v[216:219], v[8:11], v[184:187]
    ds_read_b64_tr_b16 v[240:241], v249 offset:64
    v_mfma_f32_16x16x32_bf16 v[188:191], v[216:219], v[12:15], v[188:191]
    ds_read_b64_tr_b16 v[242:243], v249 offset:1344
    s_waitcnt lgkmcnt(10)
    v_mfma_f32_16x16x32_bf16 v[192:195], v[220:223], v[8:11], v[192:195]
    ds_read_b64_tr_b16 v[216:217], v249 offset:96
    v_mfma_f32_16x16x32_bf16 v[196:199], v[220:223], v[12:15], v[196:199]
    ds_read_b64_tr_b16 v[218:219], v249 offset:1376
    s_waitcnt lgkmcnt(10)
    v_mfma_f32_16x16x32_bf16 v[200:203], v[224:227], v[8:11], v[200:203]
    ds_read_b64_tr_b16 v[220:221], v249 offset:128
    v_mfma_f32_16x16x32_bf16 v[204:207], v[224:227], v[12:15], v[204:207]
    ds_read_b64_tr_b16 v[222:223], v249 offset:1408
    s_waitcnt lgkmcnt(10)
    v_mfma_f32_16x16x32_bf16 v[208:211], v[228:231], v[8:11], v[208:211]
    ds_read_b64_tr_b16 v[224:225], v249 offset:160
    v_mfma_f32_16x16x32_bf16 v[212:215], v[228:231], v[12:15], v[212:215]
    ds_read_b64_tr_b16 v[226:227], v249 offset:1440
    s_waitcnt lgkmcnt(10)
    v_mfma_f32_16x16x32_bf16 v[144:147], v[232:235], v[16:19], v[144:147]
    ds_read_b64_tr_b16 v[228:229], v249 offset:192
    v_mfma_f32_16x16x32_bf16 v[148:151], v[232:235], v[20:23], v[148:151]
    ds_read_b64_tr_b16 v[230:231], v249 offset:1472
    s_waitcnt lgkmcnt(10)
    v_mfma_f32_16x16x32_bf16 v[152:155], v[236:239], v[16:19], v[152:155]
    ds_read_b64_tr_b16 v[232:233], v249 offset:224
    v_mfma_f32_16x16x32_bf16 v[156:159], v[236:239], v[20:23], v[156:159]
    ds_read_b64_tr_b16 v[234:235], v249 offset:1504
    s_waitcnt lgkmcnt(10)
    v_mfma_f32_16x16x32_bf16 v[160:163], v[240:243], v[16:19], v[160:163]
    ds_read_b64_tr_b16 v[236:237], v249 offset:256
    v_mfma_f32_16x16x32_bf16 v[164:167], v[240:243], v[20:23], v[164:167]
    ds_read_b64_tr_b16 v[238:239], v249 offset:1536
    s_waitcnt lgkmcnt(10)
    v_mfma_f32_16x16x32_bf16 v[168:171], v[216:219], v[16:19], v[168:171]
    ds_read_b64_tr_b16 v[240:241], v249 offset:10240
    v_mfma_f32_16x16x32_bf16 v[172:175], v[216:219], v[20:23], v[172:175]
    ds_read_b64_tr_b16 v[242:243], v249 offset:11520
    s_waitcnt lgkmcnt(10)
    v_mfma_f32_16x16x32_bf16 v[176:179], v[220:223], v[16:19], v[176:179]
    ds_read_b64_tr_b16 v[216:217], v249 offset:10272
    v_mfma_f32_16x16x32_bf16 v[180:183], v[220:223], v[20:23], v[180:183]
    ds_read_b64_tr_b16 v[218:219], v249 offset:11552
    s_waitcnt lgkmcnt(10)
    v_mfma_f32_16x16x32_bf16 v[184:187], v[224:227], v[16:19], v[184:187]
    ds_read_b64_tr_b16 v[220:221], v249 offset:10304
    v_mfma_f32_16x16x32_bf16 v[188:191], v[224:227], v[20:23], v[188:191]
    ds_read_b64_tr_b16 v[222:223], v249 offset:11584
    s_waitcnt lgkmcnt(10)
    v_mfma_f32_16x16x32_bf16 v[192:195], v[228:231], v[16:19], v[192:195]
    ds_read_b64_tr_b16 v[224:225], v249 offset:10336
    v_mfma_f32_16x16x32_bf16 v[196:199], v[228:231], v[20:23], v[196:199]
    ds_read_b64_tr_b16 v[226:227], v249 offset:11616
    s_waitcnt lgkmcnt(10)
    v_mfma_f32_16x16x32_bf16 v[200:203], v[232:235], v[16:19], v[200:203]
    ds_read_b64_tr_b16 v[228:229], v249 offset:10368
    v_mfma_f32_16x16x32_bf16 v[204:207], v[232:235], v[20:23], v[204:207]
    ds_read_b64_tr_b16 v[230:231], v249 offset:11648
    s_waitcnt lgkmcnt(10)
    v_mfma_f32_16x16x32_bf16 v[208:211], v[236:239], v[16:19], v[208:211]
    ds_read_b64_tr_b16 v[232:233], v249 offset:10400
    v_mfma_f32_16x16x32_bf16 v[212:215], v[236:239], v[20:23], v[212:215]
    ds_read_b64_tr_b16 v[234:235], v249 offset:11680
    s_waitcnt lgkmcnt(10)
    v_mfma_f32_16x16x32_bf16 v[144:147], v[240:243], v[24:27], v[144:147]
    ds_read_b64_tr_b16 v[236:237], v249 offset:10432
    v_mfma_f32_16x16x32_bf16 v[148:151], v[240:243], v[28:31], v[148:151]
    ds_read_b64_tr_b16 v[238:239], v249 offset:11712
    s_waitcnt lgkmcnt(10)
    v_mfma_f32_16x16x32_bf16 v[152:155], v[216:219], v[24:27], v[152:155]
    ds_read_b64_tr_b16 v[240:241], v249 offset:10464
    v_mfma_f32_16x16x32_bf16 v[156:159], v[216:219], v[28:31], v[156:159]
    ds_read_b64_tr_b16 v[242:243], v249 offset:11744
    s_waitcnt lgkmcnt(10)
    v_mfma_f32_16x16x32_bf16 v[160:163], v[220:223], v[24:27], v[160:163]
    ds_read_b64_tr_b16 v[216:217], v249 offset:10496
    v_mfma_f32_16x16x32_bf16 v[164:167], v[220:223], v[28:31], v[164:167]
    ds_read_b64_tr_b16 v[218:219], v249 offset:11776
    s_add_u32 s32, s32, 20480
    s_cmp_ge_u32 s32, 81920
    s_cselect_b32 s32, 0, s32
    s_cmp_eq_u32 s98, 1
    s_cbranch_scc1 k1_kernel_nw11
    s_waitcnt vmcnt(1)
k1_kernel_nw11:
    s_barrier
    v_add_u32 v249, s32, v250
    s_waitcnt lgkmcnt(10)
    v_mfma_f32_16x16x32_bf16 v[168:171], v[224:227], v[24:27], v[168:171]
    ds_read_b64_tr_b16 v[220:221], v249 offset:0
    v_mfma_f32_16x16x32_bf16 v[172:175], v[224:227], v[28:31], v[172:175]
    ds_read_b64_tr_b16 v[222:223], v249 offset:1280
    s_waitcnt lgkmcnt(10)
    v_mfma_f32_16x16x32_bf16 v[176:179], v[228:231], v[24:27], v[176:179]
    ds_read_b64_tr_b16 v[224:225], v249 offset:32
    v_mfma_f32_16x16x32_bf16 v[180:183], v[228:231], v[28:31], v[180:183]
    ds_read_b64_tr_b16 v[226:227], v249 offset:1312
    s_waitcnt lgkmcnt(10)
    v_mfma_f32_16x16x32_bf16 v[184:187], v[232:235], v[24:27], v[184:187]
    ds_read_b64_tr_b16 v[228:229], v249 offset:64
    v_mfma_f32_16x16x32_bf16 v[188:191], v[232:235], v[28:31], v[188:191]
    ds_read_b64_tr_b16 v[230:231], v249 offset:1344
    s_waitcnt lgkmcnt(10)
    v_mfma_f32_16x16x32_bf16 v[192:195], v[236:239], v[24:27], v[192:195]
    ds_read_b64_tr_b16 v[232:233], v249 offset:96
    v_mfma_f32_16x16x32_bf16 v[196:199], v[236:239], v[28:31], v[196:199]
    ds_read_b64_tr_b16 v[234:235], v249 offset:1376
    s_waitcnt lgkmcnt(10)
    v_mfma_f32_16x16x32_bf16 v[200:203], v[240:243], v[24:27], v[200:203]
    ds_read_b64_tr_b16 v[236:237], v249 offset:128
    v_mfma_f32_16x16x32_bf16 v[204:207], v[240:243], v[28:31], v[204:207]
    ds_read_b64_tr_b16 v[238:239], v249 offset:1408
    s_waitcnt lgkmcnt(10)
    v_mfma_f32_16x16x32_bf16 v[208:211], v[216:219], v[24:27], v[208:211]
    ds_read_b64_tr_b16 v[240:241], v249 offset:160
    v_mfma_f32_16x16x32_bf16 v[212:215], v[216:219], v[28:31], v[212:215]
    ds_read_b64_tr_b16 v[242:243], v249 offset:1440
    s_waitcnt lgkmcnt(10)
    v_mfma_f32_16x16x32_bf16 v[144:147], v[220:223], v[32:35], v[144:147]
    ds_read_b64_tr_b16 v[216:217], v249 offset:192
    v_mfma_f32_16x16x32_bf16 v[148:151], v[220:223], v[36:39], v[148:151]
    ds_read_b64_tr_b16 v[218:219], v249 offset:1472
    s_waitcnt lgkmcnt(10)
    v_mfma_f32_16x16x32_bf16 v[152:155], v[224:227], v[32:35], v[152:155]
    ds_read_b64_tr_b16 v[220:221], v249 offset:224
    v_mfma_f32_16x16x32_bf16 v[156:159], v[224:227], v[36:39], v[156:159]
    ds_read_b64_tr_b16 v[222:223], v249 offset:1504
    s_waitcnt lgkmcnt(10)
    v_mfma_f32_16x16x32_bf16 v[160:163], v[228:231], v[32:35], v[160:163]
    ds_read_b64_tr_b16 v[224:225], v249 offset:256
    v_mfma_f32_16x16x32_bf16 v[164:167], v[228:231], v[36:39], v[164:167]
    ds_read_b64_tr_b16 v[226:227], v249 offset:1536
    s_waitcnt lgkmcnt(10)
    v_mfma_f32_16x16x32_bf16 v[168:171], v[232:235], v[32:35], v[168:171]
    ds_read_b64_tr_b16 v[228:229], v249 offset:10240
    v_mfma_f32_16x16x32_bf16 v[172:175], v[232:235], v[36:39], v[172:175]
    ds_read_b64_tr_b16 v[230:231], v249 offset:11520
    s_waitcnt lgkmcnt(10)
    v_mfma_f32_16x16x32_bf16 v[176:179], v[236:239], v[32:35], v[176:179]
    ds_read_b64_tr_b16 v[232:233], v249 offset:10272
    v_mfma_f32_16x16x32_bf16 v[180:183], v[236:239], v[36:39], v[180:183]
    ds_read_b64_tr_b16 v[234:235], v249 offset:11552
    s_waitcnt lgkmcnt(10)
    v_mfma_f32_16x16x32_bf16 v[184:187], v[240:243], v[32:35], v[184:187]
    ds_read_b64_tr_b16 v[236:237], v249 offset:10304
    v_mfma_f32_16x16x32_bf16 v[188:191], v[240:243], v[36:39], v[188:191]
    ds_read_b64_tr_b16 v[238:239], v249 offset:11584
    s_waitcnt lgkmcnt(10)
    v_mfma_f32_16x16x32_bf16 v[192:195], v[216:219], v[32:35], v[192:195]
    ds_read_b64_tr_b16 v[240:241], v249 offset:10336
    v_mfma_f32_16x16x32_bf16 v[196:199], v[216:219], v[36:39], v[196:199]
    ds_read_b64_tr_b16 v[242:243], v249 offset:11616
    s_waitcnt lgkmcnt(10)
    v_mfma_f32_16x16x32_bf16 v[200:203], v[220:223], v[32:35], v[200:203]
    ds_read_b64_tr_b16 v[216:217], v249 offset:10368
    v_mfma_f32_16x16x32_bf16 v[204:207], v[220:223], v[36:39], v[204:207]
    ds_read_b64_tr_b16 v[218:219], v249 offset:11648
    s_waitcnt lgkmcnt(10)
    v_mfma_f32_16x16x32_bf16 v[208:211], v[224:227], v[32:35], v[208:211]
    ds_read_b64_tr_b16 v[220:221], v249 offset:10400
    v_mfma_f32_16x16x32_bf16 v[212:215], v[224:227], v[36:39], v[212:215]
    ds_read_b64_tr_b16 v[222:223], v249 offset:11680
    s_waitcnt lgkmcnt(10)
    v_mfma_f32_16x16x32_bf16 v[144:147], v[228:231], v[40:43], v[144:147]
    ds_read_b64_tr_b16 v[224:225], v249 offset:10432
    v_mfma_f32_16x16x32_bf16 v[148:151], v[228:231], v[44:47], v[148:151]
    ds_read_b64_tr_b16 v[226:227], v249 offset:11712
    s_waitcnt lgkmcnt(10)
    v_mfma_f32_16x16x32_bf16 v[152:155], v[232:235], v[40:43], v[152:155]
    ds_read_b64_tr_b16 v[228:229], v249 offset:10464
    v_mfma_f32_16x16x32_bf16 v[156:159], v[232:235], v[44:47], v[156:159]
    ds_read_b64_tr_b16 v[230:231], v249 offset:11744
    s_waitcnt lgkmcnt(10)
    v_mfma_f32_16x16x32_bf16 v[160:163], v[236:239], v[40:43], v[160:163]
    ds_read_b64_tr_b16 v[232:233], v249 offset:10496
    v_mfma_f32_16x16x32_bf16 v[164:167], v[236:239], v[44:47], v[164:167]
    ds_read_b64_tr_b16 v[234:235], v249 offset:11776
    s_add_u32 s32, s32, 20480
    s_cmp_ge_u32 s32, 81920
    s_cselect_b32 s32, 0, s32
    s_barrier
    v_add_u32 v249, s32, v250
    s_waitcnt lgkmcnt(10)
    v_mfma_f32_16x16x32_bf16 v[168:171], v[240:243], v[40:43], v[168:171]
    ds_read_b64_tr_b16 v[236:237], v249 offset:0
    v_mfma_f32_16x16x32_bf16 v[172:175], v[240:243], v[44:47], v[172:175]
    ds_read_b64_tr_b16 v[238:239], v249 offset:1280
    s_waitcnt lgkmcnt(10)
    v_mfma_f32_16x16x32_bf16 v[176:179], v[216:219], v[40:43], v[176:179]
    ds_read_b64_tr_b16 v[240:241], v249 offset:32
    v_mfma_f32_16x16x32_bf16 v[180:183], v[216:219], v[44:47], v[180:183]
    ds_read_b64_tr_b16 v[242:243], v249 offset:1312
    s_waitcnt lgkmcnt(10)
    v_mfma_f32_16x16x32_bf16 v[184:187], v[220:223], v[40:43], v[184:187]
    ds_read_b64_tr_b16 v[216:217], v249 offset:64
    v_mfma_f32_16x16x32_bf16 v[188:191], v[220:223], v[44:47], v[188:191]
    ds_read_b64_tr_b16 v[218:219], v249 offset:1344
    s_waitcnt lgkmcnt(10)
    v_mfma_f32_16x16x32_bf16 v[192:195], v[224:227], v[40:43], v[192:195]
    ds_read_b64_tr_b16 v[220:221], v249 offset:96
    v_mfma_f32_16x16x32_bf16 v[196:199], v[224:227], v[44:47], v[196:199]
    ds_read_b64_tr_b16 v[222:223], v249 offset:1376
    s_waitcnt lgkmcnt(10)
    v_mfma_f32_16x16x32_bf16 v[200:203], v[228:231], v[40:43], v[200:203]
    ds_read_b64_tr_b16 v[224:225], v249 offset:128
    v_mfma_f32_16x16x32_bf16 v[204:207], v[228:231], v[44:47], v[204:207]
    ds_read_b64_tr_b16 v[226:227], v249 offset:1408
    s_waitcnt lgkmcnt(10)
    v_mfma_f32_16x16x32_bf16 v[208:211], v[232:235], v[40:43], v[208:211]
    ds_read_b64_tr_b16 v[228:229], v249 offset:160
    v_mfma_f32_16x16x32_bf16 v[212:215], v[232:235], v[44:47], v[212:215]
    ds_read_b64_tr_b16 v[230:231], v249 offset:1440
    s_waitcnt lgkmcnt(10)
    v_mfma_f32_16x16x32_bf16 v[144:147], v[236:239], v[48:51], v[144:147]
    ds_read_b64_tr_b16 v[232:233], v249 offset:192
    v_mfma_f32_16x16x32_bf16 v[148:151], v[236:239], v[52:55], v[148:151]
    ds_read_b64_tr_b16 v[234:235], v249 offset:1472
    s_waitcnt lgkmcnt(10)
    v_mfma_f32_16x16x32_bf16 v[152:155], v[240:243], v[48:51], v[152:155]
    ds_read_b64_tr_b16 v[236:237], v249 offset:224
    v_mfma_f32_16x16x32_bf16 v[156:159], v[240:243], v[52:55], v[156:159]
    ds_read_b64_tr_b16 v[238:239], v249 offset:1504
    s_waitcnt lgkmcnt(10)
    v_mfma_f32_16x16x32_bf16 v[160:163], v[216:219], v[48:51], v[160:163]
    ds_read_b64_tr_b16 v[240:241], v249 offset:256
    v_mfma_f32_16x16x32_bf16 v[164:167], v[216:219], v[52:55], v[164:167]
    ds_read_b64_tr_b16 v[242:243], v249 offset:1536
    s_waitcnt lgkmcnt(10)
    v_mfma_f32_16x16x32_bf16 v[168:171], v[220:223], v[48:51], v[168:171]
    ds_read_b64_tr_b16 v[216:217], v249 offset:10240
    v_mfma_f32_16x16x32_bf16 v[172:175], v[220:223], v[52:55], v[172:175]
    ds_read_b64_tr_b16 v[218:219], v249 offset:11520
    s_waitcnt lgkmcnt(10)
    v_mfma_f32_16x16x32_bf16 v[176:179], v[224:227], v[48:51], v[176:179]
    ds_read_b64_tr_b16 v[220:221], v249 offset:10272
    v_mfma_f32_16x16x32_bf16 v[180:183], v[224:227], v[52:55], v[180:183]
    ds_read_b64_tr_b16 v[222:223], v249 offset:11552
    s_waitcnt lgkmcnt(10)
    v_mfma_f32_16x16x32_bf16 v[184:187], v[228:231], v[48:51], v[184:187]
    ds_read_b64_tr_b16 v[224:225], v249 offset:10304
    v_mfma_f32_16x16x32_bf16 v[188:191], v[228:231], v[52:55], v[188:191]
    ds_read_b64_tr_b16 v[226:227], v249 offset:11584
    s_waitcnt lgkmcnt(10)
    v_mfma_f32_16x16x32_bf16 v[192:195], v[232:235], v[48:51], v[192:195]
    ds_read_b64_tr_b16 v[228:229], v249 offset:10336
    v_mfma_f32_16x16x32_bf16 v[196:199], v[232:235], v[52:55], v[196:199]
    ds_read_b64_tr_b16 v[230:231], v249 offset:11616
    s_waitcnt lgkmcnt(10)
    v_mfma_f32_16x16x32_bf16 v[200:203], v[236:239], v[48:51], v[200:203]
    ds_read_b64_tr_b16 v[232:233], v249 offset:10368
    v_mfma_f32_16x16x32_bf16 v[204:207], v[236:239], v[52:55], v[204:207]
    ds_read_b64_tr_b16 v[234:235], v249 offset:11648
    s_waitcnt lgkmcnt(10)
    v_mfma_f32_16x16x32_bf16 v[208:211], v[240:243], v[48:51], v[208:211]
    ds_read_b64_tr_b16 v[236:237], v249 offset:10400
    v_mfma_f32_16x16x32_bf16 v[212:215], v[240:243], v[52:55], v[212:215]
    ds_read_b64_tr_b16 v[238:239], v249 offset:11680
    s_waitcnt lgkmcnt(10)
    v_mfma_f32_16x16x32_bf16 v[144:147], v[216:219], v[56:59], v[144:147]
    ds_read_b64_tr_b16 v[240:241], v249 offset:10432
    v_mfma_f32_16x16x32_bf16 v[148:151], v[216:219], v[60:63], v[148:151]
    ds_read_b64_tr_b16 v[242:243], v249 offset:11712
    s_waitcnt lgkmcnt(10)
    v_mfma_f32_16x16x32_bf16 v[152:155], v[220:223], v[56:59], v[152:155]
    ds_read_b64_tr_b16 v[216:217], v249 offset:10464
    v_mfma_f32_16x16x32_bf16 v[156:159], v[220:223], v[60:63], v[156:159]
    ds_read_b64_tr_b16 v[218:219], v249 offset:11744
    s_waitcnt lgkmcnt(10)
    v_mfma_f32_16x16x32_bf16 v[160:163], v[224:227], v[56:59], v[160:163]
    ds_read_b64_tr_b16 v[220:221], v249 offset:10496
    v_mfma_f32_16x16x32_bf16 v[164:167], v[224:227], v[60:63], v[164:167]
    ds_read_b64_tr_b16 v[222:223], v249 offset:11776
    s_add_u32 s32, s32, 20480
    s_cmp_ge_u32 s32, 81920
    s_cselect_b32 s32, 0, s32
    s_barrier
    v_add_u32 v249, s32, v250
    s_waitcnt lgkmcnt(10)
    v_mfma_f32_16x16x32_bf16 v[168:171], v[228:231], v[56:59], v[168:171]
    ds_read_b64_tr_b16 v[224:225], v249 offset:0
    v_mfma_f32_16x16x32_bf16 v[172:175], v[228:231], v[60:63], v[172:175]
    ds_read_b64_tr_b16 v[226:227], v249 offset:1280
    s_waitcnt lgkmcnt(10)
    v_mfma_f32_16x16x32_bf16 v[176:179], v[232:235], v[56:59], v[176:179]
    ds_read_b64_tr_b16 v[228:229], v249 offset:32
    v_mfma_f32_16x16x32_bf16 v[180:183], v[232:235], v[60:63], v[180:183]
    ds_read_b64_tr_b16 v[230:231], v249 offset:1312
    s_waitcnt lgkmcnt(10)
    v_mfma_f32_16x16x32_bf16 v[184:187], v[236:239], v[56:59], v[184:187]
    ds_read_b64_tr_b16 v[232:233], v249 offset:64
    v_mfma_f32_16x16x32_bf16 v[188:191], v[236:239], v[60:63], v[188:191]
    ds_read_b64_tr_b16 v[234:235], v249 offset:1344
    s_waitcnt lgkmcnt(10)
    v_mfma_f32_16x16x32_bf16 v[192:195], v[240:243], v[56:59], v[192:195]
    ds_read_b64_tr_b16 v[236:237], v249 offset:96
    v_mfma_f32_16x16x32_bf16 v[196:199], v[240:243], v[60:63], v[196:199]
    ds_read_b64_tr_b16 v[238:239], v249 offset:1376
    s_waitcnt lgkmcnt(10)
    v_mfma_f32_16x16x32_bf16 v[200:203], v[216:219], v[56:59], v[200:203]
    ds_read_b64_tr_b16 v[240:241], v249 offset:128
    v_mfma_f32_16x16x32_bf16 v[204:207], v[216:219], v[60:63], v[204:207]
    ds_read_b64_tr_b16 v[242:243], v249 offset:1408
    s_waitcnt lgkmcnt(10)
    v_mfma_f32_16x16x32_bf16 v[208:211], v[220:223], v[56:59], v[208:211]
    ds_read_b64_tr_b16 v[216:217], v249 offset:160
    v_mfma_f32_16x16x32_bf16 v[212:215], v[220:223], v[60:63], v[212:215]
    ds_read_b64_tr_b16 v[218:219], v249 offset:1440
    s_waitcnt lgkmcnt(10)
    v_mfma_f32_16x16x32_bf16 v[144:147], v[224:227], v[64:67], v[144:147]
    ds_read_b64_tr_b16 v[220:221], v249 offset:192
    v_mfma_f32_16x16x32_bf16 v[148:151], v[224:227], v[68:71], v[148:151]
    ds_read_b64_tr_b16 v[222:223], v249 offset:1472
    s_waitcnt lgkmcnt(10)
    v_mfma_f32_16x16x32_bf16 v[152:155], v[228:231], v[64:67], v[152:155]
    ds_read_b64_tr_b16 v[224:225], v249 offset:224
    v_mfma_f32_16x16x32_bf16 v[156:159], v[228:231], v[68:71], v[156:159]
    ds_read_b64_tr_b16 v[226:227], v249 offset:1504
    s_waitcnt lgkmcnt(10)
    v_mfma_f32_16x16x32_bf16 v[160:163], v[232:235], v[64:67], v[160:163]
    ds_read_b64_tr_b16 v[228:229], v249 offset:256
    v_mfma_f32_16x16x32_bf16 v[164:167], v[232:235], v[68:71], v[164:167]
    ds_read_b64_tr_b16 v[230:231], v249 offset:1536
    s_waitcnt lgkmcnt(10)
    v_mfma_f32_16x16x32_bf16 v[168:171], v[236:239], v[64:67], v[168:171]
    ds_read_b64_tr_b16 v[232:233], v249 offset:10240
    v_mfma_f32_16x16x32_bf16 v[172:175], v[236:239], v[68:71], v[172:175]
    ds_read_b64_tr_b16 v[234:235], v249 offset:11520
    s_waitcnt lgkmcnt(10)
    v_mfma_f32_16x16x32_bf16 v[176:179], v[240:243], v[64:67], v[176:179]
    ds_read_b64_tr_b16 v[236:237], v249 offset:10272
    v_mfma_f32_16x16x32_bf16 v[180:183], v[240:243], v[68:71], v[180:183]
    ds_read_b64_tr_b16 v[238:239], v249 offset:11552
    s_waitcnt lgkmcnt(10)
    v_mfma_f32_16x16x32_bf16 v[184:187], v[216:219], v[64:67], v[184:187]
    ds_read_b64_tr_b16 v[240:241], v249 offset:10304
    v_mfma_f32_16x16x32_bf16 v[188:191], v[216:219], v[68:71], v[188:191]
    ds_read_b64_tr_b16 v[242:243], v249 offset:11584
    s_waitcnt lgkmcnt(10)
    v_mfma_f32_16x16x32_bf16 v[192:195], v[220:223], v[64:67], v[192:195]
    ds_read_b64_tr_b16 v[216:217], v249 offset:10336
    v_mfma_f32_16x16x32_bf16 v[196:199], v[220:223], v[68:71], v[196:199]
    ds_read_b64_tr_b16 v[218:219], v249 offset:11616
    s_waitcnt lgkmcnt(10)
    v_mfma_f32_16x16x32_bf16 v[200:203], v[224:227], v[64:67], v[200:203]
    ds_read_b64_tr_b16 v[220:221], v249 offset:10368
    v_mfma_f32_16x16x32_bf16 v[204:207], v[224:227], v[68:71], v[204:207]
    ds_read_b64_tr_b16 v[222:223], v249 offset:11648
    s_waitcnt lgkmcnt(10)
    v_mfma_f32_16x16x32_bf16 v[208:211], v[228:231], v[64:67], v[208:211]
    ds_read_b64_tr_b16 v[224:225], v249 offset:10400
    v_mfma_f32_16x16x32_bf16 v[212:215], v[228:231], v[68:71], v[212:215]
    ds_read_b64_tr_b16 v[226:227], v249 offset:11680
    s_waitcnt lgkmcnt(10)
    v_mfma_f32_16x16x32_bf16 v[144:147], v[232:235], v[72:75], v[144:147]
    ds_read_b64_tr_b16 v[228:229], v249 offset:10432
    v_mfma_f32_16x16x32_bf16 v[148:151], v[232:235], v[76:79], v[148:151]
    ds_read_b64_tr_b16 v[230:231], v249 offset:11712
    s_waitcnt lgkmcnt(10)
    v_mfma_f32_16x16x32_bf16 v[152:155], v[236:239], v[72:75], v[152:155]
    ds_read_b64_tr_b16 v[232:233], v249 offset:10464
    v_mfma_f32_16x16x32_bf16 v[156:159], v[236:239], v[76:79], v[156:159]
    ds_read_b64_tr_b16 v[234:235], v249 offset:11744
    s_waitcnt lgkmcnt(10)
    v_mfma_f32_16x16x32_bf16 v[160:163], v[240:243], v[72:75], v[160:163]
    ds_read_b64_tr_b16 v[236:237], v249 offset:10496
    v_mfma_f32_16x16x32_bf16 v[164:167], v[240:243], v[76:79], v[164:167]
    ds_read_b64_tr_b16 v[238:239], v249 offset:11776
    s_add_u32 s32, s32, 20480
    s_cmp_ge_u32 s32, 81920
    s_cselect_b32 s32, 0, s32
    s_barrier
    v_add_u32 v249, s32, v250
    s_waitcnt lgkmcnt(10)
    v_mfma_f32_16x16x32_bf16 v[168:171], v[216:219], v[72:75], v[168:171]
    ds_read_b64_tr_b16 v[240:241], v249 offset:0
    v_mfma_f32_16x16x32_bf16 v[172:175], v[216:219], v[76:79], v[172:175]
    ds_read_b64_tr_b16 v[242:243], v249 offset:1280
    s_waitcnt lgkmcnt(10)
    v_mfma_f32_16x16x32_bf16 v[176:179], v[220:223], v[72:75], v[176:179]
    ds_read_b64_tr_b16 v[216:217], v249 offset:32
    v_mfma_f32_16x16x32_bf16 v[180:183], v[220:223], v[76:79], v[180:183]
    ds_read_b64_tr_b16 v[218:219], v249 offset:1312
    s_waitcnt lgkmcnt(10)
    v_mfma_f32_16x16x32_bf16 v[184:187], v[224:227], v[72:75], v[184:187]
    ds_read_b64_tr_b16 v[220:221], v249 offset:64
    v_mfma_f32_16x16x32_bf16 v[188:191], v[224:227], v[76:79], v[188:191]
    ds_read_b64_tr_b16 v[222:223], v249 offset:1344
    s_waitcnt lgkmcnt(10)
    v_mfma_f32_16x16x32_bf16 v[192:195], v[228:231], v[72:75], v[192:195]
    ds_read_b64_tr_b16 v[224:225], v249 offset:96
    v_mfma_f32_16x16x32_bf16 v[196:199], v[228:231], v[76:79], v[196:199]
    ds_read_b64_tr_b16 v[226:227], v249 offset:1376
    s_waitcnt lgkmcnt(10)
    v_mfma_f32_16x16x32_bf16 v[200:203], v[232:235], v[72:75], v[200:203]
    ds_read_b64_tr_b16 v[228:229], v249 offset:128
    v_mfma_f32_16x16x32_bf16 v[204:207], v[232:235], v[76:79], v[204:207]
    ds_read_b64_tr_b16 v[230:231], v249 offset:1408
    s_waitcnt lgkmcnt(10)
    v_mfma_f32_16x16x32_bf16 v[208:211], v[236:239], v[72:75], v[208:211]
    ds_read_b64_tr_b16 v[232:233], v249 offset:160
    v_mfma_f32_16x16x32_bf16 v[212:215], v[236:239], v[76:79], v[212:215]
    ds_read_b64_tr_b16 v[234:235], v249 offset:1440
    s_waitcnt lgkmcnt(10)
    v_mfma_f32_16x16x32_bf16 v[144:147], v[240:243], v[80:83], v[144:147]
    ds_read_b64_tr_b16 v[236:237], v249 offset:192
    v_mfma_f32_16x16x32_bf16 v[148:151], v[240:243], v[84:87], v[148:151]
    ds_read_b64_tr_b16 v[238:239], v249 offset:1472
    s_waitcnt lgkmcnt(10)
    v_mfma_f32_16x16x32_bf16 v[152:155], v[216:219], v[80:83], v[152:155]
    ds_read_b64_tr_b16 v[240:241], v249 offset:224
    v_mfma_f32_16x16x32_bf16 v[156:159], v[216:219], v[84:87], v[156:159]
    ds_read_b64_tr_b16 v[242:243], v249 offset:1504
    s_waitcnt lgkmcnt(10)
    v_mfma_f32_16x16x32_bf16 v[160:163], v[220:223], v[80:83], v[160:163]
    ds_read_b64_tr_b16 v[216:217], v249 offset:256
    v_mfma_f32_16x16x32_bf16 v[164:167], v[220:223], v[84:87], v[164:167]
    ds_read_b64_tr_b16 v[218:219], v249 offset:1536
    s_waitcnt lgkmcnt(10)
    v_mfma_f32_16x16x32_bf16 v[168:171], v[224:227], v[80:83], v[168:171]
    ds_read_b64_tr_b16 v[220:221], v249 offset:10240
    v_mfma_f32_16x16x32_bf16 v[172:175], v[224:227], v[84:87], v[172:175]
    ds_read_b64_tr_b16 v[222:223], v249 offset:11520
    s_waitcnt lgkmcnt(10)
    v_mfma_f32_16x16x32_bf16 v[176:179], v[228:231], v[80:83], v[176:179]
    ds_read_b64_tr_b16 v[224:225], v249 offset:10272
    v_mfma_f32_16x16x32_bf16 v[180:183], v[228:231], v[84:87], v[180:183]
    ds_read_b64_tr_b16 v[226:227], v249 offset:11552
    s_waitcnt lgkmcnt(10)
    v_mfma_f32_16x16x32_bf16 v[184:187], v[232:235], v[80:83], v[184:187]
    ds_read_b64_tr_b16 v[228:229], v249 offset:10304
    v_mfma_f32_16x16x32_bf16 v[188:191], v[232:235], v[84:87], v[188:191]
    ds_read_b64_tr_b16 v[230:231], v249 offset:11584
    s_waitcnt lgkmcnt(10)
    v_mfma_f32_16x16x32_bf16 v[192:195], v[236:239], v[80:83], v[192:195]
    ds_read_b64_tr_b16 v[232:233], v249 offset:10336
    v_mfma_f32_16x16x32_bf16 v[196:199], v[236:239], v[84:87], v[196:199]
    ds_read_b64_tr_b16 v[234:235], v249 offset:11616
    s_waitcnt lgkmcnt(10)
    v_mfma_f32_16x16x32_bf16 v[200:203], v[240:243], v[80:83], v[200:203]
    ds_read_b64_tr_b16 v[236:237], v249 offset:10368
    v_mfma_f32_16x16x32_bf16 v[204:207], v[240:243], v[84:87], v[204:207]
    ds_read_b64_tr_b16 v[238:239], v249 offset:11648
    s_waitcnt lgkmcnt(10)
    v_mfma_f32_16x16x32_bf16 v[208:211], v[216:219], v[80:83], v[208:211]
    ds_read_b64_tr_b16 v[240:241], v249 offset:10400
    v_mfma_f32_16x16x32_bf16 v[212:215], v[216:219], v[84:87], v[212:215]
    ds_read_b64_tr_b16 v[242:243], v249 offset:11680
    s_waitcnt lgkmcnt(10)
    v_mfma_f32_16x16x32_bf16 v[144:147], v[220:223], v[88:91], v[144:147]
    ds_read_b64_tr_b16 v[216:217], v249 offset:10432
    v_mfma_f32_16x16x32_bf16 v[148:151], v[220:223], v[92:95], v[148:151]
    ds_read_b64_tr_b16 v[218:219], v249 offset:11712
    s_waitcnt lgkmcnt(10)
    v_mfma_f32_16x16x32_bf16 v[152:155], v[224:227], v[88:91], v[152:155]
    ds_read_b64_tr_b16 v[220:221], v249 offset:10464
    v_mfma_f32_16x16x32_bf16 v[156:159], v[224:227], v[92:95], v[156:159]
    ds_read_b64_tr_b16 v[222:223], v249 offset:11744
    s_waitcnt lgkmcnt(10)
    v_mfma_f32_16x16x32_bf16 v[160:163], v[228:231], v[88:91], v[160:163]
    ds_read_b64_tr_b16 v[224:225], v249 offset:10496
    v_mfma_f32_16x16x32_bf16 v[164:167], v[228:231], v[92:95], v[164:167]
    ds_read_b64_tr_b16 v[226:227], v249 offset:11776
    s_add_u32 s32, s32, 20480
    s_cmp_ge_u32 s32, 81920
    s_cselect_b32 s32, 0, s32
    s_barrier
    s_cmp_eq_u32 s45, 1
    s_cbranch_scc1 k1_kernel_mflag
k1_kernel_mflagback:
    v_add_u32 v249, s32, v250
    s_waitcnt lgkmcnt(10)
    v_mfma_f32_16x16x32_bf16 v[168:171], v[232:235], v[88:91], v[168:171]
    ds_read_b64_tr_b16 v[228:229], v249 offset:0
    v_mfma_f32_16x16x32_bf16 v[172:175], v[232:235], v[92:95], v[172:175]
    ds_read_b64_tr_b16 v[230:231], v249 offset:1280
    s_waitcnt lgkmcnt(10)
    v_mfma_f32_16x16x32_bf16 v[176:179], v[236:239], v[88:91], v[176:179]
    ds_read_b64_tr_b16 v[232:233], v249 offset:32
    v_mfma_f32_16x16x32_bf16 v[180:183], v[236:239], v[92:95], v[180:183]
    ds_read_b64_tr_b16 v[234:235], v249 offset:1312
    s_waitcnt lgkmcnt(10)
    v_mfma_f32_16x16x32_bf16 v[184:187], v[240:243], v[88:91], v[184:187]
    ds_read_b64_tr_b16 v[236:237], v249 offset:64
    v_mfma_f32_16x16x32_bf16 v[188:191], v[240:243], v[92:95], v[188:191]
    ds_read_b64_tr_b16 v[238:239], v249 offset:1344
    s_waitcnt lgkmcnt(10)
    v_mfma_f32_16x16x32_bf16 v[192:195], v[216:219], v[88:91], v[192:195]
    ds_read_b64_tr_b16 v[240:241], v249 offset:96
    v_mfma_f32_16x16x32_bf16 v[196:199], v[216:219], v[92:95], v[196:199]
    ds_read_b64_tr_b16 v[242:243], v249 offset:1376
    s_waitcnt lgkmcnt(10)
    v_mfma_f32_16x16x32_bf16 v[200:203], v[220:223], v[88:91], v[200:203]
    ds_read_b64_tr_b16 v[216:217], v249 offset:128
    v_mfma_f32_16x16x32_bf16 v[204:207], v[220:223], v[92:95], v[204:207]
    ds_read_b64_tr_b16 v[218:219], v249 offset:1408
    s_waitcnt lgkmcnt(10)
    v_mfma_f32_16x16x32_bf16 v[208:211], v[224:227], v[88:91], v[208:211]
    ds_read_b64_tr_b16 v[220:221], v249 offset:160
    v_mfma_f32_16x16x32_bf16 v[212:215], v[224:227], v[92:95], v[212:215]
    ds_read_b64_tr_b16 v[222:223], v249 offset:1440
    s_waitcnt lgkmcnt(10)
    v_mfma_f32_16x16x32_bf16 v[144:147], v[228:231], v[96:99], v[144:147]
    ds_read_b64_tr_b16 v[224:225], v249 offset:192
    v_mfma_f32_16x16x32_bf16 v[148:151], v[228:231], v[100:103], v[148:151]
    ds_read_b64_tr_b16 v[226:227], v249 offset:1472
    s_waitcnt lgkmcnt(10)
    v_mfma_f32_16x16x32_bf16 v[152:155], v[232:235], v[96:99], v[152:155]
    ds_read_b64_tr_b16 v[228:229], v249 offset:224
    v_mfma_f32_16x16x32_bf16 v[156:159], v[232:235], v[100:103], v[156:159]
    ds_read_b64_tr_b16 v[230:231], v249 offset:1504
    s_waitcnt lgkmcnt(10)
    v_mfma_f32_16x16x32_bf16 v[160:163], v[236:239], v[96:99], v[160:163]
    ds_read_b64_tr_b16 v[232:233], v249 offset:256
    v_mfma_f32_16x16x32_bf16 v[164:167], v[236:239], v[100:103], v[164:167]
    ds_read_b64_tr_b16 v[234:235], v249 offset:1536
    s_waitcnt lgkmcnt(10)
    v_mfma_f32_16x16x32_bf16 v[168:171], v[240:243], v[96:99], v[168:171]
    ds_read_b64_tr_b16 v[236:237], v249 offset:10240
    v_mfma_f32_16x16x32_bf16 v[172:175], v[240:243], v[100:103], v[172:175]
    ds_read_b64_tr_b16 v[238:239], v249 offset:11520
    s_waitcnt lgkmcnt(10)
    v_mfma_f32_16x16x32_bf16 v[176:179], v[216:219], v[96:99], v[176:179]
    ds_read_b64_tr_b16 v[240:241], v249 offset:10272
    v_mfma_f32_16x16x32_bf16 v[180:183], v[216:219], v[100:103], v[180:183]
    ds_read_b64_tr_b16 v[242:243], v249 offset:11552
    s_waitcnt lgkmcnt(10)
    v_mfma_f32_16x16x32_bf16 v[184:187], v[220:223], v[96:99], v[184:187]
    ds_read_b64_tr_b16 v[216:217], v249 offset:10304
    v_mfma_f32_16x16x32_bf16 v[188:191], v[220:223], v[100:103], v[188:191]
    ds_read_b64_tr_b16 v[218:219], v249 offset:11584
    s_waitcnt lgkmcnt(10)
    v_mfma_f32_16x16x32_bf16 v[192:195], v[224:227], v[96:99], v[192:195]
    ds_read_b64_tr_b16 v[220:221], v249 offset:10336
    v_mfma_f32_16x16x32_bf16 v[196:199], v[224:227], v[100:103], v[196:199]
    ds_read_b64_tr_b16 v[222:223], v249 offset:11616
    s_waitcnt lgkmcnt(10)
    v_mfma_f32_16x16x32_bf16 v[200:203], v[228:231], v[96:99], v[200:203]
    ds_read_b64_tr_b16 v[224:225], v249 offset:10368
    v_mfma_f32_16x16x32_bf16 v[204:207], v[228:231], v[100:103], v[204:207]
    ds_read_b64_tr_b16 v[226:227], v249 offset:11648
    s_waitcnt lgkmcnt(10)
    v_mfma_f32_16x16x32_bf16 v[208:211], v[232:235], v[96:99], v[208:211]
    ds_read_b64_tr_b16 v[228:229], v249 offset:10400
    v_mfma_f32_16x16x32_bf16 v[212:215], v[232:235], v[100:103], v[212:215]
    ds_read_b64_tr_b16 v[230:231], v249 offset:11680
    s_waitcnt lgkmcnt(10)
    v_mfma_f32_16x16x32_bf16 v[144:147], v[236:239], v[104:107], v[144:147]
    ds_read_b64_tr_b16 v[232:233], v249 offset:10432
    v_mfma_f32_16x16x32_bf16 v[148:151], v[236:239], v[108:111], v[148:151]
    ds_read_b64_tr_b16 v[234:235], v249 offset:11712
    s_waitcnt lgkmcnt(10)
    v_mfma_f32_16x16x32_bf16 v[152:155], v[240:243], v[104:107], v[152:155]
    ds_read_b64_tr_b16 v[236:237], v249 offset:10464
    v_mfma_f32_16x16x32_bf16 v[156:159], v[240:243], v[108:111], v[156:159]
    ds_read_b64_tr_b16 v[238:239], v249 offset:11744
    s_waitcnt lgkmcnt(10)
    v_mfma_f32_16x16x32_bf16 v[160:163], v[216:219], v[104:107], v[160:163]
    ds_read_b64_tr_b16 v[240:241], v249 offset:10496
    v_mfma_f32_16x16x32_bf16 v[164:167], v[216:219], v[108:111], v[164:167]
    ds_read_b64_tr_b16 v[242:243], v249 offset:11776
    s_add_u32 s32, s32, 20480
    s_cmp_ge_u32 s32, 81920
    s_cselect_b32 s32, 0, s32
    s_barrier
    v_add_u32 v249, s32, v250
    s_waitcnt lgkmcnt(10)
    v_mfma_f32_16x16x32_bf16 v[168:171], v[220:223], v[104:107], v[168:171]
    ds_read_b64_tr_b16 v[216:217], v249 offset:0
    v_mfma_f32_16x16x32_bf16 v[172:175], v[220:223], v[108:111], v[172:175]
    ds_read_b64_tr_b16 v[218:219], v249 offset:1280
    s_waitcnt lgkmcnt(10)
    v_mfma_f32_16x16x32_bf16 v[176:179], v[224:227], v[104:107], v[176:179]
    ds_read_b64_tr_b16 v[220:221], v249 offset:32
    v_mfma_f32_16x16x32_bf16 v[180:183], v[224:227], v[108:111], v[180:183]
    ds_read_b64_tr_b16 v[222:223], v249 offset:1312
    s_waitcnt lgkmcnt(10)
    v_mfma_f32_16x16x32_bf16 v[184:187], v[228:231], v[104:107], v[184:187]
    ds_read_b64_tr_b16 v[224:225], v249 offset:64
    v_mfma_f32_16x16x32_bf16 v[188:191], v[228:231], v[108:111], v[188:191]
    ds_read_b64_tr_b16 v[226:227], v249 offset:1344
    s_waitcnt lgkmcnt(10)
    v_mfma_f32_16x16x32_bf16 v[192:195], v[232:235], v[104:107], v[192:195]
    ds_read_b64_tr_b16 v[228:229], v249 offset:96
    v_mfma_f32_16x16x32_bf16 v[196:199], v[232:235], v[108:111], v[196:199]
    ds_read_b64_tr_b16 v[230:231], v249 offset:1376
    s_waitcnt lgkmcnt(10)
    v_mfma_f32_16x16x32_bf16 v[200:203], v[236:239], v[104:107], v[200:203]
    ds_read_b64_tr_b16 v[232:233], v249 offset:128
    v_mfma_f32_16x16x32_bf16 v[204:207], v[236:239], v[108:111], v[204:207]
    ds_read_b64_tr_b16 v[234:235], v249 offset:1408
    s_waitcnt lgkmcnt(10)
    v_mfma_f32_16x16x32_bf16 v[208:211], v[240:243], v[104:107], v[208:211]
    ds_read_b64_tr_b16 v[236:237], v249 offset:160
    v_mfma_f32_16x16x32_bf16 v[212:215], v[240:243], v[108:111], v[212:215]
    ds_read_b64_tr_b16 v[238:239], v249 offset:1440
    s_waitcnt lgkmcnt(10)
    v_mfma_f32_16x16x32_bf16 v[144:147], v[216:219], v[112:115], v[144:147]
    ds_read_b64_tr_b16 v[240:241], v249 offset:192
    v_mfma_f32_16x16x32_bf16 v[148:151], v[216:219], v[116:119], v[148:151]
    ds_read_b64_tr_b16 v[242:243], v249 offset:1472
    s_waitcnt lgkmcnt(10)
    v_mfma_f32_16x16x32_bf16 v[152:155], v[220:223], v[112:115], v[152:155]
    ds_read_b64_tr_b16 v[216:217], v249 offset:224
    v_mfma_f32_16x16x32_bf16 v[156:159], v[220:223], v[116:119], v[156:159]
    ds_read_b64_tr_b16 v[218:219], v249 offset:1504
    s_waitcnt lgkmcnt(10)
    v_mfma_f32_16x16x32_bf16 v[160:163], v[224:227], v[112:115], v[160:163]
    ds_read_b64_tr_b16 v[220:221], v249 offset:256
    v_mfma_f32_16x16x32_bf16 v[164:167], v[224:227], v[116:119], v[164:167]
    ds_read_b64_tr_b16 v[222:223], v249 offset:1536
    s_waitcnt lgkmcnt(10)
    v_mfma_f32_16x16x32_bf16 v[168:171], v[228:231], v[112:115], v[168:171]
    ds_read_b64_tr_b16 v[224:225], v249 offset:10240
    v_mfma_f32_16x16x32_bf16 v[172:175], v[228:231], v[116:119], v[172:175]
    ds_read_b64_tr_b16 v[226:227], v249 offset:11520
    s_waitcnt lgkmcnt(10)
    v_mfma_f32_16x16x32_bf16 v[176:179], v[232:235], v[112:115], v[176:179]
    ds_read_b64_tr_b16 v[228:229], v249 offset:10272
    v_mfma_f32_16x16x32_bf16 v[180:183], v[232:235], v[116:119], v[180:183]
    ds_read_b64_tr_b16 v[230:231], v249 offset:11552
    s_waitcnt lgkmcnt(10)
    v_mfma_f32_16x16x32_bf16 v[184:187], v[236:239], v[112:115], v[184:187]
    ds_read_b64_tr_b16 v[232:233], v249 offset:10304
    v_mfma_f32_16x16x32_bf16 v[188:191], v[236:239], v[116:119], v[188:191]
    ds_read_b64_tr_b16 v[234:235], v249 offset:11584
    s_waitcnt lgkmcnt(10)
    v_mfma_f32_16x16x32_bf16 v[192:195], v[240:243], v[112:115], v[192:195]
    ds_read_b64_tr_b16 v[236:237], v249 offset:10336
    v_mfma_f32_16x16x32_bf16 v[196:199], v[240:243], v[116:119], v[196:199]
    ds_read_b64_tr_b16 v[238:239], v249 offset:11616
    s_waitcnt lgkmcnt(10)
    v_mfma_f32_16x16x32_bf16 v[200:203], v[216:219], v[112:115], v[200:203]
    ds_read_b64_tr_b16 v[240:241], v249 offset:10368
    v_mfma_f32_16x16x32_bf16 v[204:207], v[216:219], v[116:119], v[204:207]
    ds_read_b64_tr_b16 v[242:243], v249 offset:11648
    s_waitcnt lgkmcnt(10)
    v_mfma_f32_16x16x32_bf16 v[208:211], v[220:223], v[112:115], v[208:211]
    ds_read_b64_tr_b16 v[216:217], v249 offset:10400
    v_mfma_f32_16x16x32_bf16 v[212:215], v[220:223], v[116:119], v[212:215]
    ds_read_b64_tr_b16 v[218:219], v249 offset:11680
    s_waitcnt lgkmcnt(10)
    v_mfma_f32_16x16x32_bf16 v[144:147], v[224:227], v[120:123], v[144:147]
    ds_read_b64_tr_b16 v[220:221], v249 offset:10432
    v_mfma_f32_16x16x32_bf16 v[148:151], v[224:227], v[124:127], v[148:151]
    ds_read_b64_tr_b16 v[222:223], v249 offset:11712
    s_waitcnt lgkmcnt(10)
    v_mfma_f32_16x16x32_bf16 v[152:155], v[228:231], v[120:123], v[152:155]
    ds_read_b64_tr_b16 v[224:225], v249 offset:10464
    v_mfma_f32_16x16x32_bf16 v[156:159], v[228:231], v[124:127], v[156:159]
    ds_read_b64_tr_b16 v[226:227], v249 offset:11744
    s_waitcnt lgkmcnt(10)
    v_mfma_f32_16x16x32_bf16 v[160:163], v[232:235], v[120:123], v[160:163]
    ds_read_b64_tr_b16 v[228:229], v249 offset:10496
    v_mfma_f32_16x16x32_bf16 v[164:167], v[232:235], v[124:127], v[164:167]
    ds_read_b64_tr_b16 v[230:231], v249 offset:11776
    s_add_u32 s32, s32, 20480
    s_cmp_ge_u32 s32, 81920
    s_cselect_b32 s32, 0, s32
    s_barrier
    v_add_u32 v249, s32, v250
    s_waitcnt lgkmcnt(10)
    v_mfma_f32_16x16x32_bf16 v[168:171], v[236:239], v[120:123], v[168:171]
    ds_read_b64_tr_b16 v[232:233], v249 offset:0
    v_mfma_f32_16x16x32_bf16 v[172:175], v[236:239], v[124:127], v[172:175]
    ds_read_b64_tr_b16 v[234:235], v249 offset:1280
    s_waitcnt lgkmcnt(10)
    v_mfma_f32_16x16x32_bf16 v[176:179], v[240:243], v[120:123], v[176:179]
    ds_read_b64_tr_b16 v[236:237], v249 offset:32
    v_mfma_f32_16x16x32_bf16 v[180:183], v[240:243], v[124:127], v[180:183]
    ds_read_b64_tr_b16 v[238:239], v249 offset:1312
    s_waitcnt lgkmcnt(10)
    v_mfma_f32_16x16x32_bf16 v[184:187], v[216:219], v[120:123], v[184:187]
    ds_read_b64_tr_b16 v[240:241], v249 offset:64
    v_mfma_f32_16x16x32_bf16 v[188:191], v[216:219], v[124:127], v[188:191]
    ds_read_b64_tr_b16 v[242:243], v249 offset:1344
    s_waitcnt lgkmcnt(10)
    v_mfma_f32_16x16x32_bf16 v[192:195], v[220:223], v[120:123], v[192:195]
    ds_read_b64_tr_b16 v[216:217], v249 offset:96
    v_mfma_f32_16x16x32_bf16 v[196:199], v[220:223], v[124:127], v[196:199]
    ds_read_b64_tr_b16 v[218:219], v249 offset:1376
    s_waitcnt lgkmcnt(10)
    v_mfma_f32_16x16x32_bf16 v[200:203], v[224:227], v[120:123], v[200:203]
    ds_read_b64_tr_b16 v[220:221], v249 offset:128
    v_mfma_f32_16x16x32_bf16 v[204:207], v[224:227], v[124:127], v[204:207]
    ds_read_b64_tr_b16 v[222:223], v249 offset:1408
    s_waitcnt lgkmcnt(10)
    v_mfma_f32_16x16x32_bf16 v[208:211], v[228:231], v[120:123], v[208:211]
    ds_read_b64_tr_b16 v[224:225], v249 offset:160
    v_mfma_f32_16x16x32_bf16 v[212:215], v[228:231], v[124:127], v[212:215]
    ds_read_b64_tr_b16 v[226:227], v249 offset:1440
    s_waitcnt lgkmcnt(10)
    v_mfma_f32_16x16x32_bf16 v[144:147], v[232:235], v[128:131], v[144:147]
    ds_read_b64_tr_b16 v[228:229], v249 offset:192
    v_mfma_f32_16x16x32_bf16 v[148:151], v[232:235], v[132:135], v[148:151]
    ds_read_b64_tr_b16 v[230:231], v249 offset:1472
    s_waitcnt lgkmcnt(10)
    v_mfma_f32_16x16x32_bf16 v[152:155], v[236:239], v[128:131], v[152:155]
    ds_read_b64_tr_b16 v[232:233], v249 offset:224
    v_mfma_f32_16x16x32_bf16 v[156:159], v[236:239], v[132:135], v[156:159]
    ds_read_b64_tr_b16 v[234:235], v249 offset:1504
    s_waitcnt lgkmcnt(10)
    v_mfma_f32_16x16x32_bf16 v[160:163], v[240:243], v[128:131], v[160:163]
    ds_read_b64_tr_b16 v[236:237], v249 offset:256
    v_mfma_f32_16x16x32_bf16 v[164:167], v[240:243], v[132:135], v[164:167]
    ds_read_b64_tr_b16 v[238:239], v249 offset:1536
    s_waitcnt lgkmcnt(10)
    v_mfma_f32_16x16x32_bf16 v[168:171], v[216:219], v[128:131], v[168:171]
    ds_read_b64_tr_b16 v[240:241], v249 offset:10240
    v_mfma_f32_16x16x32_bf16 v[172:175], v[216:219], v[132:135], v[172:175]
    ds_read_b64_tr_b16 v[242:243], v249 offset:11520
    s_waitcnt lgkmcnt(10)
    v_mfma_f32_16x16x32_bf16 v[176:179], v[220:223], v[128:131], v[176:179]
    ds_read_b64_tr_b16 v[216:217], v249 offset:10272
    v_mfma_f32_16x16x32_bf16 v[180:183], v[220:223], v[132:135], v[180:183]
    ds_read_b64_tr_b16 v[218:219], v249 offset:11552
    s_waitcnt lgkmcnt(10)
    v_mfma_f32_16x16x32_bf16 v[184:187], v[224:227], v[128:131], v[184:187]
    ds_read_b64_tr_b16 v[220:221], v249 offset:10304
    v_mfma_f32_16x16x32_bf16 v[188:191], v[224:227], v[132:135], v[188:191]
    ds_read_b64_tr_b16 v[222:223], v249 offset:11584
    s_waitcnt lgkmcnt(10)
    v_mfma_f32_16x16x32_bf16 v[192:195], v[228:231], v[128:131], v[192:195]
    ds_read_b64_tr_b16 v[224:225], v249 offset:10336
    v_mfma_f32_16x16x32_bf16 v[196:199], v[228:231], v[132:135], v[196:199]
    ds_read_b64_tr_b16 v[226:227], v249 offset:11616
    s_waitcnt lgkmcnt(10)
    v_mfma_f32_16x16x32_bf16 v[200:203], v[232:235], v[128:131], v[200:203]
    ds_read_b64_tr_b16 v[228:229], v249 offset:10368
    v_mfma_f32_16x16x32_bf16 v[204:207], v[232:235], v[132:135], v[204:207]
    ds_read_b64_tr_b16 v[230:231], v249 offset:11648
    s_waitcnt lgkmcnt(10)
    v_mfma_f32_16x16x32_bf16 v[208:211], v[236:239], v[128:131], v[208:211]
    ds_read_b64_tr_b16 v[232:233], v249 offset:10400
    v_mfma_f32_16x16x32_bf16 v[212:215], v[236:239], v[132:135], v[212:215]
    ds_read_b64_tr_b16 v[234:235], v249 offset:11680
    s_waitcnt lgkmcnt(10)
    v_mfma_f32_16x16x32_bf16 v[144:147], v[240:243], v[136:139], v[144:147]
    ds_read_b64_tr_b16 v[236:237], v249 offset:10432
    v_mfma_f32_16x16x32_bf16 v[148:151], v[240:243], v[140:143], v[148:151]
    ds_read_b64_tr_b16 v[238:239], v249 offset:11712
    s_waitcnt lgkmcnt(10)
    v_mfma_f32_16x16x32_bf16 v[152:155], v[216:219], v[136:139], v[152:155]
    ds_read_b64_tr_b16 v[240:241], v249 offset:10464
    v_mfma_f32_16x16x32_bf16 v[156:159], v[216:219], v[140:143], v[156:159]
    ds_read_b64_tr_b16 v[242:243], v249 offset:11744
    s_waitcnt lgkmcnt(10)
    v_mfma_f32_16x16x32_bf16 v[160:163], v[220:223], v[136:139], v[160:163]
    ds_read_b64_tr_b16 v[216:217], v249 offset:10496
    v_mfma_f32_16x16x32_bf16 v[164:167], v[220:223], v[140:143], v[164:167]
    ds_read_b64_tr_b16 v[218:219], v249 offset:11776
    s_add_u32 s32, s32, 20480
    s_cmp_ge_u32 s32, 81920
    s_cselect_b32 s32, 0, s32
    s_barrier
    s_waitcnt lgkmcnt(10)
    v_mfma_f32_16x16x32_bf16 v[168:171], v[224:227], v[136:139], v[168:171]
    v_mfma_f32_16x16x32_bf16 v[172:175], v[224:227], v[140:143], v[172:175]
    s_waitcnt lgkmcnt(8)
    v_mfma_f32_16x16x32_bf16 v[176:179], v[228:231], v[136:139], v[176:179]
    v_mfma_f32_16x16x32_bf16 v[180:183], v[228:231], v[140:143], v[180:183]
    s_waitcnt lgkmcnt(6)
    v_mfma_f32_16x16x32_bf16 v[184:187], v[232:235], v[136:139], v[184:187]
    v_mfma_f32_16x16x32_bf16 v[188:191], v[232:235], v[140:143], v[188:191]
    s_waitcnt lgkmcnt(4)
    v_mfma_f32_16x16x32_bf16 v[192:195], v[236:239], v[136:139], v[192:195]
    v_mfma_f32_16x16x32_bf16 v[196:199], v[236:239], v[140:143], v[196:199]
    s_waitcnt lgkmcnt(2)
    v_mfma_f32_16x16x32_bf16 v[200:203], v[240:243], v[136:139], v[200:203]
    v_mfma_f32_16x16x32_bf16 v[204:207], v[240:243], v[140:143], v[204:207]
    s_waitcnt lgkmcnt(0)
    v_mfma_f32_16x16x32_bf16 v[208:211], v[216:219], v[136:139], v[208:211]
    v_mfma_f32_16x16x32_bf16 v[212:215], v[216:219], v[140:143], v[212:215]
    s_nop 7
    s_setpc_b64 s[50:51]
.p2align 6
k1_kernel_epi_z2_side:
    v_bfe_u32 v252, v251, 4, 4
    v_lshrrev_b32 v253, 8, v251
    v_mul_u32_u24 v249, 296, v252
    v_lshl_add_u32 v249, v253, 3, v249
    s_mul_i32 s33, s24, 9472
    s_add_u32 s33, s33, s41
    v_add_u32 v249, s33, v249
    v_mov_b32 v240, s42
    v_mov_b32 v241, s42
    v_mov_b32 v242, s42
    v_mov_b32 v243, s42
    v_fma_f32 v216, -v144, v144, s46
    v_fma_f32 v217, -v145, v145, s46
    v_fma_f32 v218, -v146, v146, s46
    v_fma_f32 v219, -v147, v147, s46
    v_fma_f32 v220, -v148, v148, s46
    v_fma_f32 v221, -v149, v149, s46
    v_fma_f32 v222, -v150, v150, s46
    v_fma_f32 v223, -v151, v151, s46
    v_mul_f32 v216, v144, v216
    v_mul_f32 v217, v145, v217
    v_mul_f32 v218, v146, v218
    v_mul_f32 v219, v147, v219
    v_mul_f32 v220, v148, v220
    v_mul_f32 v221, v149, v221
    v_mul_f32 v222, v150, v222
    v_mul_f32 v223, v151, v223
    v_exp_f32 v216, v216
    v_exp_f32 v217, v217
    v_add_f32 v216, 1.0, v216
    v_exp_f32 v218, v218
    v_add_f32 v217, 1.0, v217
    v_exp_f32 v219, v219
    v_add_f32 v218, 1.0, v218
    v_exp_f32 v220, v220
    v_add_f32 v219, 1.0, v219
    v_exp_f32 v221, v221
    v_add_f32 v220, 1.0, v220
    v_exp_f32 v222, v222
    v_add_f32 v221, 1.0, v221
    v_exp_f32 v223, v223
    v_add_f32 v222, 1.0, v222
    v_rcp_f32 v216, v216
    v_add_f32 v223, 1.0, v223
    v_rcp_f32 v217, v217
    v_mul_f32 v144, v144, v216
    v_rcp_f32 v218, v218
    v_mul_f32 v145, v145, v217
    v_rcp_f32 v219, v219
    v_mul_f32 v146, v146, v218
    v_rcp_f32 v220, v220
    v_mul_f32 v147, v147, v219
    v_rcp_f32 v221, v221
    v_mul_f32 v148, v148, v220
    v_rcp_f32 v222, v222
    v_mul_f32 v149, v149, v221
    v_rcp_f32 v223, v223
    v_mul_f32 v150, v150, v222
    s_nop 0
    v_mul_f32 v151, v151, v223
    v_cvt_pk_bf16_f32 v144, v144, v145
    v_cvt_pk_bf16_f32 v145, v146, v147
    v_cvt_pk_bf16_f32 v148, v148, v149
    v_cvt_pk_bf16_f32 v149, v150, v151
    s_barrier
    s_add_u32 m0, s31, s43
    s_add_u32 s31, s31, 20480
    buffer_load_dwordx4 v244, s[8:11], s30 offen lds
    v_fma_f32 v216, -v152, v152, s46
    v_fma_f32 v217, -v153, v153, s46
    v_fma_f32 v218, -v154, v154, s46
    v_fma_f32 v219, -v155, v155, s46
    v_fma_f32 v220, -v156, v156, s46
    v_fma_f32 v221, -v157, v157, s46
    v_fma_f32 v222, -v158, v158, s46
    v_fma_f32 v223, -v159, v159, s46
    v_mul_f32 v216, v152, v216
    v_mul_f32 v217, v153, v217
    buffer_load_dwordx4 v245, s[8:11], s30 offen offset:1024 lds
    v_mul_f32 v218, v154, v218
    v_mul_f32 v219, v155, v219
    v_mul_f32 v220, v156, v220
    v_mul_f32 v221, v157, v221
    v_mul_f32 v222, v158, v222
    v_mul_f32 v223, v159, v223
    v_exp_f32 v216, v216
    v_exp_f32 v217, v217
    v_add_f32 v216, 1.0, v216
    buffer_load_dwordx4 v246, s[8:11], s30 offen offset:2048 lds
    v_exp_f32 v218, v218
    v_add_f32 v217, 1.0, v217
    v_exp_f32 v219, v219
    v_add_f32 v218, 1.0, v218
    v_exp_f32 v220, v220
    v_add_f32 v219, 1.0, v219
    v_exp_f32 v221, v221
    v_add_f32 v220, 1.0, v220
    v_exp_f32 v222, v222
    buffer_load_dwordx4 v247, s[8:11], s30 offen offset:3072 lds
    v_add_f32 v221, 1.0, v221
    v_exp_f32 v223, v223
    v_add_f32 v222, 1.0, v222
    v_rcp_f32 v216, v216
    v_add_f32 v223, 1.0, v223
    v_rcp_f32 v217, v217
    v_mul_f32 v152, v152, v216
    v_rcp_f32 v218, v218
    v_mul_f32 v153, v153, v217
    s_add_u32 m0, m0, 4096
    s_cmp_ge_u32 s31, 81920
    s_cselect_b32 s31, 0, s31
    buffer_load_dwordx4 v248, s[8:11], s30 offen lds
    s_add_u32 s30, s30, s26
    v_rcp_f32 v219, v219
    v_mul_f32 v154, v154, v218
    v_rcp_f32 v220, v220
    v_mul_f32 v155, v155, v219
    v_rcp_f32 v221, v221
    v_mul_f32 v156, v156, v220
    v_rcp_f32 v222, v222
    v_mul_f32 v157, v157, v221
    v_rcp_f32 v223, v223
    buffer_load_dwordx4 v[252:255], v251, s[56:59], s39 offen
    s_add_u32 s39, s39, 4096
    v_mul_f32 v158, v158, v222
    s_nop 0
    v_mul_f32 v159, v159, v223
    v_cvt_pk_bf16_f32 v146, v152, v153
    v_cvt_pk_bf16_f32 v147, v154, v155
    v_cvt_pk_bf16_f32 v150, v156, v157
    v_cvt_pk_bf16_f32 v151, v158, v159
    v_mfma_f32_16x16x32_bf16 v[224:227], v[240:243], v[144:147], 0
    v_mfma_f32_16x16x32_bf16 v[228:231], v[144:147], v[144:147], 0
    v_mfma_f32_16x16x32_bf16 v[232:235], v[240:243], v[148:151], 0
    v_mfma_f32_16x16x32_bf16 v[236:239], v[148:151], v[148:151], 0
    s_barrier
    s_add_u32 m0, s31, s43
    s_add_u32 s31, s31, 20480
    buffer_load_dwordx4 v244, s[8:11], s30 offen lds
    v_fma_f32 v216, -v160, v160, s46
    v_fma_f32 v217, -v161, v161, s46
    v_fma_f32 v218, -v162, v162, s46
    v_fma_f32 v219, -v163, v163, s46
    v_fma_f32 v220, -v164, v164, s46
    v_fma_f32 v221, -v165, v165, s46
    v_fma_f32 v222, -v166, v166, s46
    v_fma_f32 v223, -v167, v167, s46
    v_mul_f32 v216, v160, v216
    buffer_load_dwordx4 v245, s[8:11], s30 offen offset:1024 lds
    v_mul_f32 v217, v161, v217
    v_mul_f32 v218, v162, v218
    v_mul_f32 v219, v163, v219
    v_mul_f32 v220, v164, v220
    v_mul_f32 v221, v165, v221
    v_mul_f32 v222, v166, v222
    v_mul_f32 v223, v167, v223
    v_exp_f32 v216, v216
    buffer_load_dwordx4 v246, s[8:11], s30 offen offset:2048 lds
    v_exp_f32 v217, v217
    v_add_f32 v216, 1.0, v216
    v_exp_f32 v218, v218
    v_add_f32 v217, 1.0, v217
    v_exp_f32 v219, v219
    v_add_f32 v218, 1.0, v218
    v_exp_f32 v220, v220
    v_add_f32 v219, 1.0, v219
    v_exp_f32 v221, v221
    buffer_load_dwordx4 v247, s[8:11], s30 offen offset:3072 lds
    v_add_f32 v220, 1.0, v220
    v_exp_f32 v222, v222
    v_add_f32 v221, 1.0, v221
    v_exp_f32 v223, v223
    v_add_f32 v222, 1.0, v222
    v_rcp_f32 v216, v216
    v_add_f32 v223, 1.0, v223
    v_rcp_f32 v217, v217
    s_add_u32 m0, m0, 4096
    s_cmp_ge_u32 s31, 81920
    s_cselect_b32 s31, 0, s31
    buffer_load_dwordx4 v248, s[8:11], s30 offen lds
    s_add_u32 s30, s30, s26
    v_mul_f32 v160, v160, v216
    v_rcp_f32 v218, v218
    v_mul_f32 v161, v161, v217
    v_rcp_f32 v219, v219
    v_mul_f32 v162, v162, v218
    v_rcp_f32 v220, v220
    v_mul_f32 v163, v163, v219
    v_rcp_f32 v221, v221
    buffer_load_dwordx4 v[252:255], v251, s[56:59], s39 offen
    s_add_u32 s39, s39, 4096
    v_mul_f32 v164, v164, v220
    v_rcp_f32 v222, v222
    v_mul_f32 v165, v165, v221
    v_rcp_f32 v223, v223
    v_mul_f32 v166, v166, v222
    s_nop 0
    v_mul_f32 v167, v167, v223
    v_cvt_pk_bf16_f32 v160, v160, v161
    v_cvt_pk_bf16_f32 v161, v162, v163
    v_cvt_pk_bf16_f32 v164, v164, v165
    v_cvt_pk_bf16_f32 v165, v166, v167
    s_waitcnt vmcnt(7)
    s_barrier
    s_add_u32 m0, s31, s43
    s_add_u32 s31, s31, 20480
    buffer_load_dwordx4 v244, s[8:11], s30 offen lds
    v_fma_f32 v216, -v168, v168, s46
    v_fma_f32 v217, -v169, v169, s46
    v_fma_f32 v218, -v170, v170, s46
    v_fma_f32 v219, -v171, v171, s46
    v_fma_f32 v220, -v172, v172, s46
    v_fma_f32 v221, -v173, v173, s46
    v_fma_f32 v222, -v174, v174, s46
    v_fma_f32 v223, -v175, v175, s46
    v_mul_f32 v216, v168, v216
    v_mul_f32 v217, v169, v217
    buffer_load_dwordx4 v245, s[8:11], s30 offen offset:1024 lds
    v_mul_f32 v218, v170, v218
    v_mul_f32 v219, v171, v219
    v_mul_f32 v220, v172, v220
    v_mul_f32 v221, v173, v221
    v_mul_f32 v222, v174, v222
    v_mul_f32 v223, v175, v223
    v_exp_f32 v216, v216
    v_exp_f32 v217, v217
    v_add_f32 v216, 1.0, v216
    buffer_load_dwordx4 v246, s[8:11], s30 offen offset:2048 lds
    v_exp_f32 v218, v218
    v_add_f32 v217, 1.0, v217
    v_exp_f32 v219, v219
    v_add_f32 v218, 1.0, v218
    v_exp_f32 v220, v220
    v_add_f32 v219, 1.0, v219
    v_exp_f32 v221, v221
    v_add_f32 v220, 1.0, v220
    v_exp_f32 v222, v222
    buffer_load_dwordx4 v247, s[8:11], s30 offen offset:3072 lds
    v_add_f32 v221, 1.0, v221
    v_exp_f32 v223, v223
    v_add_f32 v222, 1.0, v222
    v_rcp_f32 v216, v216
    v_add_f32 v223, 1.0, v223
    v_rcp_f32 v217, v217
    v_mul_f32 v168, v168, v216
    v_rcp_f32 v218, v218
    v_mul_f32 v169, v169, v217
    s_add_u32 m0, m0, 4096
    s_cmp_ge_u32 s31, 81920
    s_cselect_b32 s31, 0, s31
    buffer_load_dwordx4 v248, s[8:11], s30 offen lds
    s_add_u32 s30, s30, s26
    v_rcp_f32 v219, v219
    v_mul_f32 v170, v170, v218
    v_rcp_f32 v220, v220
    v_mul_f32 v171, v171, v219
    v_rcp_f32 v221, v221
    v_mul_f32 v172, v172, v220
    v_rcp_f32 v222, v222
    v_mul_f32 v173, v173, v221
    v_rcp_f32 v223, v223
    buffer_load_dwordx4 v[252:255], v251, s[56:59], s39 offen
    s_add_u32 s39, s39, 4096
    v_mul_f32 v174, v174, v222
    s_nop 0
    v_mul_f32 v175, v175, v223
    v_cvt_pk_bf16_f32 v162, v168, v169
    v_cvt_pk_bf16_f32 v163, v170, v171
    v_cvt_pk_bf16_f32 v166, v172, v173
    v_cvt_pk_bf16_f32 v167, v174, v175
    v_mfma_f32_16x16x32_bf16 v[224:227], v[240:243], v[160:163], v[224:227]
    v_mfma_f32_16x16x32_bf16 v[228:231], v[160:163], v[160:163], v[228:231]
    v_mfma_f32_16x16x32_bf16 v[232:235], v[240:243], v[164:167], v[232:235]
    v_mfma_f32_16x16x32_bf16 v[236:239], v[164:167], v[164:167], v[236:239]
    s_waitcnt vmcnt(7)
    s_barrier
    s_add_u32 m0, s31, s43
    s_add_u32 s31, s31, 20480
    buffer_load_dwordx4 v244, s[8:11], s30 offen lds
    v_fma_f32 v216, -v176, v176, s46
    v_fma_f32 v217, -v177, v177, s46
    v_fma_f32 v218, -v178, v178, s46
    v_fma_f32 v219, -v179, v179, s46
    v_fma_f32 v220, -v180, v180, s46
    v_fma_f32 v221, -v181, v181, s46
    v_fma_f32 v222, -v182, v182, s46
    v_fma_f32 v223, -v183, v183, s46
    v_mul_f32 v216, v176, v216
    buffer_load_dwordx4 v245, s[8:11], s30 offen offset:1024 lds
    v_mul_f32 v217, v177, v217
    v_mul_f32 v218, v178, v218
    v_mul_f32 v219, v179, v219
    v_mul_f32 v220, v180, v220
    v_mul_f32 v221, v181, v221
    v_mul_f32 v222, v182, v222
    v_mul_f32 v223, v183, v223
    v_exp_f32 v216, v216
    buffer_load_dwordx4 v246, s[8:11], s30 offen offset:2048 lds
    v_exp_f32 v217, v217
    v_add_f32 v216, 1.0, v216
    v_exp_f32 v218, v218
    v_add_f32 v217, 1.0, v217
    v_exp_f32 v219, v219
    v_add_f32 v218, 1.0, v218
    v_exp_f32 v220, v220
    v_add_f32 v219, 1.0, v219
    v_exp_f32 v221, v221
    buffer_load_dwordx4 v247, s[8:11], s30 offen offset:3072 lds
    v_add_f32 v220, 1.0, v220
    v_exp_f32 v222, v222
    v_add_f32 v221, 1.0, v221
    v_exp_f32 v223, v223
    v_add_f32 v222, 1.0, v222
    v_rcp_f32 v216, v216
    v_add_f32 v223, 1.0, v223
    v_rcp_f32 v217, v217
    s_add_u32 m0, m0, 4096
    s_cmp_ge_u32 s31, 81920
    s_cselect_b32 s31, 0, s31
    buffer_load_dwordx4 v248, s[8:11], s30 offen lds
    s_add_u32 s30, s30, s26
    v_mul_f32 v176, v176, v216
    v_rcp_f32 v218, v218
    v_mul_f32 v177, v177, v217
    v_rcp_f32 v219, v219
    v_mul_f32 v178, v178, v218
    v_rcp_f32 v220, v220
    v_mul_f32 v179, v179, v219
    v_rcp_f32 v221, v221
    s_mov_b32 s56, s62
    s_and_b32 s57, s63, 0xffff
    s_mov_b32 s58, 663552
    s_lshl_b32 s39, s2, 12
    s_lshl_b32 s37, s24, 10
    s_add_u32 s39, s39, s37
    buffer_load_dwordx4 v[252:255], v251, s[56:59], s39 offen
    s_add_u32 s39, s39, 4096
    v_mul_f32 v180, v180, v220
    v_rcp_f32 v222, v222
    v_mul_f32 v181, v181, v221
    v_rcp_f32 v223, v223
    v_mul_f32 v182, v182, v222
    s_nop 0
    v_mul_f32 v183, v183, v223
    v_cvt_pk_bf16_f32 v176, v176, v177
    v_cvt_pk_bf16_f32 v177, v178, v179
    v_cvt_pk_bf16_f32 v180, v180, v181
    v_cvt_pk_bf16_f32 v181, v182, v183
    s_waitcnt vmcnt(7)
    s_barrier
    s_add_u32 m0, s31, s43
    s_add_u32 s31, s31, 20480
    buffer_load_dwordx4 v244, s[8:11], s30 offen lds
    v_mov_b32 v216, 157696
    ds_read_b32 v216, v216
    s_waitcnt lgkmcnt(0)
    v_readfirstlane_b32 s84, v216
    s_mul_i32 s85, s84, 0x9e3779b1
    s_xor_b32 s85, s85, 0x5bd1e995
    v_fma_f32 v216, -v184, v184, s46
    v_fma_f32 v217, -v185, v185, s46
    v_fma_f32 v218, -v186, v186, s46
    v_fma_f32 v219, -v187, v187, s46
    v_fma_f32 v220, -v188, v188, s46
    v_fma_f32 v221, -v189, v189, s46
    v_fma_f32 v222, -v190, v190, s46
    v_fma_f32 v223, -v191, v191, s46
    v_mul_f32 v216, v184, v216
    v_mul_f32 v217, v185, v217
    v_mul_f32 v218, v186, v218
    buffer_load_dwordx4 v245, s[8:11], s30 offen offset:1024 lds
    v_mul_f32 v219, v187, v219
    v_mul_f32 v220, v188, v220
    v_mul_f32 v221, v189, v221
    v_mul_f32 v222, v190, v222
    v_mul_f32 v223, v191, v223
    v_exp_f32 v216, v216
    v_exp_f32 v217, v217
    v_add_f32 v216, 1.0, v216
    v_exp_f32 v218, v218
    v_add_f32 v217, 1.0, v217
    v_exp_f32 v219, v219
    buffer_load_dwordx4 v246, s[8:11], s30 offen offset:2048 lds
    v_add_f32 v218, 1.0, v218
    v_exp_f32 v220, v220
    v_add_f32 v219, 1.0, v219
    v_exp_f32 v221, v221
    v_add_f32 v220, 1.0, v220
    v_exp_f32 v222, v222
    v_add_f32 v221, 1.0, v221
    v_exp_f32 v223, v223
    v_add_f32 v222, 1.0, v222
    v_rcp_f32 v216, v216
    v_add_f32 v223, 1.0, v223
    buffer_load_dwordx4 v247, s[8:11], s30 offen offset:3072 lds
    v_rcp_f32 v217, v217
    v_mul_f32 v184, v184, v216
    v_rcp_f32 v218, v218
    v_mul_f32 v185, v185, v217
    v_rcp_f32 v219, v219
    v_mul_f32 v186, v186, v218
    v_rcp_f32 v220, v220
    v_mul_f32 v187, v187, v219
    v_rcp_f32 v221, v221
    v_mul_f32 v188, v188, v220
    v_rcp_f32 v222, v222
    s_add_u32 m0, m0, 4096
    s_cmp_ge_u32 s31, 81920
    s_cselect_b32 s31, 0, s31
    buffer_load_dwordx4 v248, s[8:11], s30 offen lds
    s_add_u32 s30, s30, s26
    v_mul_f32 v189, v189, v221
    v_rcp_f32 v223, v223
    v_mul_f32 v190, v190, v222
    s_nop 0
    v_mul_f32 v191, v191, v223
    v_cvt_pk_bf16_f32 v178, v184, v185
    v_cvt_pk_bf16_f32 v179, v186, v187
    v_cvt_pk_bf16_f32 v182, v188, v189
    v_cvt_pk_bf16_f32 v183, v190, v191
    v_mfma_f32_16x16x32_bf16 v[224:227], v[240:243], v[176:179], v[224:227]
    v_mfma_f32_16x16x32_bf16 v[228:231], v[176:179], v[176:179], v[228:231]
    v_mfma_f32_16x16x32_bf16 v[232:235], v[240:243], v[180:183], v[232:235]
    v_mfma_f32_16x16x32_bf16 v[236:239], v[180:183], v[180:183], v[236:239]
    s_waitcnt vmcnt(6)
    s_barrier
    s_add_u32 m0, s31, s43
    s_add_u32 s31, s31, 20480
    buffer_load_dwordx4 v244, s[8:11], s30 offen lds
    v_fma_f32 v216, -v192, v192, s46
    v_fma_f32 v217, -v193, v193, s46
    v_fma_f32 v218, -v194, v194, s46
    v_fma_f32 v219, -v195, v195, s46
    v_fma_f32 v220, -v196, v196, s46
    v_fma_f32 v221, -v197, v197, s46
    v_fma_f32 v222, -v198, v198, s46
    v_fma_f32 v223, -v199, v199, s46
    v_mul_f32 v216, v192, v216
    v_mul_f32 v217, v193, v217
    v_mul_f32 v218, v194, v218
    buffer_load_dwordx4 v245, s[8:11], s30 offen offset:1024 lds
    v_mul_f32 v219, v195, v219
    v_mul_f32 v220, v196, v220
    v_mul_f32 v221, v197, v221
    v_mul_f32 v222, v198, v222
    v_mul_f32 v223, v199, v223
    v_exp_f32 v216, v216
    v_exp_f32 v217, v217
    v_add_f32 v216, 1.0, v216
    v_exp_f32 v218, v218
    v_add_f32 v217, 1.0, v217
    buffer_load_dwordx4 v246, s[8:11], s30 offen offset:2048 lds
    v_exp_f32 v219, v219
    v_add_f32 v218, 1.0, v218
    v_exp_f32 v220, v220
    v_add_f32 v219, 1.0, v219
    v_exp_f32 v221, v221
    v_add_f32 v220, 1.0, v220
    v_exp_f32 v222, v222
    v_add_f32 v221, 1.0, v221
    v_exp_f32 v223, v223
    v_add_f32 v222, 1.0, v222
    buffer_load_dwordx4 v247, s[8:11], s30 offen offset:3072 lds
    v_rcp_f32 v216, v216
    v_add_f32 v223, 1.0, v223
    v_rcp_f32 v217, v217
    v_mul_f32 v192, v192, v216
    v_rcp_f32 v218, v218
    v_mul_f32 v193, v193, v217
    v_rcp_f32 v219, v219
    v_mul_f32 v194, v194, v218
    v_rcp_f32 v220, v220
    v_mul_f32 v195, v195, v219
    s_add_u32 m0, m0, 4096
    s_cmp_ge_u32 s31, 81920
    s_cselect_b32 s31, 0, s31
    buffer_load_dwordx4 v248, s[8:11], s30 offen lds
    s_add_u32 s30, s30, s26
    v_rcp_f32 v221, v221
    v_mul_f32 v196, v196, v220
    v_rcp_f32 v222, v222
    v_mul_f32 v197, v197, v221
    v_rcp_f32 v223, v223
    v_mul_f32 v198, v198, v222
    s_nop 0
    v_mul_f32 v199, v199, v223
    v_cvt_pk_bf16_f32 v192, v192, v193
    v_cvt_pk_bf16_f32 v193, v194, v195
    v_cvt_pk_bf16_f32 v196, v196, v197
    v_cvt_pk_bf16_f32 v197, v198, v199
    s_waitcnt vmcnt(5)
    s_barrier
    s_mov_b32 s30, s38
    s_add_u32 m0, s31, s43
    s_add_u32 s31, s31, 20480
    buffer_load_dwordx4 v244, s[8:11], s30 offen lds
    v_fma_f32 v216, -v200, v200, s46
    v_fma_f32 v217, -v201, v201, s46
    v_fma_f32 v218, -v202, v202, s46
    v_fma_f32 v219, -v203, v203, s46
    v_fma_f32 v220, -v204, v204, s46
    v_fma_f32 v221, -v205, v205, s46
    v_fma_f32 v222, -v206, v206, s46
    v_fma_f32 v223, -v207, v207, s46
    v_mul_f32 v216, v200, v216
    v_mul_f32 v217, v201, v217
    v_mul_f32 v218, v202, v218
    buffer_load_dwordx4 v245, s[8:11], s30 offen offset:1024 lds
    v_mul_f32 v219, v203, v219
    v_mul_f32 v220, v204, v220
    v_mul_f32 v221, v205, v221
    v_mul_f32 v222, v206, v222
    v_mul_f32 v223, v207, v223
    v_exp_f32 v216, v216
    v_exp_f32 v217, v217
    v_add_f32 v216, 1.0, v216
    v_exp_f32 v218, v218
    v_add_f32 v217, 1.0, v217
    v_exp_f32 v219, v219
    buffer_load_dwordx4 v246, s[8:11], s30 offen offset:2048 lds
    v_add_f32 v218, 1.0, v218
    v_exp_f32 v220, v220
    v_add_f32 v219, 1.0, v219
    v_exp_f32 v221, v221
    v_add_f32 v220, 1.0, v220
    v_exp_f32 v222, v222
    v_add_f32 v221, 1.0, v221
    v_exp_f32 v223, v223
    v_add_f32 v222, 1.0, v222
    v_rcp_f32 v216, v216
    v_add_f32 v223, 1.0, v223
    buffer_load_dwordx4 v247, s[8:11], s30 offen offset:3072 lds
    v_rcp_f32 v217, v217
    v_mul_f32 v200, v200, v216
    v_rcp_f32 v218, v218
    v_mul_f32 v201, v201, v217
    v_rcp_f32 v219, v219
    v_mul_f32 v202, v202, v218
    v_rcp_f32 v220, v220
    v_mul_f32 v203, v203, v219
    v_rcp_f32 v221, v221
    v_mul_f32 v204, v204, v220
    v_rcp_f32 v222, v222
    s_add_u32 m0, m0, 4096
    s_cmp_ge_u32 s31, 81920
    s_cselect_b32 s31, 0, s31
    buffer_load_dwordx4 v248, s[8:11], s30 offen lds
    s_add_u32 s30, s30, s26
    v_mul_f32 v205, v205, v221
    v_rcp_f32 v223, v223
    v_mul_f32 v206, v206, v222
    s_nop 0
    v_mul_f32 v207, v207, v223
    v_cvt_pk_bf16_f32 v194, v200, v201
    v_cvt_pk_bf16_f32 v195, v202, v203
    v_cvt_pk_bf16_f32 v198, v204, v205
    v_cvt_pk_bf16_f32 v199, v206, v207
    v_mfma_f32_16x16x32_bf16 v[224:227], v[240:243], v[192:195], v[224:227]
    v_mfma_f32_16x16x32_bf16 v[228:231], v[192:195], v[192:195], v[228:231]
    v_mfma_f32_16x16x32_bf16 v[232:235], v[240:243], v[196:199], v[232:235]
    v_mfma_f32_16x16x32_bf16 v[236:239], v[196:199], v[196:199], v[236:239]
    s_waitcnt vmcnt(5)
    s_barrier
    s_add_u32 m0, s31, s43
    s_add_u32 s31, s31, 20480
    buffer_load_dwordx4 v244, s[8:11], s30 offen lds
    v_fma_f32 v216, -v208, v208, s46
    v_fma_f32 v217, -v209, v209, s46
    v_fma_f32 v218, -v210, v210, s46
    v_fma_f32 v219, -v211, v211, s46
    v_fma_f32 v220, -v212, v212, s46
    v_fma_f32 v221, -v213, v213, s46
    v_fma_f32 v222, -v214, v214, s46
    v_fma_f32 v223, -v215, v215, s46
    v_mul_f32 v216, v208, v216
    v_mul_f32 v217, v209, v217
    v_mul_f32 v218, v210, v218
    v_mul_f32 v219, v211, v219
    buffer_load_dwordx4 v245, s[8:11], s30 offen offset:1024 lds
    v_mul_f32 v220, v212, v220
    v_mul_f32 v221, v213, v221
    v_mul_f32 v222, v214, v222
    v_mul_f32 v223, v215, v223
    v_exp_f32 v216, v216
    v_exp_f32 v217, v217
    v_add_f32 v216, 1.0, v216
    v_exp_f32 v218, v218
    v_add_f32 v217, 1.0, v217
    v_exp_f32 v219, v219
    v_add_f32 v218, 1.0, v218
    v_exp_f32 v220, v220
    buffer_load_dwordx4 v246, s[8:11], s30 offen offset:2048 lds
    v_add_f32 v219, 1.0, v219
    v_exp_f32 v221, v221
    v_add_f32 v220, 1.0, v220
    v_exp_f32 v222, v222
    v_add_f32 v221, 1.0, v221
    v_exp_f32 v223, v223
    v_add_f32 v222, 1.0, v222
    v_rcp_f32 v216, v216
    v_add_f32 v223, 1.0, v223
    v_rcp_f32 v217, v217
    v_mul_f32 v208, v208, v216
    buffer_load_dwordx4 v247, s[8:11], s30 offen offset:3072 lds
    v_rcp_f32 v218, v218
    v_mul_f32 v209, v209, v217
    v_rcp_f32 v219, v219
    v_mul_f32 v210, v210, v218
    v_rcp_f32 v220, v220
    v_mul_f32 v211, v211, v219
    v_rcp_f32 v221, v221
    v_mul_f32 v212, v212, v220
    v_rcp_f32 v222, v222
    v_mul_f32 v213, v213, v221
    v_rcp_f32 v223, v223
    v_mul_f32 v214, v214, v222
    s_nop 0
    v_mul_f32 v215, v215, v223
    s_add_u32 m0, m0, 4096
    s_cmp_ge_u32 s31, 81920
    s_cselect_b32 s31, 0, s31
    buffer_load_dwordx4 v248, s[8:11], s30 offen lds
    s_add_u32 s30, s30, s26
    v_cvt_pk_bf16_f32 v208, v208, v209
    v_cvt_pk_bf16_f32 v209, v210, v211
    v_cvt_pk_bf16_f32 v212, v212, v213
    v_cvt_pk_bf16_f32 v213, v214, v215
    v_mov_b32 v210, 0
    v_mov_b32 v211, 0
    v_mov_b32 v214, 0
    v_mov_b32 v215, 0
    v_mfma_f32_16x16x32_bf16 v[224:227], v[240:243], v[208:211], v[224:227]
    v_mfma_f32_16x16x32_bf16 v[228:231], v[208:211], v[208:211], v[228:231]
    v_mfma_f32_16x16x32_bf16 v[232:235], v[240:243], v[212:215], v[232:235]
    v_mfma_f32_16x16x32_bf16 v[236:239], v[212:215], v[212:215], v[236:239]
    s_waitcnt vmcnt(5) lgkmcnt(0)
    s_barrier
    s_add_u32 m0, s31, s43
    s_add_u32 s31, s31, 20480
    buffer_load_dwordx4 v244, s[8:11], s30 offen lds
    buffer_load_dwordx4 v245, s[8:11], s30 offen offset:1024 lds
    buffer_load_dwordx4 v246, s[8:11], s30 offen offset:2048 lds
    buffer_load_dwordx4 v247, s[8:11], s30 offen offset:3072 lds
    s_add_u32 m0, m0, 4096
    s_cmp_ge_u32 s31, 81920
    s_cselect_b32 s31, 0, s31
    buffer_load_dwordx4 v248, s[8:11], s30 offen lds
    s_add_u32 s30, s30, s26
    ds_write_b64 v249, v[144:145] offset:0
    ds_write_b64 v249, v[148:149] offset:4736
    ds_write_b64 v249, v[146:147] offset:32
    ds_write_b64 v249, v[150:151] offset:4768
    ds_write_b64 v249, v[160:161] offset:64
    ds_write_b64 v249, v[164:165] offset:4800
    ds_write_b64 v249, v[162:163] offset:96
    ds_write_b64 v249, v[166:167] offset:4832
    ds_write_b64 v249, v[176:177] offset:128
    ds_write_b64 v249, v[180:181] offset:4864
    ds_write_b64 v249, v[178:179] offset:160
    ds_write_b64 v249, v[182:183] offset:4896
    ds_write_b64 v249, v[192:193] offset:192
    ds_write_b64 v249, v[196:197] offset:4928
    ds_write_b64 v249, v[194:195] offset:224
    ds_write_b64 v249, v[198:199] offset:4960
    ds_write_b64 v249, v[208:209] offset:256
    ds_write_b64 v249, v[212:213] offset:4992
    s_nop 3
    v_bfe_u32 v252, v251, 4, 4
    v_lshrrev_b32 v253, 8, v251
    v_and_b32 v254, 3, v252
    v_cmp_eq_u32 vcc, 1, v254
    s_nop 1
    v_cndmask_b32 v228, v228, v229, vcc
    v_cndmask_b32 v236, v236, v237, vcc
    v_cmp_eq_u32 vcc, 2, v254
    s_nop 1
    v_cndmask_b32 v228, v228, v230, vcc
    v_cndmask_b32 v236, v236, v238, vcc
    v_cmp_eq_u32 vcc, 3, v254
    s_nop 1
    v_cndmask_b32 v228, v228, v231, vcc
    v_cndmask_b32 v236, v236, v239, vcc
    v_lshrrev_b32 v254, 2, v252
    v_lshlrev_b32 v254, 6, v254
    v_lshl_add_u32 v254, v252, 2, v254
    ds_bpermute_b32 v225, v254, v228
    ds_bpermute_b32 v233, v254, v236
    s_waitcnt lgkmcnt(0)
    v_mov_b32 v255, 2130706432
    v_cmp_gt_u32 vcc, 2, v253
    s_lshl_b32 s33, s20, 4
    s_add_u32 s33, s33, s40
    v_cndmask_b32 v254, v255, v251, vcc
    v_cmp_eq_u32 vcc, 1, v253
    s_lshl_b32 s33, s33, 2
    s_add_u32 s33, s33, s24
    v_cndmask_b32 v224, v224, v232, vcc
    v_cndmask_b32 v225, v225, v233, vcc
    v_mov_b32 v226, s84
    v_mov_b32 v227, s85
    s_lshl_b32 s33, s33, 9
    s_add_u32 s33, s33, 33300480
    buffer_store_dwordx4 v[224:227], v254, s[12:15], s33 offen sc1
    s_setpc_b64 s[50:51]
.p2align 6
k1_kernel_epi_z2_solo:
    v_bfe_u32 v252, v251, 4, 4
    v_lshrrev_b32 v253, 8, v251
    v_mul_u32_u24 v249, 296, v252
    v_lshl_add_u32 v249, v253, 3, v249
    s_mul_i32 s33, s24, 9472
    s_add_u32 s33, s33, s41
    v_add_u32 v249, s33, v249
    v_mov_b32 v240, s42
    v_mov_b32 v241, s42
    v_mov_b32 v242, s42
    v_mov_b32 v243, s42
    v_pk_fma_f32 v[216:217], v[144:145], v[144:145], s[46:47] op_sel_hi:[1,1,0] neg_lo:[1,0,0] neg_hi:[1,0,0]
    v_pk_fma_f32 v[218:219], v[146:147], v[146:147], s[46:47] op_sel_hi:[1,1,0] neg_lo:[1,0,0] neg_hi:[1,0,0]
    v_pk_fma_f32 v[220:221], v[148:149], v[148:149], s[46:47] op_sel_hi:[1,1,0] neg_lo:[1,0,0] neg_hi:[1,0,0]
    v_pk_fma_f32 v[222:223], v[150:151], v[150:151], s[46:47] op_sel_hi:[1,1,0] neg_lo:[1,0,0] neg_hi:[1,0,0]
    v_pk_mul_f32 v[216:217], v[216:217], v[144:145]
    v_pk_mul_f32 v[218:219], v[218:219], v[146:147]
    v_pk_mul_f32 v[220:221], v[220:221], v[148:149]
    v_pk_mul_f32 v[222:223], v[222:223], v[150:151]
    v_exp_f32 v216, v216
    v_exp_f32 v217, v217
    v_exp_f32 v218, v218
    v_exp_f32 v219, v219
    v_pk_add_f32 v[216:217], v[216:217], 1.0 op_sel_hi:[1,0]
    v_exp_f32 v220, v220
    v_exp_f32 v221, v221
    v_pk_add_f32 v[218:219], v[218:219], 1.0 op_sel_hi:[1,0]
    v_exp_f32 v222, v222
    v_exp_f32 v223, v223
    v_pk_add_f32 v[220:221], v[220:221], 1.0 op_sel_hi:[1,0]
    v_rcp_f32 v216, v216
    v_pk_add_f32 v[222:223], v[222:223], 1.0 op_sel_hi:[1,0]
    v_rcp_f32 v217, v217
    v_rcp_f32 v218, v218
    v_pk_mul_f32 v[144:145], v[144:145], v[216:217]
    v_rcp_f32 v219, v219
    v_rcp_f32 v220, v220
    v_pk_mul_f32 v[146:147], v[146:147], v[218:219]
    v_rcp_f32 v221, v221
    v_rcp_f32 v222, v222
    v_pk_mul_f32 v[148:149], v[148:149], v[220:221]
    v_rcp_f32 v223, v223
    s_nop 0
    v_pk_mul_f32 v[150:151], v[150:151], v[222:223]
    v_cvt_pk_bf16_f32 v144, v144, v145
    v_cvt_pk_bf16_f32 v145, v146, v147
    v_cvt_pk_bf16_f32 v148, v148, v149
    v_cvt_pk_bf16_f32 v149, v150, v151
    ds_write_b64 v249, v[144:145] offset:0
    ds_write_b64 v249, v[148:149] offset:4736
    v_pk_fma_f32 v[216:217], v[152:153], v[152:153], s[46:47] op_sel_hi:[1,1,0] neg_lo:[1,0,0] neg_hi:[1,0,0]
    v_pk_fma_f32 v[218:219], v[154:155], v[154:155], s[46:47] op_sel_hi:[1,1,0] neg_lo:[1,0,0] neg_hi:[1,0,0]
    v_pk_fma_f32 v[220:221], v[156:157], v[156:157], s[46:47] op_sel_hi:[1,1,0] neg_lo:[1,0,0] neg_hi:[1,0,0]
    v_pk_fma_f32 v[222:223], v[158:159], v[158:159], s[46:47] op_sel_hi:[1,1,0] neg_lo:[1,0,0] neg_hi:[1,0,0]
    v_pk_mul_f32 v[216:217], v[216:217], v[152:153]
    v_pk_mul_f32 v[218:219], v[218:219], v[154:155]
    v_pk_mul_f32 v[220:221], v[220:221], v[156:157]
    v_pk_mul_f32 v[222:223], v[222:223], v[158:159]
    v_exp_f32 v216, v216
    v_exp_f32 v217, v217
    v_exp_f32 v218, v218
    v_exp_f32 v219, v219
    v_pk_add_f32 v[216:217], v[216:217], 1.0 op_sel_hi:[1,0]
    v_exp_f32 v220, v220
    v_exp_f32 v221, v221
    v_pk_add_f32 v[218:219], v[218:219], 1.0 op_sel_hi:[1,0]
    v_exp_f32 v222, v222
    v_exp_f32 v223, v223
    v_pk_add_f32 v[220:221], v[220:221], 1.0 op_sel_hi:[1,0]
    v_rcp_f32 v216, v216
    v_pk_add_f32 v[222:223], v[222:223], 1.0 op_sel_hi:[1,0]
    v_rcp_f32 v217, v217
    v_rcp_f32 v218, v218
    v_pk_mul_f32 v[152:153], v[152:153], v[216:217]
    v_rcp_f32 v219, v219
    v_rcp_f32 v220, v220
    v_pk_mul_f32 v[154:155], v[154:155], v[218:219]
    v_rcp_f32 v221, v221
    v_rcp_f32 v222, v222
    v_pk_mul_f32 v[156:157], v[156:157], v[220:221]
    v_rcp_f32 v223, v223
    s_nop 0
    v_pk_mul_f32 v[158:159], v[158:159], v[222:223]
    v_cvt_pk_bf16_f32 v146, v152, v153
    v_cvt_pk_bf16_f32 v147, v154, v155
    v_cvt_pk_bf16_f32 v150, v156, v157
    v_cvt_pk_bf16_f32 v151, v158, v159
    ds_write_b64 v249, v[146:147] offset:32
    ds_write_b64 v249, v[150:151] offset:4768
    v_mfma_f32_16x16x32_bf16 v[224:227], v[240:243], v[144:147], 0
    v_mfma_f32_16x16x32_bf16 v[228:231], v[144:147], v[144:147], 0
    v_mfma_f32_16x16x32_bf16 v[232:235], v[240:243], v[148:151], 0
    v_mfma_f32_16x16x32_bf16 v[236:239], v[148:151], v[148:151], 0
    v_pk_fma_f32 v[216:217], v[160:161], v[160:161], s[46:47] op_sel_hi:[1,1,0] neg_lo:[1,0,0] neg_hi:[1,0,0]
    v_pk_fma_f32 v[218:219], v[162:163], v[162:163], s[46:47] op_sel_hi:[1,1,0] neg_lo:[1,0,0] neg_hi:[1,0,0]
    v_pk_fma_f32 v[220:221], v[164:165], v[164:165], s[46:47] op_sel_hi:[1,1,0] neg_lo:[1,0,0] neg_hi:[1,0,0]
    v_pk_fma_f32 v[222:223], v[166:167], v[166:167], s[46:47] op_sel_hi:[1,1,0] neg_lo:[1,0,0] neg_hi:[1,0,0]
    v_pk_mul_f32 v[216:217], v[216:217], v[160:161]
    v_pk_mul_f32 v[218:219], v[218:219], v[162:163]
    v_pk_mul_f32 v[220:221], v[220:221], v[164:165]
    v_pk_mul_f32 v[222:223], v[222:223], v[166:167]
    v_exp_f32 v216, v216
    v_exp_f32 v217, v217
    v_exp_f32 v218, v218
    v_exp_f32 v219, v219
    v_pk_add_f32 v[216:217], v[216:217], 1.0 op_sel_hi:[1,0]
    v_exp_f32 v220, v220
    v_exp_f32 v221, v221
    v_pk_add_f32 v[218:219], v[218:219], 1.0 op_sel_hi:[1,0]
    v_exp_f32 v222, v222
    v_exp_f32 v223, v223
    v_pk_add_f32 v[220:221], v[220:221], 1.0 op_sel_hi:[1,0]
    v_rcp_f32 v216, v216
    v_pk_add_f32 v[222:223], v[222:223], 1.0 op_sel_hi:[1,0]
    v_rcp_f32 v217, v217
    v_rcp_f32 v218, v218
    v_pk_mul_f32 v[160:161], v[160:161], v[216:217]
    v_rcp_f32 v219, v219
    v_rcp_f32 v220, v220
    v_pk_mul_f32 v[162:163], v[162:163], v[218:219]
    v_rcp_f32 v221, v221
    v_rcp_f32 v222, v222
    v_pk_mul_f32 v[164:165], v[164:165], v[220:221]
    v_rcp_f32 v223, v223
    s_nop 0
    v_pk_mul_f32 v[166:167], v[166:167], v[222:223]
    v_cvt_pk_bf16_f32 v160, v160, v161
    v_cvt_pk_bf16_f32 v161, v162, v163
    v_cvt_pk_bf16_f32 v164, v164, v165
    v_cvt_pk_bf16_f32 v165, v166, v167
    ds_write_b64 v249, v[160:161] offset:64
    ds_write_b64 v249, v[164:165] offset:4800
    v_pk_fma_f32 v[216:217], v[168:169], v[168:169], s[46:47] op_sel_hi:[1,1,0] neg_lo:[1,0,0] neg_hi:[1,0,0]
    v_pk_fma_f32 v[218:219], v[170:171], v[170:171], s[46:47] op_sel_hi:[1,1,0] neg_lo:[1,0,0] neg_hi:[1,0,0]
    v_pk_fma_f32 v[220:221], v[172:173], v[172:173], s[46:47] op_sel_hi:[1,1,0] neg_lo:[1,0,0] neg_hi:[1,0,0]
    v_pk_fma_f32 v[222:223], v[174:175], v[174:175], s[46:47] op_sel_hi:[1,1,0] neg_lo:[1,0,0] neg_hi:[1,0,0]
    v_pk_mul_f32 v[216:217], v[216:217], v[168:169]
    v_pk_mul_f32 v[218:219], v[218:219], v[170:171]
    v_pk_mul_f32 v[220:221], v[220:221], v[172:173]
    v_pk_mul_f32 v[222:223], v[222:223], v[174:175]
    v_exp_f32 v216, v216
    v_exp_f32 v217, v217
    v_exp_f32 v218, v218
    v_exp_f32 v219, v219
    v_pk_add_f32 v[216:217], v[216:217], 1.0 op_sel_hi:[1,0]
    v_exp_f32 v220, v220
    v_exp_f32 v221, v221
    v_pk_add_f32 v[218:219], v[218:219], 1.0 op_sel_hi:[1,0]
    v_exp_f32 v222, v222
    v_exp_f32 v223, v223
    v_pk_add_f32 v[220:221], v[220:221], 1.0 op_sel_hi:[1,0]
    v_rcp_f32 v216, v216
    v_pk_add_f32 v[222:223], v[222:223], 1.0 op_sel_hi:[1,0]
    v_rcp_f32 v217, v217
    v_rcp_f32 v218, v218
    v_pk_mul_f32 v[168:169], v[168:169], v[216:217]
    v_rcp_f32 v219, v219
    v_rcp_f32 v220, v220
    v_pk_mul_f32 v[170:171], v[170:171], v[218:219]
    v_rcp_f32 v221, v221
    v_rcp_f32 v222, v222
    v_pk_mul_f32 v[172:173], v[172:173], v[220:221]
    v_rcp_f32 v223, v223
    s_nop 0
    v_pk_mul_f32 v[174:175], v[174:175], v[222:223]
    v_cvt_pk_bf16_f32 v162, v168, v169
    v_cvt_pk_bf16_f32 v163, v170, v171
    v_cvt_pk_bf16_f32 v166, v172, v173
    v_cvt_pk_bf16_f32 v167, v174, v175
    ds_write_b64 v249, v[162:163] offset:96
    ds_write_b64 v249, v[166:167] offset:4832
    v_mfma_f32_16x16x32_bf16 v[224:227], v[240:243], v[160:163], v[224:227]
    v_mfma_f32_16x16x32_bf16 v[228:231], v[160:163], v[160:163], v[228:231]
    v_mfma_f32_16x16x32_bf16 v[232:235], v[240:243], v[164:167], v[232:235]
    v_mfma_f32_16x16x32_bf16 v[236:239], v[164:167], v[164:167], v[236:239]
    v_pk_fma_f32 v[216:217], v[176:177], v[176:177], s[46:47] op_sel_hi:[1,1,0] neg_lo:[1,0,0] neg_hi:[1,0,0]
    v_pk_fma_f32 v[218:219], v[178:179], v[178:179], s[46:47] op_sel_hi:[1,1,0] neg_lo:[1,0,0] neg_hi:[1,0,0]
    v_pk_fma_f32 v[220:221], v[180:181], v[180:181], s[46:47] op_sel_hi:[1,1,0] neg_lo:[1,0,0] neg_hi:[1,0,0]
    v_pk_fma_f32 v[222:223], v[182:183], v[182:183], s[46:47] op_sel_hi:[1,1,0] neg_lo:[1,0,0] neg_hi:[1,0,0]
    v_pk_mul_f32 v[216:217], v[216:217], v[176:177]
    v_pk_mul_f32 v[218:219], v[218:219], v[178:179]
    v_pk_mul_f32 v[220:221], v[220:221], v[180:181]
    v_pk_mul_f32 v[222:223], v[222:223], v[182:183]
    v_exp_f32 v216, v216
    v_exp_f32 v217, v217
    v_exp_f32 v218, v218
    v_exp_f32 v219, v219
    v_pk_add_f32 v[216:217], v[216:217], 1.0 op_sel_hi:[1,0]
    v_exp_f32 v220, v220
    v_exp_f32 v221, v221
    v_pk_add_f32 v[218:219], v[218:219], 1.0 op_sel_hi:[1,0]
    v_exp_f32 v222, v222
    v_exp_f32 v223, v223
    v_pk_add_f32 v[220:221], v[220:221], 1.0 op_sel_hi:[1,0]
    v_rcp_f32 v216, v216
    v_pk_add_f32 v[222:223], v[222:223], 1.0 op_sel_hi:[1,0]
    v_rcp_f32 v217, v217
    v_rcp_f32 v218, v218
    v_pk_mul_f32 v[176:177], v[176:177], v[216:217]
    v_rcp_f32 v219, v219
    v_rcp_f32 v220, v220
    v_pk_mul_f32 v[178:179], v[178:179], v[218:219]
    v_rcp_f32 v221, v221
    v_rcp_f32 v222, v222
    v_pk_mul_f32 v[180:181], v[180:181], v[220:221]
    v_rcp_f32 v223, v223
    s_nop 0
    v_pk_mul_f32 v[182:183], v[182:183], v[222:223]
    v_cvt_pk_bf16_f32 v176, v176, v177
    v_cvt_pk_bf16_f32 v177, v178, v179
    v_cvt_pk_bf16_f32 v180, v180, v181
    v_cvt_pk_bf16_f32 v181, v182, v183
    ds_write_b64 v249, v[176:177] offset:128
    ds_write_b64 v249, v[180:181] offset:4864
    v_mov_b32 v216, 157696
    ds_read_b32 v216, v216
    s_waitcnt lgkmcnt(0)
    v_readfirstlane_b32 s84, v216
    s_mul_i32 s85, s84, 0x9e3779b1
    s_xor_b32 s85, s85, 0x5bd1e995
    v_pk_fma_f32 v[216:217], v[184:185], v[184:185], s[46:47] op_sel_hi:[1,1,0] neg_lo:[1,0,0] neg_hi:[1,0,0]
    v_pk_fma_f32 v[218:219], v[186:187], v[186:187], s[46:47] op_sel_hi:[1,1,0] neg_lo:[1,0,0] neg_hi:[1,0,0]
    v_pk_fma_f32 v[220:221], v[188:189], v[188:189], s[46:47] op_sel_hi:[1,1,0] neg_lo:[1,0,0] neg_hi:[1,0,0]
    v_pk_fma_f32 v[222:223], v[190:191], v[190:191], s[46:47] op_sel_hi:[1,1,0] neg_lo:[1,0,0] neg_hi:[1,0,0]
    v_pk_mul_f32 v[216:217], v[216:217], v[184:185]
    v_pk_mul_f32 v[218:219], v[218:219], v[186:187]
    v_pk_mul_f32 v[220:221], v[220:221], v[188:189]
    v_pk_mul_f32 v[222:223], v[222:223], v[190:191]
    v_exp_f32 v216, v216
    v_exp_f32 v217, v217
    v_exp_f32 v218, v218
    v_exp_f32 v219, v219
    v_pk_add_f32 v[216:217], v[216:217], 1.0 op_sel_hi:[1,0]
    v_exp_f32 v220, v220
    v_exp_f32 v221, v221
    v_pk_add_f32 v[218:219], v[218:219], 1.0 op_sel_hi:[1,0]
    v_exp_f32 v222, v222
    v_exp_f32 v223, v223
    v_pk_add_f32 v[220:221], v[220:221], 1.0 op_sel_hi:[1,0]
    v_rcp_f32 v216, v216
    v_pk_add_f32 v[222:223], v[222:223], 1.0 op_sel_hi:[1,0]
    v_rcp_f32 v217, v217
    v_rcp_f32 v218, v218
    v_pk_mul_f32 v[184:185], v[184:185], v[216:217]
    v_rcp_f32 v219, v219
    v_rcp_f32 v220, v220
    v_pk_mul_f32 v[186:187], v[186:187], v[218:219]
    v_rcp_f32 v221, v221
    v_rcp_f32 v222, v222
    v_pk_mul_f32 v[188:189], v[188:189], v[220:221]
    v_rcp_f32 v223, v223
    s_nop 0
    v_pk_mul_f32 v[190:191], v[190:191], v[222:223]
    v_cvt_pk_bf16_f32 v178, v184, v185
    v_cvt_pk_bf16_f32 v179, v186, v187
    v_cvt_pk_bf16_f32 v182, v188, v189
    v_cvt_pk_bf16_f32 v183, v190, v191
    ds_write_b64 v249, v[178:179] offset:160
    ds_write_b64 v249, v[182:183] offset:4896
    v_mfma_f32_16x16x32_bf16 v[224:227], v[240:243], v[176:179], v[224:227]
    v_mfma_f32_16x16x32_bf16 v[228:231], v[176:179], v[176:179], v[228:231]
    v_mfma_f32_16x16x32_bf16 v[232:235], v[240:243], v[180:183], v[232:235]
    v_mfma_f32_16x16x32_bf16 v[236:239], v[180:183], v[180:183], v[236:239]
    v_pk_fma_f32 v[216:217], v[192:193], v[192:193], s[46:47] op_sel_hi:[1,1,0] neg_lo:[1,0,0] neg_hi:[1,0,0]
    v_pk_fma_f32 v[218:219], v[194:195], v[194:195], s[46:47] op_sel_hi:[1,1,0] neg_lo:[1,0,0] neg_hi:[1,0,0]
    v_pk_fma_f32 v[220:221], v[196:197], v[196:197], s[46:47] op_sel_hi:[1,1,0] neg_lo:[1,0,0] neg_hi:[1,0,0]
    v_pk_fma_f32 v[222:223], v[198:199], v[198:199], s[46:47] op_sel_hi:[1,1,0] neg_lo:[1,0,0] neg_hi:[1,0,0]
    v_pk_mul_f32 v[216:217], v[216:217], v[192:193]
    v_pk_mul_f32 v[218:219], v[218:219], v[194:195]
    v_pk_mul_f32 v[220:221], v[220:221], v[196:197]
    v_pk_mul_f32 v[222:223], v[222:223], v[198:199]
    v_exp_f32 v216, v216
    v_exp_f32 v217, v217
    v_exp_f32 v218, v218
    v_exp_f32 v219, v219
    v_pk_add_f32 v[216:217], v[216:217], 1.0 op_sel_hi:[1,0]
    v_exp_f32 v220, v220
    v_exp_f32 v221, v221
    v_pk_add_f32 v[218:219], v[218:219], 1.0 op_sel_hi:[1,0]
    v_exp_f32 v222, v222
    v_exp_f32 v223, v223
    v_pk_add_f32 v[220:221], v[220:221], 1.0 op_sel_hi:[1,0]
    v_rcp_f32 v216, v216
    v_pk_add_f32 v[222:223], v[222:223], 1.0 op_sel_hi:[1,0]
    v_rcp_f32 v217, v217
    v_rcp_f32 v218, v218
    v_pk_mul_f32 v[192:193], v[192:193], v[216:217]
    v_rcp_f32 v219, v219
    v_rcp_f32 v220, v220
    v_pk_mul_f32 v[194:195], v[194:195], v[218:219]
    v_rcp_f32 v221, v221
    v_rcp_f32 v222, v222
    v_pk_mul_f32 v[196:197], v[196:197], v[220:221]
    v_rcp_f32 v223, v223
    s_nop 0
    v_pk_mul_f32 v[198:199], v[198:199], v[222:223]
    v_cvt_pk_bf16_f32 v192, v192, v193
    v_cvt_pk_bf16_f32 v193, v194, v195
    v_cvt_pk_bf16_f32 v196, v196, v197
    v_cvt_pk_bf16_f32 v197, v198, v199
    ds_write_b64 v249, v[192:193] offset:192
    ds_write_b64 v249, v[196:197] offset:4928
    v_pk_fma_f32 v[216:217], v[200:201], v[200:201], s[46:47] op_sel_hi:[1,1,0] neg_lo:[1,0,0] neg_hi:[1,0,0]
    v_pk_fma_f32 v[218:219], v[202:203], v[202:203], s[46:47] op_sel_hi:[1,1,0] neg_lo:[1,0,0] neg_hi:[1,0,0]
    v_pk_fma_f32 v[220:221], v[204:205], v[204:205], s[46:47] op_sel_hi:[1,1,0] neg_lo:[1,0,0] neg_hi:[1,0,0]
    v_pk_fma_f32 v[222:223], v[206:207], v[206:207], s[46:47] op_sel_hi:[1,1,0] neg_lo:[1,0,0] neg_hi:[1,0,0]
    v_pk_mul_f32 v[216:217], v[216:217], v[200:201]
    v_pk_mul_f32 v[218:219], v[218:219], v[202:203]
    v_pk_mul_f32 v[220:221], v[220:221], v[204:205]
    v_pk_mul_f32 v[222:223], v[222:223], v[206:207]
    v_exp_f32 v216, v216
    v_exp_f32 v217, v217
    v_exp_f32 v218, v218
    v_exp_f32 v219, v219
    v_pk_add_f32 v[216:217], v[216:217], 1.0 op_sel_hi:[1,0]
    v_exp_f32 v220, v220
    v_exp_f32 v221, v221
    v_pk_add_f32 v[218:219], v[218:219], 1.0 op_sel_hi:[1,0]
    v_exp_f32 v222, v222
    v_exp_f32 v223, v223
    v_pk_add_f32 v[220:221], v[220:221], 1.0 op_sel_hi:[1,0]
    v_rcp_f32 v216, v216
    v_pk_add_f32 v[222:223], v[222:223], 1.0 op_sel_hi:[1,0]
    v_rcp_f32 v217, v217
    v_rcp_f32 v218, v218
    v_pk_mul_f32 v[200:201], v[200:201], v[216:217]
    v_rcp_f32 v219, v219
    v_rcp_f32 v220, v220
    v_pk_mul_f32 v[202:203], v[202:203], v[218:219]
    v_rcp_f32 v221, v221
    v_rcp_f32 v222, v222
    v_pk_mul_f32 v[204:205], v[204:205], v[220:221]
    v_rcp_f32 v223, v223
    s_nop 0
    v_pk_mul_f32 v[206:207], v[206:207], v[222:223]
    v_cvt_pk_bf16_f32 v194, v200, v201
    v_cvt_pk_bf16_f32 v195, v202, v203
    v_cvt_pk_bf16_f32 v198, v204, v205
    v_cvt_pk_bf16_f32 v199, v206, v207
    ds_write_b64 v249, v[194:195] offset:224
    ds_write_b64 v249, v[198:199] offset:4960
    v_mfma_f32_16x16x32_bf16 v[224:227], v[240:243], v[192:195], v[224:227]
    v_mfma_f32_16x16x32_bf16 v[228:231], v[192:195], v[192:195], v[228:231]
    v_mfma_f32_16x16x32_bf16 v[232:235], v[240:243], v[196:199], v[232:235]
    v_mfma_f32_16x16x32_bf16 v[236:239], v[196:199], v[196:199], v[236:239]
    v_pk_fma_f32 v[216:217], v[208:209], v[208:209], s[46:47] op_sel_hi:[1,1,0] neg_lo:[1,0,0] neg_hi:[1,0,0]
    v_pk_fma_f32 v[218:219], v[210:211], v[210:211], s[46:47] op_sel_hi:[1,1,0] neg_lo:[1,0,0] neg_hi:[1,0,0]
    v_pk_fma_f32 v[220:221], v[212:213], v[212:213], s[46:47] op_sel_hi:[1,1,0] neg_lo:[1,0,0] neg_hi:[1,0,0]
    v_pk_fma_f32 v[222:223], v[214:215], v[214:215], s[46:47] op_sel_hi:[1,1,0] neg_lo:[1,0,0] neg_hi:[1,0,0]
    v_pk_mul_f32 v[216:217], v[216:217], v[208:209]
    v_pk_mul_f32 v[218:219], v[218:219], v[210:211]
    v_pk_mul_f32 v[220:221], v[220:221], v[212:213]
    v_pk_mul_f32 v[222:223], v[222:223], v[214:215]
    v_exp_f32 v216, v216
    v_exp_f32 v217, v217
    v_exp_f32 v218, v218
    v_exp_f32 v219, v219
    v_pk_add_f32 v[216:217], v[216:217], 1.0 op_sel_hi:[1,0]
    v_exp_f32 v220, v220
    v_exp_f32 v221, v221
    v_pk_add_f32 v[218:219], v[218:219], 1.0 op_sel_hi:[1,0]
    v_exp_f32 v222, v222
    v_exp_f32 v223, v223
    v_pk_add_f32 v[220:221], v[220:221], 1.0 op_sel_hi:[1,0]
    v_rcp_f32 v216, v216
    v_pk_add_f32 v[222:223], v[222:223], 1.0 op_sel_hi:[1,0]
    v_rcp_f32 v217, v217
    v_rcp_f32 v218, v218
    v_pk_mul_f32 v[208:209], v[208:209], v[216:217]
    v_rcp_f32 v219, v219
    v_rcp_f32 v220, v220
    v_pk_mul_f32 v[210:211], v[210:211], v[218:219]
    v_rcp_f32 v221, v221
    v_rcp_f32 v222, v222
    v_pk_mul_f32 v[212:213], v[212:213], v[220:221]
    v_rcp_f32 v223, v223
    s_nop 0
    v_pk_mul_f32 v[214:215], v[214:215], v[222:223]
    v_cvt_pk_bf16_f32 v208, v208, v209
    v_cvt_pk_bf16_f32 v209, v210, v211
    v_cvt_pk_bf16_f32 v212, v212, v213
    v_cvt_pk_bf16_f32 v213, v214, v215
    v_mov_b32 v210, 0
    v_mov_b32 v211, 0
    v_mov_b32 v214, 0
    v_mov_b32 v215, 0
    ds_write_b64 v249, v[208:209] offset:256
    ds_write_b64 v249, v[212:213] offset:4992
    v_mfma_f32_16x16x32_bf16 v[224:227], v[240:243], v[208:211], v[224:227]
    v_mfma_f32_16x16x32_bf16 v[228:231], v[208:211], v[208:211], v[228:231]
    v_mfma_f32_16x16x32_bf16 v[232:235], v[240:243], v[212:215], v[232:235]
    v_mfma_f32_16x16x32_bf16 v[236:239], v[212:215], v[212:215], v[236:239]
    s_nop 3
    v_bfe_u32 v252, v251, 4, 4
    v_lshrrev_b32 v253, 8, v251
    v_and_b32 v254, 3, v252
    v_cmp_eq_u32 vcc, 1, v254
    s_nop 1
    v_cndmask_b32 v228, v228, v229, vcc
    v_cndmask_b32 v236, v236, v237, vcc
    v_cmp_eq_u32 vcc, 2, v254
    s_nop 1
    v_cndmask_b32 v228, v228, v230, vcc
    v_cndmask_b32 v236, v236, v238, vcc
    v_cmp_eq_u32 vcc, 3, v254
    s_nop 1
    v_cndmask_b32 v228, v228, v231, vcc
    v_cndmask_b32 v236, v236, v239, vcc
    v_lshrrev_b32 v254, 2, v252
    v_lshlrev_b32 v254, 6, v254
    v_lshl_add_u32 v254, v252, 2, v254
    ds_bpermute_b32 v225, v254, v228
    ds_bpermute_b32 v233, v254, v236
    s_waitcnt lgkmcnt(0)
    v_mov_b32 v255, 2130706432
    v_cmp_gt_u32 vcc, 2, v253
    s_lshl_b32 s33, s20, 4
    s_add_u32 s33, s33, s40
    v_cndmask_b32 v254, v255, v251, vcc
    v_cmp_eq_u32 vcc, 1, v253
    s_lshl_b32 s33, s33, 2
    s_add_u32 s33, s33, s24
    v_cndmask_b32 v224, v224, v232, vcc
    v_cndmask_b32 v225, v225, v233, vcc
    v_mov_b32 v226, s84
    v_mov_b32 v227, s85
    s_lshl_b32 s33, s33, 9
    s_add_u32 s33, s33, 33300480
    buffer_store_dwordx4 v[224:227], v254, s[12:15], s33 offen sc1
    s_setpc_b64 s[50:51]
.p2align 6
k1_kernel_epi_k_side:
    s_lshl_b32 s33, s24, 10
    s_add_u32 s33, s33, s41
    v_add_u32 v249, s33, v251
    v_min_f32 v216, 0, v144
    v_min_f32 v217, 0, v145
    v_min_f32 v218, 0, v146
    v_min_f32 v219, 0, v147
    v_min_f32 v220, 0, v148
    v_min_f32 v221, 0, v149
    v_min_f32 v222, 0, v150
    v_min_f32 v223, 0, v151
    v_mul_f32 v216, s48, v216
    v_mul_f32 v217, s48, v217
    v_mul_f32 v218, s48, v218
    v_mul_f32 v219, s48, v219
    v_mul_f32 v220, s48, v220
    v_mul_f32 v221, s48, v221
    v_mul_f32 v222, s48, v222
    v_mul_f32 v223, s48, v223
    v_exp_f32 v216, v216
    v_max_f32 v144, 0, v144
    v_exp_f32 v217, v217
    v_max_f32 v145, 0, v145
    v_exp_f32 v218, v218
    v_max_f32 v146, 0, v146
    v_exp_f32 v219, v219
    v_max_f32 v147, 0, v147
    v_exp_f32 v220, v220
    v_max_f32 v148, 0, v148
    v_exp_f32 v221, v221
    v_max_f32 v149, 0, v149
    v_exp_f32 v222, v222
    v_max_f32 v150, 0, v150
    v_exp_f32 v223, v223
    v_max_f32 v151, 0, v151
    v_add_f32 v144, s49, v144
    v_add_f32 v145, s49, v145
    v_add_f32 v146, s49, v146
    v_add_f32 v147, s49, v147
    v_add_f32 v148, s49, v148
    v_add_f32 v149, s49, v149
    v_add_f32 v150, s49, v150
    v_add_f32 v151, s49, v151
    v_add_f32 v144, v144, v216
    v_add_f32 v145, v145, v217
    v_add_f32 v146, v146, v218
    v_add_f32 v147, v147, v219
    v_add_f32 v148, v148, v220
    v_add_f32 v149, v149, v221
    v_add_f32 v150, v150, v222
    v_add_f32 v151, v151, v223
    v_cvt_pk_bf16_f32 v144, v144, v145
    v_cvt_pk_bf16_f32 v145, v146, v147
    v_cvt_pk_bf16_f32 v146, v148, v149
    v_cvt_pk_bf16_f32 v147, v150, v151
    s_barrier
    s_add_u32 m0, s31, s43
    s_add_u32 s31, s31, 20480
    buffer_load_dwordx4 v244, s[8:11], s30 offen lds
    v_min_f32 v216, 0, v152
    v_min_f32 v217, 0, v153
    v_min_f32 v218, 0, v154
    v_min_f32 v219, 0, v155
    v_min_f32 v220, 0, v156
    v_min_f32 v221, 0, v157
    v_min_f32 v222, 0, v158
    v_min_f32 v223, 0, v159
    v_mul_f32 v216, s48, v216
    buffer_load_dwordx4 v245, s[8:11], s30 offen offset:1024 lds
    v_mul_f32 v217, s48, v217
    v_mul_f32 v218, s48, v218
    v_mul_f32 v219, s48, v219
    v_mul_f32 v220, s48, v220
    v_mul_f32 v221, s48, v221
    v_mul_f32 v222, s48, v222
    v_mul_f32 v223, s48, v223
    v_exp_f32 v216, v216
    v_max_f32 v152, 0, v152
    buffer_load_dwordx4 v246, s[8:11], s30 offen offset:2048 lds
    v_exp_f32 v217, v217
    v_max_f32 v153, 0, v153
    v_exp_f32 v218, v218
    v_max_f32 v154, 0, v154
    v_exp_f32 v219, v219
    v_max_f32 v155, 0, v155
    v_exp_f32 v220, v220
    v_max_f32 v156, 0, v156
    buffer_load_dwordx4 v247, s[8:11], s30 offen offset:3072 lds
    v_exp_f32 v221, v221
    v_max_f32 v157, 0, v157
    v_exp_f32 v222, v222
    v_max_f32 v158, 0, v158
    v_exp_f32 v223, v223
    v_max_f32 v159, 0, v159
    v_add_f32 v152, s49, v152
    v_add_f32 v153, s49, v153
    v_add_f32 v154, s49, v154
    s_add_u32 m0, m0, 4096
    s_cmp_ge_u32 s31, 81920
    s_cselect_b32 s31, 0, s31
    buffer_load_dwordx4 v248, s[8:11], s30 offen lds
    s_add_u32 s30, s30, s26
    v_add_f32 v155, s49, v155
    v_add_f32 v156, s49, v156
    v_add_f32 v157, s49, v157
    v_add_f32 v158, s49, v158
    v_add_f32 v159, s49, v159
    v_add_f32 v152, v152, v216
    v_add_f32 v153, v153, v217
    v_add_f32 v154, v154, v218
    buffer_load_dwordx4 v[252:255], v251, s[56:59], s39 offen
    s_add_u32 s39, s39, 4096
    v_add_f32 v155, v155, v219
    v_add_f32 v156, v156, v220
    v_add_f32 v157, v157, v221
    v_add_f32 v158, v158, v222
    v_add_f32 v159, v159, v223
    v_cvt_pk_bf16_f32 v152, v152, v153
    v_cvt_pk_bf16_f32 v153, v154, v155
    v_cvt_pk_bf16_f32 v154, v156, v157
    v_cvt_pk_bf16_f32 v155, v158, v159
    s_barrier
    s_add_u32 m0, s31, s43
    s_add_u32 s31, s31, 20480
    buffer_load_dwordx4 v244, s[8:11], s30 offen lds
    v_min_f32 v216, 0, v160
    v_min_f32 v217, 0, v161
    v_min_f32 v218, 0, v162
    v_min_f32 v219, 0, v163
    v_min_f32 v220, 0, v164
    v_min_f32 v221, 0, v165
    v_min_f32 v222, 0, v166
    v_min_f32 v223, 0, v167
    v_mul_f32 v216, s48, v216
    buffer_load_dwordx4 v245, s[8:11], s30 offen offset:1024 lds
    v_mul_f32 v217, s48, v217
    v_mul_f32 v218, s48, v218
    v_mul_f32 v219, s48, v219
    v_mul_f32 v220, s48, v220
    v_mul_f32 v221, s48, v221
    v_mul_f32 v222, s48, v222
    v_mul_f32 v223, s48, v223
    v_exp_f32 v216, v216
    v_max_f32 v160, 0, v160
    buffer_load_dwordx4 v246, s[8:11], s30 offen offset:2048 lds
    v_exp_f32 v217, v217
    v_max_f32 v161, 0, v161
    v_exp_f32 v218, v218
    v_max_f32 v162, 0, v162
    v_exp_f32 v219, v219
    v_max_f32 v163, 0, v163
    v_exp_f32 v220, v220
    v_max_f32 v164, 0, v164
    buffer_load_dwordx4 v247, s[8:11], s30 offen offset:3072 lds
    v_exp_f32 v221, v221
    v_max_f32 v165, 0, v165
    v_exp_f32 v222, v222
    v_max_f32 v166, 0, v166
    v_exp_f32 v223, v223
    v_max_f32 v167, 0, v167
    v_add_f32 v160, s49, v160
    v_add_f32 v161, s49, v161
    v_add_f32 v162, s49, v162
    s_add_u32 m0, m0, 4096
    s_cmp_ge_u32 s31, 81920
    s_cselect_b32 s31, 0, s31
    buffer_load_dwordx4 v248, s[8:11], s30 offen lds
    s_add_u32 s30, s30, s26
    v_add_f32 v163, s49, v163
    v_add_f32 v164, s49, v164
    v_add_f32 v165, s49, v165
    v_add_f32 v166, s49, v166
    v_add_f32 v167, s49, v167
    v_add_f32 v160, v160, v216
    v_add_f32 v161, v161, v217
    v_add_f32 v162, v162, v218
    buffer_load_dwordx4 v[252:255], v251, s[56:59], s39 offen
    s_add_u32 s39, s39, 4096
    v_add_f32 v163, v163, v219
    v_add_f32 v164, v164, v220
    v_add_f32 v165, v165, v221
    v_add_f32 v166, v166, v222
    v_add_f32 v167, v167, v223
    v_cvt_pk_bf16_f32 v160, v160, v161
    v_cvt_pk_bf16_f32 v161, v162, v163
    v_cvt_pk_bf16_f32 v162, v164, v165
    v_cvt_pk_bf16_f32 v163, v166, v167
    s_waitcnt vmcnt(7)
    s_barrier
    s_add_u32 m0, s31, s43
    s_add_u32 s31, s31, 20480
    buffer_load_dwordx4 v244, s[8:11], s30 offen lds
    v_min_f32 v216, 0, v168
    v_min_f32 v217, 0, v169
    v_min_f32 v218, 0, v170
    v_min_f32 v219, 0, v171
    v_min_f32 v220, 0, v172
    v_min_f32 v221, 0, v173
    v_min_f32 v222, 0, v174
    v_min_f32 v223, 0, v175
    v_mul_f32 v216, s48, v216
    buffer_load_dwordx4 v245, s[8:11], s30 offen offset:1024 lds
    v_mul_f32 v217, s48, v217
    v_mul_f32 v218, s48, v218
    v_mul_f32 v219, s48, v219
    v_mul_f32 v220, s48, v220
    v_mul_f32 v221, s48, v221
    v_mul_f32 v222, s48, v222
    v_mul_f32 v223, s48, v223
    v_exp_f32 v216, v216
    v_max_f32 v168, 0, v168
    buffer_load_dwordx4 v246, s[8:11], s30 offen offset:2048 lds
    v_exp_f32 v217, v217
    v_max_f32 v169, 0, v169
    v_exp_f32 v218, v218
    v_max_f32 v170, 0, v170
    v_exp_f32 v219, v219
    v_max_f32 v171, 0, v171
    v_exp_f32 v220, v220
    v_max_f32 v172, 0, v172
    buffer_load_dwordx4 v247, s[8:11], s30 offen offset:3072 lds
    v_exp_f32 v221, v221
    v_max_f32 v173, 0, v173
    v_exp_f32 v222, v222
    v_max_f32 v174, 0, v174
    v_exp_f32 v223, v223
    v_max_f32 v175, 0, v175
    v_add_f32 v168, s49, v168
    v_add_f32 v169, s49, v169
    v_add_f32 v170, s49, v170
    s_add_u32 m0, m0, 4096
    s_cmp_ge_u32 s31, 81920
    s_cselect_b32 s31, 0, s31
    buffer_load_dwordx4 v248, s[8:11], s30 offen lds
    s_add_u32 s30, s30, s26
    v_add_f32 v171, s49, v171
    v_add_f32 v172, s49, v172
    v_add_f32 v173, s49, v173
    v_add_f32 v174, s49, v174
    v_add_f32 v175, s49, v175
    v_add_f32 v168, v168, v216
    v_add_f32 v169, v169, v217
    v_add_f32 v170, v170, v218
    buffer_load_dwordx4 v[252:255], v251, s[56:59], s39 offen
    s_add_u32 s39, s39, 4096
    v_add_f32 v171, v171, v219
    v_add_f32 v172, v172, v220
    v_add_f32 v173, v173, v221
    v_add_f32 v174, v174, v222
    v_add_f32 v175, v175, v223
    v_cvt_pk_bf16_f32 v168, v168, v169
    v_cvt_pk_bf16_f32 v169, v170, v171
    v_cvt_pk_bf16_f32 v170, v172, v173
    v_cvt_pk_bf16_f32 v171, v174, v175
    s_waitcnt vmcnt(7)
    s_barrier
    s_add_u32 m0, s31, s43
    s_add_u32 s31, s31, 20480
    buffer_load_dwordx4 v244, s[8:11], s30 offen lds
    v_min_f32 v216, 0, v176
    v_min_f32 v217, 0, v177
    v_min_f32 v218, 0, v178
    v_min_f32 v219, 0, v179
    v_min_f32 v220, 0, v180
    v_min_f32 v221, 0, v181
    v_min_f32 v222, 0, v182
    v_min_f32 v223, 0, v183
    v_mul_f32 v216, s48, v216
    buffer_load_dwordx4 v245, s[8:11], s30 offen offset:1024 lds
    v_mul_f32 v217, s48, v217
    v_mul_f32 v218, s48, v218
    v_mul_f32 v219, s48, v219
    v_mul_f32 v220, s48, v220
    v_mul_f32 v221, s48, v221
    v_mul_f32 v222, s48, v222
    v_mul_f32 v223, s48, v223
    v_exp_f32 v216, v216
    v_max_f32 v176, 0, v176
    buffer_load_dwordx4 v246, s[8:11], s30 offen offset:2048 lds
    v_exp_f32 v217, v217
    v_max_f32 v177, 0, v177
    v_exp_f32 v218, v218
    v_max_f32 v178, 0, v178
    v_exp_f32 v219, v219
    v_max_f32 v179, 0, v179
    v_exp_f32 v220, v220
    v_max_f32 v180, 0, v180
    buffer_load_dwordx4 v247, s[8:11], s30 offen offset:3072 lds
    v_exp_f32 v221, v221
    v_max_f32 v181, 0, v181
    v_exp_f32 v222, v222
    v_max_f32 v182, 0, v182
    v_exp_f32 v223, v223
    v_max_f32 v183, 0, v183
    v_add_f32 v176, s49, v176
    v_add_f32 v177, s49, v177
    v_add_f32 v178, s49, v178
    s_add_u32 m0, m0, 4096
    s_cmp_ge_u32 s31, 81920
    s_cselect_b32 s31, 0, s31
    buffer_load_dwordx4 v248, s[8:11], s30 offen lds
    s_add_u32 s30, s30, s26
    v_add_f32 v179, s49, v179
    v_add_f32 v180, s49, v180
    v_add_f32 v181, s49, v181
    v_add_f32 v182, s49, v182
    v_add_f32 v183, s49, v183
    v_add_f32 v176, v176, v216
    v_add_f32 v177, v177, v217
    v_add_f32 v178, v178, v218
    s_mov_b32 s56, s62
    s_and_b32 s57, s63, 0xffff
    s_mov_b32 s58, 663552
    s_lshl_b32 s39, s2, 12
    s_lshl_b32 s37, s24, 10
    s_add_u32 s39, s39, s37
    buffer_load_dwordx4 v[252:255], v251, s[56:59], s39 offen
    s_add_u32 s39, s39, 4096
    v_add_f32 v179, v179, v219
    v_add_f32 v180, v180, v220
    v_add_f32 v181, v181, v221
    v_add_f32 v182, v182, v222
    v_add_f32 v183, v183, v223
    v_cvt_pk_bf16_f32 v176, v176, v177
    v_cvt_pk_bf16_f32 v177, v178, v179
    v_cvt_pk_bf16_f32 v178, v180, v181
    v_cvt_pk_bf16_f32 v179, v182, v183
    s_waitcnt vmcnt(7)
    s_barrier
    s_add_u32 m0, s31, s43
    s_add_u32 s31, s31, 20480
    buffer_load_dwordx4 v244, s[8:11], s30 offen lds
    v_min_f32 v216, 0, v184
    v_min_f32 v217, 0, v185
    v_min_f32 v218, 0, v186
    v_min_f32 v219, 0, v187
    v_min_f32 v220, 0, v188
    v_min_f32 v221, 0, v189
    v_min_f32 v222, 0, v190
    v_min_f32 v223, 0, v191
    v_mul_f32 v216, s48, v216
    v_mul_f32 v217, s48, v217
    v_mul_f32 v218, s48, v218
    buffer_load_dwordx4 v245, s[8:11], s30 offen offset:1024 lds
    v_mul_f32 v219, s48, v219
    v_mul_f32 v220, s48, v220
    v_mul_f32 v221, s48, v221
    v_mul_f32 v222, s48, v222
    v_mul_f32 v223, s48, v223
    v_exp_f32 v216, v216
    v_max_f32 v184, 0, v184
    v_exp_f32 v217, v217
    v_max_f32 v185, 0, v185
    v_exp_f32 v218, v218
    buffer_load_dwordx4 v246, s[8:11], s30 offen offset:2048 lds
    v_max_f32 v186, 0, v186
    v_exp_f32 v219, v219
    v_max_f32 v187, 0, v187
    v_exp_f32 v220, v220
    v_max_f32 v188, 0, v188
    v_exp_f32 v221, v221
    v_max_f32 v189, 0, v189
    v_exp_f32 v222, v222
    v_max_f32 v190, 0, v190
    v_exp_f32 v223, v223
    buffer_load_dwordx4 v247, s[8:11], s30 offen offset:3072 lds
    v_max_f32 v191, 0, v191
    v_add_f32 v184, s49, v184
    v_add_f32 v185, s49, v185
    v_add_f32 v186, s49, v186
    v_add_f32 v187, s49, v187
    v_add_f32 v188, s49, v188
    v_add_f32 v189, s49, v189
    v_add_f32 v190, s49, v190
    v_add_f32 v191, s49, v191
    v_add_f32 v184, v184, v216
    s_add_u32 m0, m0, 4096
    s_cmp_ge_u32 s31, 81920
    s_cselect_b32 s31, 0, s31
    buffer_load_dwordx4 v248, s[8:11], s30 offen lds
    s_add_u32 s30, s30, s26
    v_add_f32 v185, v185, v217
    v_add_f32 v186, v186, v218
    v_add_f32 v187, v187, v219
    v_add_f32 v188, v188, v220
    v_add_f32 v189, v189, v221
    v_add_f32 v190, v190, v222
    v_add_f32 v191, v191, v223
    v_cvt_pk_bf16_f32 v184, v184, v185
    v_cvt_pk_bf16_f32 v185, v186, v187
    v_cvt_pk_bf16_f32 v186, v188, v189
    v_cvt_pk_bf16_f32 v187, v190, v191
    s_waitcnt vmcnt(6)
    s_barrier
    s_add_u32 m0, s31, s43
    s_add_u32 s31, s31, 20480
    buffer_load_dwordx4 v244, s[8:11], s30 offen lds
    v_min_f32 v216, 0, v192
    v_min_f32 v217, 0, v193
    v_min_f32 v218, 0, v194
    v_min_f32 v219, 0, v195
    v_min_f32 v220, 0, v196
    v_min_f32 v221, 0, v197
    v_min_f32 v222, 0, v198
    v_min_f32 v223, 0, v199
    v_mul_f32 v216, s48, v216
    v_mul_f32 v217, s48, v217
    v_mul_f32 v218, s48, v218
    buffer_load_dwordx4 v245, s[8:11], s30 offen offset:1024 lds
    v_mul_f32 v219, s48, v219
    v_mul_f32 v220, s48, v220
    v_mul_f32 v221, s48, v221
    v_mul_f32 v222, s48, v222
    v_mul_f32 v223, s48, v223
    v_exp_f32 v216, v216
    v_max_f32 v192, 0, v192
    v_exp_f32 v217, v217
    v_max_f32 v193, 0, v193
    v_exp_f32 v218, v218
    buffer_load_dwordx4 v246, s[8:11], s30 offen offset:2048 lds
    v_max_f32 v194, 0, v194
    v_exp_f32 v219, v219
    v_max_f32 v195, 0, v195
    v_exp_f32 v220, v220
    v_max_f32 v196, 0, v196
    v_exp_f32 v221, v221
    v_max_f32 v197, 0, v197
    v_exp_f32 v222, v222
    v_max_f32 v198, 0, v198
    v_exp_f32 v223, v223
    buffer_load_dwordx4 v247, s[8:11], s30 offen offset:3072 lds
    v_max_f32 v199, 0, v199
    v_add_f32 v192, s49, v192
    v_add_f32 v193, s49, v193
    v_add_f32 v194, s49, v194
    v_add_f32 v195, s49, v195
    v_add_f32 v196, s49, v196
    v_add_f32 v197, s49, v197
    v_add_f32 v198, s49, v198
    v_add_f32 v199, s49, v199
    v_add_f32 v192, v192, v216
    s_add_u32 m0, m0, 4096
    s_cmp_ge_u32 s31, 81920
    s_cselect_b32 s31, 0, s31
    buffer_load_dwordx4 v248, s[8:11], s30 offen lds
    s_add_u32 s30, s30, s26
    v_add_f32 v193, v193, v217
    v_add_f32 v194, v194, v218
    v_add_f32 v195, v195, v219
    v_add_f32 v196, v196, v220
    v_add_f32 v197, v197, v221
    v_add_f32 v198, v198, v222
    v_add_f32 v199, v199, v223
    v_cvt_pk_bf16_f32 v192, v192, v193
    v_cvt_pk_bf16_f32 v193, v194, v195
    v_cvt_pk_bf16_f32 v194, v196, v197
    v_cvt_pk_bf16_f32 v195, v198, v199
    s_waitcnt vmcnt(5)
    s_barrier
    s_mov_b32 s30, s38
    s_add_u32 m0, s31, s43
    s_add_u32 s31, s31, 20480
    buffer_load_dwordx4 v244, s[8:11], s30 offen lds
    v_min_f32 v216, 0, v200
    v_min_f32 v217, 0, v201
    v_min_f32 v218, 0, v202
    v_min_f32 v219, 0, v203
    v_min_f32 v220, 0, v204
    v_min_f32 v221, 0, v205
    v_min_f32 v222, 0, v206
    v_min_f32 v223, 0, v207
    v_mul_f32 v216, s48, v216
    v_mul_f32 v217, s48, v217
    v_mul_f32 v218, s48, v218
    buffer_load_dwordx4 v245, s[8:11], s30 offen offset:1024 lds
    v_mul_f32 v219, s48, v219
    v_mul_f32 v220, s48, v220
    v_mul_f32 v221, s48, v221
    v_mul_f32 v222, s48, v222
    v_mul_f32 v223, s48, v223
    v_exp_f32 v216, v216
    v_max_f32 v200, 0, v200
    v_exp_f32 v217, v217
    v_max_f32 v201, 0, v201
    v_exp_f32 v218, v218
    buffer_load_dwordx4 v246, s[8:11], s30 offen offset:2048 lds
    v_max_f32 v202, 0, v202
    v_exp_f32 v219, v219
    v_max_f32 v203, 0, v203
    v_exp_f32 v220, v220
    v_max_f32 v204, 0, v204
    v_exp_f32 v221, v221
    v_max_f32 v205, 0, v205
    v_exp_f32 v222, v222
    v_max_f32 v206, 0, v206
    v_exp_f32 v223, v223
    buffer_load_dwordx4 v247, s[8:11], s30 offen offset:3072 lds
    v_max_f32 v207, 0, v207
    v_add_f32 v200, s49, v200
    v_add_f32 v201, s49, v201
    v_add_f32 v202, s49, v202
    v_add_f32 v203, s49, v203
    v_add_f32 v204, s49, v204
    v_add_f32 v205, s49, v205
    v_add_f32 v206, s49, v206
    v_add_f32 v207, s49, v207
    v_add_f32 v200, v200, v216
    s_add_u32 m0, m0, 4096
    s_cmp_ge_u32 s31, 81920
    s_cselect_b32 s31, 0, s31
    buffer_load_dwordx4 v248, s[8:11], s30 offen lds
    s_add_u32 s30, s30, s26
    v_add_f32 v201, v201, v217
    v_add_f32 v202, v202, v218
    v_add_f32 v203, v203, v219
    v_add_f32 v204, v204, v220
    v_add_f32 v205, v205, v221
    v_add_f32 v206, v206, v222
    v_add_f32 v207, v207, v223
    v_cvt_pk_bf16_f32 v200, v200, v201
    v_cvt_pk_bf16_f32 v201, v202, v203
    v_cvt_pk_bf16_f32 v202, v204, v205
    v_cvt_pk_bf16_f32 v203, v206, v207
    s_waitcnt vmcnt(5)
    s_barrier
    s_add_u32 m0, s31, s43
    s_add_u32 s31, s31, 20480
    buffer_load_dwordx4 v244, s[8:11], s30 offen lds
    v_min_f32 v216, 0, v208
    v_min_f32 v217, 0, v209
    v_min_f32 v218, 0, v210
    v_min_f32 v219, 0, v211
    v_min_f32 v220, 0, v212
    v_min_f32 v221, 0, v213
    v_min_f32 v222, 0, v214
    v_min_f32 v223, 0, v215
    v_mul_f32 v216, s48, v216
    v_mul_f32 v217, s48, v217
    v_mul_f32 v218, s48, v218
    buffer_load_dwordx4 v245, s[8:11], s30 offen offset:1024 lds
    v_mul_f32 v219, s48, v219
    v_mul_f32 v220, s48, v220
    v_mul_f32 v221, s48, v221
    v_mul_f32 v222, s48, v222
    v_mul_f32 v223, s48, v223
    v_exp_f32 v216, v216
    v_max_f32 v208, 0, v208
    v_exp_f32 v217, v217
    v_max_f32 v209, 0, v209
    v_exp_f32 v218, v218
    buffer_load_dwordx4 v246, s[8:11], s30 offen offset:2048 lds
    v_max_f32 v210, 0, v210
    v_exp_f32 v219, v219
    v_max_f32 v211, 0, v211
    v_exp_f32 v220, v220
    v_max_f32 v212, 0, v212
    v_exp_f32 v221, v221
    v_max_f32 v213, 0, v213
    v_exp_f32 v222, v222
    v_max_f32 v214, 0, v214
    v_exp_f32 v223, v223
    buffer_load_dwordx4 v247, s[8:11], s30 offen offset:3072 lds
    v_max_f32 v215, 0, v215
    v_add_f32 v208, s49, v208
    v_add_f32 v209, s49, v209
    v_add_f32 v210, s49, v210
    v_add_f32 v211, s49, v211
    v_add_f32 v212, s49, v212
    v_add_f32 v213, s49, v213
    v_add_f32 v214, s49, v214
    v_add_f32 v215, s49, v215
    v_add_f32 v208, v208, v216
    s_add_u32 m0, m0, 4096
    s_cmp_ge_u32 s31, 81920
    s_cselect_b32 s31, 0, s31
    buffer_load_dwordx4 v248, s[8:11], s30 offen lds
    s_add_u32 s30, s30, s26
    v_add_f32 v209, v209, v217
    v_add_f32 v210, v210, v218
    v_add_f32 v211, v211, v219
    v_add_f32 v212, v212, v220
    v_add_f32 v213, v213, v221
    v_add_f32 v214, v214, v222
    v_add_f32 v215, v215, v223
    v_cvt_pk_bf16_f32 v208, v208, v209
    v_cvt_pk_bf16_f32 v209, v210, v211
    v_cvt_pk_bf16_f32 v210, v212, v213
    v_cvt_pk_bf16_f32 v211, v214, v215
    s_waitcnt vmcnt(5) lgkmcnt(0)
    s_barrier
    s_add_u32 m0, s31, s43
    s_add_u32 s31, s31, 20480
    buffer_load_dwordx4 v244, s[8:11], s30 offen lds
    buffer_load_dwordx4 v245, s[8:11], s30 offen offset:1024 lds
    buffer_load_dwordx4 v246, s[8:11], s30 offen offset:2048 lds
    buffer_load_dwordx4 v247, s[8:11], s30 offen offset:3072 lds
    s_add_u32 m0, m0, 4096
    s_cmp_ge_u32 s31, 81920
    s_cselect_b32 s31, 0, s31
    buffer_load_dwordx4 v248, s[8:11], s30 offen lds
    s_add_u32 s30, s30, s26
    s_mov_b32 s33, 2130706432
    buffer_load_dword v252, v251, s[12:15], s33 offen
    ds_write_b128 v249, v[144:147] offset:0
    ds_write_b128 v249, v[152:155] offset:4096
    ds_write_b128 v249, v[160:163] offset:8192
    ds_write_b128 v249, v[168:171] offset:12288
    ds_write_b128 v249, v[176:179] offset:16384
    ds_write_b128 v249, v[184:187] offset:20480
    ds_write_b128 v249, v[192:195] offset:24576
    ds_write_b128 v249, v[200:203] offset:28672
    ds_write_b128 v249, v[208:211] offset:32768
    s_setpc_b64 s[50:51]
.p2align 6
k1_kernel_epi_z1_side:
    v_fma_f32 v216, -v144, v144, s46
    v_fma_f32 v217, -v145, v145, s46
    v_fma_f32 v218, -v146, v146, s46
    v_fma_f32 v219, -v147, v147, s46
    v_fma_f32 v220, -v148, v148, s46
    v_fma_f32 v221, -v149, v149, s46
    v_fma_f32 v222, -v150, v150, s46
    v_fma_f32 v223, -v151, v151, s46
    v_mul_f32 v216, v144, v216
    v_mul_f32 v217, v145, v217
    v_mul_f32 v218, v146, v218
    v_mul_f32 v219, v147, v219
    v_mul_f32 v220, v148, v220
    v_mul_f32 v221, v149, v221
    v_mul_f32 v222, v150, v222
    v_mul_f32 v223, v151, v223
    v_exp_f32 v216, v216
    v_exp_f32 v217, v217
    v_add_f32 v216, 1.0, v216
    v_exp_f32 v218, v218
    v_add_f32 v217, 1.0, v217
    v_exp_f32 v219, v219
    v_add_f32 v218, 1.0, v218
    v_exp_f32 v220, v220
    v_add_f32 v219, 1.0, v219
    v_exp_f32 v221, v221
    v_add_f32 v220, 1.0, v220
    v_exp_f32 v222, v222
    v_add_f32 v221, 1.0, v221
    v_exp_f32 v223, v223
    v_add_f32 v222, 1.0, v222
    v_rcp_f32 v216, v216
    v_add_f32 v223, 1.0, v223
    v_rcp_f32 v217, v217
    v_mul_f32 v144, v144, v216
    v_rcp_f32 v218, v218
    v_mul_f32 v145, v145, v217
    v_rcp_f32 v219, v219
    v_mul_f32 v146, v146, v218
    v_rcp_f32 v220, v220
    v_mul_f32 v147, v147, v219
    v_rcp_f32 v221, v221
    v_mul_f32 v148, v148, v220
    v_rcp_f32 v222, v222
    v_mul_f32 v149, v149, v221
    v_rcp_f32 v223, v223
    v_mul_f32 v150, v150, v222
    s_nop 0
    v_mul_f32 v151, v151, v223
    v_cvt_pk_bf16_f32 v144, v144, v145
    v_cvt_pk_bf16_f32 v145, v146, v147
    v_cvt_pk_bf16_f32 v146, v148, v149
    v_cvt_pk_bf16_f32 v147, v150, v151
    s_barrier
    s_add_u32 m0, s31, s43
    s_add_u32 s31, s31, 20480
    buffer_load_dwordx4 v244, s[8:11], s30 offen lds
    v_fma_f32 v216, -v152, v152, s46
    v_fma_f32 v217, -v153, v153, s46
    v_fma_f32 v218, -v154, v154, s46
    v_fma_f32 v219, -v155, v155, s46
    v_fma_f32 v220, -v156, v156, s46
    v_fma_f32 v221, -v157, v157, s46
    v_fma_f32 v222, -v158, v158, s46
    v_fma_f32 v223, -v159, v159, s46
    v_mul_f32 v216, v152, v216
    v_mul_f32 v217, v153, v217
    v_mul_f32 v218, v154, v218
    buffer_load_dwordx4 v245, s[8:11], s30 offen offset:1024 lds
    v_mul_f32 v219, v155, v219
    v_mul_f32 v220, v156, v220
    v_mul_f32 v221, v157, v221
    v_mul_f32 v222, v158, v222
    v_mul_f32 v223, v159, v223
    v_exp_f32 v216, v216
    v_exp_f32 v217, v217
    v_add_f32 v216, 1.0, v216
    v_exp_f32 v218, v218
    v_add_f32 v217, 1.0, v217
    buffer_load_dwordx4 v246, s[8:11], s30 offen offset:2048 lds
    v_exp_f32 v219, v219
    v_add_f32 v218, 1.0, v218
    v_exp_f32 v220, v220
    v_add_f32 v219, 1.0, v219
    v_exp_f32 v221, v221
    v_add_f32 v220, 1.0, v220
    v_exp_f32 v222, v222
    v_add_f32 v221, 1.0, v221
    v_exp_f32 v223, v223
    v_add_f32 v222, 1.0, v222
    buffer_load_dwordx4 v247, s[8:11], s30 offen offset:3072 lds
    v_rcp_f32 v216, v216
    v_add_f32 v223, 1.0, v223
    v_rcp_f32 v217, v217
    v_mul_f32 v152, v152, v216
    v_rcp_f32 v218, v218
    v_mul_f32 v153, v153, v217
    v_rcp_f32 v219, v219
    v_mul_f32 v154, v154, v218
    v_rcp_f32 v220, v220
    v_mul_f32 v155, v155, v219
    s_add_u32 m0, m0, 4096
    s_cmp_ge_u32 s31, 81920
    s_cselect_b32 s31, 0, s31
    buffer_load_dwordx4 v248, s[8:11], s30 offen lds
    s_add_u32 s30, s30, s26
    v_rcp_f32 v221, v221
    v_mul_f32 v156, v156, v220
    v_rcp_f32 v222, v222
    v_mul_f32 v157, v157, v221
    v_rcp_f32 v223, v223
    v_mul_f32 v158, v158, v222
    s_nop 0
    v_mul_f32 v159, v159, v223
    v_cvt_pk_bf16_f32 v152, v152, v153
    v_cvt_pk_bf16_f32 v153, v154, v155
    v_cvt_pk_bf16_f32 v154, v156, v157
    v_cvt_pk_bf16_f32 v155, v158, v159
    s_barrier
    s_add_u32 m0, s31, s43
    s_add_u32 s31, s31, 20480
    buffer_load_dwordx4 v244, s[8:11], s30 offen lds
    v_fma_f32 v216, -v160, v160, s46
    v_fma_f32 v217, -v161, v161, s46
    v_fma_f32 v218, -v162, v162, s46
    v_fma_f32 v219, -v163, v163, s46
    v_fma_f32 v220, -v164, v164, s46
    v_fma_f32 v221, -v165, v165, s46
    v_fma_f32 v222, -v166, v166, s46
    v_fma_f32 v223, -v167, v167, s46
    v_mul_f32 v216, v160, v216
    v_mul_f32 v217, v161, v217
    v_mul_f32 v218, v162, v218
    buffer_load_dwordx4 v245, s[8:11], s30 offen offset:1024 lds
    v_mul_f32 v219, v163, v219
    v_mul_f32 v220, v164, v220
    v_mul_f32 v221, v165, v221
    v_mul_f32 v222, v166, v222
    v_mul_f32 v223, v167, v223
    v_exp_f32 v216, v216
    v_exp_f32 v217, v217
    v_add_f32 v216, 1.0, v216
    v_exp_f32 v218, v218
    v_add_f32 v217, 1.0, v217
    buffer_load_dwordx4 v246, s[8:11], s30 offen offset:2048 lds
    v_exp_f32 v219, v219
    v_add_f32 v218, 1.0, v218
    v_exp_f32 v220, v220
    v_add_f32 v219, 1.0, v219
    v_exp_f32 v221, v221
    v_add_f32 v220, 1.0, v220
    v_exp_f32 v222, v222
    v_add_f32 v221, 1.0, v221
    v_exp_f32 v223, v223
    v_add_f32 v222, 1.0, v222
    buffer_load_dwordx4 v247, s[8:11], s30 offen offset:3072 lds
    v_rcp_f32 v216, v216
    v_add_f32 v223, 1.0, v223
    v_rcp_f32 v217, v217
    v_mul_f32 v160, v160, v216
    v_rcp_f32 v218, v218
    v_mul_f32 v161, v161, v217
    v_rcp_f32 v219, v219
    v_mul_f32 v162, v162, v218
    v_rcp_f32 v220, v220
    v_mul_f32 v163, v163, v219
    s_add_u32 m0, m0, 4096
    s_cmp_ge_u32 s31, 81920
    s_cselect_b32 s31, 0, s31
    buffer_load_dwordx4 v248, s[8:11], s30 offen lds
    s_add_u32 s30, s30, s26
    v_rcp_f32 v221, v221
    v_mul_f32 v164, v164, v220
    v_rcp_f32 v222, v222
    v_mul_f32 v165, v165, v221
    v_rcp_f32 v223, v223
    v_mul_f32 v166, v166, v222
    s_nop 0
    v_mul_f32 v167, v167, v223
    v_cvt_pk_bf16_f32 v160, v160, v161
    v_cvt_pk_bf16_f32 v161, v162, v163
    v_cvt_pk_bf16_f32 v162, v164, v165
    v_cvt_pk_bf16_f32 v163, v166, v167
    s_waitcnt vmcnt(5)
    s_barrier
    s_add_u32 m0, s31, s43
    s_add_u32 s31, s31, 20480
    buffer_load_dwordx4 v244, s[8:11], s30 offen lds
    v_fma_f32 v216, -v168, v168, s46
    v_fma_f32 v217, -v169, v169, s46
    v_fma_f32 v218, -v170, v170, s46
    v_fma_f32 v219, -v171, v171, s46
    v_fma_f32 v220, -v172, v172, s46
    v_fma_f32 v221, -v173, v173, s46
    v_fma_f32 v222, -v174, v174, s46
    v_fma_f32 v223, -v175, v175, s46
    v_mul_f32 v216, v168, v216
    v_mul_f32 v217, v169, v217
    v_mul_f32 v218, v170, v218
    buffer_load_dwordx4 v245, s[8:11], s30 offen offset:1024 lds
    v_mul_f32 v219, v171, v219
    v_mul_f32 v220, v172, v220
    v_mul_f32 v221, v173, v221
    v_mul_f32 v222, v174, v222
    v_mul_f32 v223, v175, v223
    v_exp_f32 v216, v216
    v_exp_f32 v217, v217
    v_add_f32 v216, 1.0, v216
    v_exp_f32 v218, v218
    v_add_f32 v217, 1.0, v217
    buffer_load_dwordx4 v246, s[8:11], s30 offen offset:2048 lds
    v_exp_f32 v219, v219
    v_add_f32 v218, 1.0, v218
    v_exp_f32 v220, v220
    v_add_f32 v219, 1.0, v219
    v_exp_f32 v221, v221
    v_add_f32 v220, 1.0, v220
    v_exp_f32 v222, v222
    v_add_f32 v221, 1.0, v221
    v_exp_f32 v223, v223
    v_add_f32 v222, 1.0, v222
    buffer_load_dwordx4 v247, s[8:11], s30 offen offset:3072 lds
    v_rcp_f32 v216, v216
    v_add_f32 v223, 1.0, v223
    v_rcp_f32 v217, v217
    v_mul_f32 v168, v168, v216
    v_rcp_f32 v218, v218
    v_mul_f32 v169, v169, v217
    v_rcp_f32 v219, v219
    v_mul_f32 v170, v170, v218
    v_rcp_f32 v220, v220
    v_mul_f32 v171, v171, v219
    s_add_u32 m0, m0, 4096
    s_cmp_ge_u32 s31, 81920
    s_cselect_b32 s31, 0, s31
    buffer_load_dwordx4 v248, s[8:11], s30 offen lds
    s_add_u32 s30, s30, s26
    v_rcp_f32 v221, v221
    v_mul_f32 v172, v172, v220
    v_rcp_f32 v222, v222
    v_mul_f32 v173, v173, v221
    v_rcp_f32 v223, v223
    v_mul_f32 v174, v174, v222
    s_nop 0
    v_mul_f32 v175, v175, v223
    v_cvt_pk_bf16_f32 v168, v168, v169
    v_cvt_pk_bf16_f32 v169, v170, v171
    v_cvt_pk_bf16_f32 v170, v172, v173
    v_cvt_pk_bf16_f32 v171, v174, v175
    s_waitcnt vmcnt(5)
    s_barrier
    s_add_u32 m0, s31, s43
    s_add_u32 s31, s31, 20480
    buffer_load_dwordx4 v244, s[8:11], s30 offen lds
    v_fma_f32 v216, -v176, v176, s46
    v_fma_f32 v217, -v177, v177, s46
    v_fma_f32 v218, -v178, v178, s46
    v_fma_f32 v219, -v179, v179, s46
    v_fma_f32 v220, -v180, v180, s46
    v_fma_f32 v221, -v181, v181, s46
    v_fma_f32 v222, -v182, v182, s46
    v_fma_f32 v223, -v183, v183, s46
    v_mul_f32 v216, v176, v216
    v_mul_f32 v217, v177, v217
    v_mul_f32 v218, v178, v218
    buffer_load_dwordx4 v245, s[8:11], s30 offen offset:1024 lds
    v_mul_f32 v219, v179, v219
    v_mul_f32 v220, v180, v220
    v_mul_f32 v221, v181, v221
    v_mul_f32 v222, v182, v222
    v_mul_f32 v223, v183, v223
    v_exp_f32 v216, v216
    v_exp_f32 v217, v217
    v_add_f32 v216, 1.0, v216
    v_exp_f32 v218, v218
    v_add_f32 v217, 1.0, v217
    buffer_load_dwordx4 v246, s[8:11], s30 offen offset:2048 lds
    v_exp_f32 v219, v219
    v_add_f32 v218, 1.0, v218
    v_exp_f32 v220, v220
    v_add_f32 v219, 1.0, v219
    v_exp_f32 v221, v221
    v_add_f32 v220, 1.0, v220
    v_exp_f32 v222, v222
    v_add_f32 v221, 1.0, v221
    v_exp_f32 v223, v223
    v_add_f32 v222, 1.0, v222
    buffer_load_dwordx4 v247, s[8:11], s30 offen offset:3072 lds
    v_rcp_f32 v216, v216
    v_add_f32 v223, 1.0, v223
    v_rcp_f32 v217, v217
    v_mul_f32 v176, v176, v216
    v_rcp_f32 v218, v218
    v_mul_f32 v177, v177, v217
    v_rcp_f32 v219, v219
    v_mul_f32 v178, v178, v218
    v_rcp_f32 v220, v220
    v_mul_f32 v179, v179, v219
    s_add_u32 m0, m0, 4096
    s_cmp_ge_u32 s31, 81920
    s_cselect_b32 s31, 0, s31
    buffer_load_dwordx4 v248, s[8:11], s30 offen lds
    s_add_u32 s30, s30, s26
    v_rcp_f32 v221, v221
    v_mul_f32 v180, v180, v220
    v_rcp_f32 v222, v222
    v_mul_f32 v181, v181, v221
    v_rcp_f32 v223, v223
    v_mul_f32 v182, v182, v222
    s_nop 0
    v_mul_f32 v183, v183, v223
    v_cvt_pk_bf16_f32 v176, v176, v177
    v_cvt_pk_bf16_f32 v177, v178, v179
    v_cvt_pk_bf16_f32 v178, v180, v181
    v_cvt_pk_bf16_f32 v179, v182, v183
    s_waitcnt vmcnt(5)
    s_barrier
    s_add_u32 m0, s31, s43
    s_add_u32 s31, s31, 20480
    buffer_load_dwordx4 v244, s[8:11], s30 offen lds
    v_fma_f32 v216, -v184, v184, s46
    v_fma_f32 v217, -v185, v185, s46
    v_fma_f32 v218, -v186, v186, s46
    v_fma_f32 v219, -v187, v187, s46
    v_fma_f32 v220, -v188, v188, s46
    v_fma_f32 v221, -v189, v189, s46
    v_fma_f32 v222, -v190, v190, s46
    v_fma_f32 v223, -v191, v191, s46
    v_mul_f32 v216, v184, v216
    v_mul_f32 v217, v185, v217
    v_mul_f32 v218, v186, v218
    buffer_load_dwordx4 v245, s[8:11], s30 offen offset:1024 lds
    v_mul_f32 v219, v187, v219
    v_mul_f32 v220, v188, v220
    v_mul_f32 v221, v189, v221
    v_mul_f32 v222, v190, v222
    v_mul_f32 v223, v191, v223
    v_exp_f32 v216, v216
    v_exp_f32 v217, v217
    v_add_f32 v216, 1.0, v216
    v_exp_f32 v218, v218
    v_add_f32 v217, 1.0, v217
    buffer_load_dwordx4 v246, s[8:11], s30 offen offset:2048 lds
    v_exp_f32 v219, v219
    v_add_f32 v218, 1.0, v218
    v_exp_f32 v220, v220
    v_add_f32 v219, 1.0, v219
    v_exp_f32 v221, v221
    v_add_f32 v220, 1.0, v220
    v_exp_f32 v222, v222
    v_add_f32 v221, 1.0, v221
    v_exp_f32 v223, v223
    v_add_f32 v222, 1.0, v222
    buffer_load_dwordx4 v247, s[8:11], s30 offen offset:3072 lds
    v_rcp_f32 v216, v216
    v_add_f32 v223, 1.0, v223
    v_rcp_f32 v217, v217
    v_mul_f32 v184, v184, v216
    v_rcp_f32 v218, v218
    v_mul_f32 v185, v185, v217
    v_rcp_f32 v219, v219
    v_mul_f32 v186, v186, v218
    v_rcp_f32 v220, v220
    v_mul_f32 v187, v187, v219
    s_add_u32 m0, m0, 4096
    s_cmp_ge_u32 s31, 81920
    s_cselect_b32 s31, 0, s31
    buffer_load_dwordx4 v248, s[8:11], s30 offen lds
    s_add_u32 s30, s30, s26
    v_rcp_f32 v221, v221
    v_mul_f32 v188, v188, v220
    v_rcp_f32 v222, v222
    v_mul_f32 v189, v189, v221
    v_rcp_f32 v223, v223
    v_mul_f32 v190, v190, v222
    s_nop 0
    v_mul_f32 v191, v191, v223
    v_cvt_pk_bf16_f32 v184, v184, v185
    v_cvt_pk_bf16_f32 v185, v186, v187
    v_cvt_pk_bf16_f32 v186, v188, v189
    v_cvt_pk_bf16_f32 v187, v190, v191
    s_waitcnt vmcnt(5)
    s_barrier
    s_add_u32 m0, s31, s43
    s_add_u32 s31, s31, 20480
    buffer_load_dwordx4 v244, s[8:11], s30 offen lds
    v_fma_f32 v216, -v192, v192, s46
    v_fma_f32 v217, -v193, v193, s46
    v_fma_f32 v218, -v194, v194, s46
    v_fma_f32 v219, -v195, v195, s46
    v_fma_f32 v220, -v196, v196, s46
    v_fma_f32 v221, -v197, v197, s46
    v_fma_f32 v222, -v198, v198, s46
    v_fma_f32 v223, -v199, v199, s46
    v_mul_f32 v216, v192, v216
    v_mul_f32 v217, v193, v217
    v_mul_f32 v218, v194, v218
    buffer_load_dwordx4 v245, s[8:11], s30 offen offset:1024 lds
    v_mul_f32 v219, v195, v219
    v_mul_f32 v220, v196, v220
    v_mul_f32 v221, v197, v221
    v_mul_f32 v222, v198, v222
    v_mul_f32 v223, v199, v223
    v_exp_f32 v216, v216
    v_exp_f32 v217, v217
    v_add_f32 v216, 1.0, v216
    v_exp_f32 v218, v218
    v_add_f32 v217, 1.0, v217
    buffer_load_dwordx4 v246, s[8:11], s30 offen offset:2048 lds
    v_exp_f32 v219, v219
    v_add_f32 v218, 1.0, v218
    v_exp_f32 v220, v220
    v_add_f32 v219, 1.0, v219
    v_exp_f32 v221, v221
    v_add_f32 v220, 1.0, v220
    v_exp_f32 v222, v222
    v_add_f32 v221, 1.0, v221
    v_exp_f32 v223, v223
    v_add_f32 v222, 1.0, v222
    buffer_load_dwordx4 v247, s[8:11], s30 offen offset:3072 lds
    v_rcp_f32 v216, v216
    v_add_f32 v223, 1.0, v223
    v_rcp_f32 v217, v217
    v_mul_f32 v192, v192, v216
    v_rcp_f32 v218, v218
    v_mul_f32 v193, v193, v217
    v_rcp_f32 v219, v219
    v_mul_f32 v194, v194, v218
    v_rcp_f32 v220, v220
    v_mul_f32 v195, v195, v219
    s_add_u32 m0, m0, 4096
    s_cmp_ge_u32 s31, 81920
    s_cselect_b32 s31, 0, s31
    buffer_load_dwordx4 v248, s[8:11], s30 offen lds
    s_add_u32 s30, s30, s26
    v_rcp_f32 v221, v221
    v_mul_f32 v196, v196, v220
    v_rcp_f32 v222, v222
    v_mul_f32 v197, v197, v221
    v_rcp_f32 v223, v223
    v_mul_f32 v198, v198, v222
    s_nop 0
    v_mul_f32 v199, v199, v223
    v_cvt_pk_bf16_f32 v192, v192, v193
    v_cvt_pk_bf16_f32 v193, v194, v195
    v_cvt_pk_bf16_f32 v194, v196, v197
    v_cvt_pk_bf16_f32 v195, v198, v199
    s_waitcnt vmcnt(5)
    s_barrier
    v_fma_f32 v216, -v200, v200, s46
    v_fma_f32 v217, -v201, v201, s46
    v_fma_f32 v218, -v202, v202, s46
    v_fma_f32 v219, -v203, v203, s46
    v_fma_f32 v220, -v204, v204, s46
    v_fma_f32 v221, -v205, v205, s46
    v_fma_f32 v222, -v206, v206, s46
    v_fma_f32 v223, -v207, v207, s46
    v_mul_f32 v216, v200, v216
    v_mul_f32 v217, v201, v217
    v_mul_f32 v218, v202, v218
    v_mul_f32 v219, v203, v219
    v_mul_f32 v220, v204, v220
    v_mul_f32 v221, v205, v221
    v_mul_f32 v222, v206, v222
    v_mul_f32 v223, v207, v223
    v_exp_f32 v216, v216
    v_exp_f32 v217, v217
    v_add_f32 v216, 1.0, v216
    v_exp_f32 v218, v218
    v_add_f32 v217, 1.0, v217
    v_exp_f32 v219, v219
    v_add_f32 v218, 1.0, v218
    v_exp_f32 v220, v220
    v_add_f32 v219, 1.0, v219
    v_exp_f32 v221, v221
    v_add_f32 v220, 1.0, v220
    v_exp_f32 v222, v222
    v_add_f32 v221, 1.0, v221
    v_exp_f32 v223, v223
    v_add_f32 v222, 1.0, v222
    v_rcp_f32 v216, v216
    v_add_f32 v223, 1.0, v223
    v_rcp_f32 v217, v217
    v_mul_f32 v200, v200, v216
    v_rcp_f32 v218, v218
    v_mul_f32 v201, v201, v217
    v_rcp_f32 v219, v219
    v_mul_f32 v202, v202, v218
    v_rcp_f32 v220, v220
    v_mul_f32 v203, v203, v219
    v_rcp_f32 v221, v221
    v_mul_f32 v204, v204, v220
    v_rcp_f32 v222, v222
    v_mul_f32 v205, v205, v221
    v_rcp_f32 v223, v223
    v_mul_f32 v206, v206, v222
    s_nop 0
    v_mul_f32 v207, v207, v223
    v_cvt_pk_bf16_f32 v200, v200, v201
    v_cvt_pk_bf16_f32 v201, v202, v203
    v_cvt_pk_bf16_f32 v202, v204, v205
    v_cvt_pk_bf16_f32 v203, v206, v207
    s_waitcnt vmcnt(0)
    s_barrier
    v_lshrrev_b32 v96, 9, v251
    v_lshlrev_b32 v96, 11, v96
    v_and_b32 v97, 0x1f0, v251
    v_add_u32 v96, v96, v97
    s_lshl_b32 s97, s20, 15
    s_lshl_b32 s36, s24, 9
    s_add_u32 s97, s97, s36
    s_add_u32 s97, s97, 33300480
    s_mov_b32 s36, s97
    buffer_load_dwordx4 v[64:67], v96, s[12:15], s36 offen sc1
    s_add_u32 s36, s36, 4096
    buffer_load_dwordx4 v[68:71], v96, s[12:15], s36 offen sc1
    s_add_u32 s36, s36, 4096
    buffer_load_dwordx4 v[72:75], v96, s[12:15], s36 offen sc1
    s_add_u32 s36, s36, 4096
    buffer_load_dwordx4 v[76:79], v96, s[12:15], s36 offen sc1
    s_add_u32 s36, s36, 4096
    buffer_load_dwordx4 v[80:83], v96, s[12:15], s36 offen sc1
    s_add_u32 s36, s36, 4096
    buffer_load_dwordx4 v[84:87], v96, s[12:15], s36 offen sc1
    s_add_u32 s36, s36, 4096
    buffer_load_dwordx4 v[88:91], v96, s[12:15], s36 offen sc1
    s_add_u32 s36, s36, 4096
    buffer_load_dwordx4 v[92:95], v96, s[12:15], s36 offen sc1
    s_mov_b32 s96, 1
    v_fma_f32 v216, -v208, v208, s46
    v_fma_f32 v217, -v209, v209, s46
    v_fma_f32 v218, -v210, v210, s46
    v_fma_f32 v219, -v211, v211, s46
    v_fma_f32 v220, -v212, v212, s46
    v_fma_f32 v221, -v213, v213, s46
    v_fma_f32 v222, -v214, v214, s46
    v_fma_f32 v223, -v215, v215, s46
    v_mul_f32 v216, v208, v216
    v_mul_f32 v217, v209, v217
    v_mul_f32 v218, v210, v218
    v_mul_f32 v219, v211, v219
    v_mul_f32 v220, v212, v220
    v_mul_f32 v221, v213, v221
    v_mul_f32 v222, v214, v222
    v_mul_f32 v223, v215, v223
    v_exp_f32 v216, v216
    v_exp_f32 v217, v217
    v_add_f32 v216, 1.0, v216
    v_exp_f32 v218, v218
    v_add_f32 v217, 1.0, v217
    v_exp_f32 v219, v219
    v_add_f32 v218, 1.0, v218
    v_exp_f32 v220, v220
    v_add_f32 v219, 1.0, v219
    v_exp_f32 v221, v221
    v_add_f32 v220, 1.0, v220
    v_exp_f32 v222, v222
    v_add_f32 v221, 1.0, v221
    v_exp_f32 v223, v223
    v_add_f32 v222, 1.0, v222
    v_rcp_f32 v216, v216
    v_add_f32 v223, 1.0, v223
    v_rcp_f32 v217, v217
    v_mul_f32 v208, v208, v216
    v_rcp_f32 v218, v218
    v_mul_f32 v209, v209, v217
    v_rcp_f32 v219, v219
    v_mul_f32 v210, v210, v218
    v_rcp_f32 v220, v220
    v_mul_f32 v211, v211, v219
    v_rcp_f32 v221, v221
    v_mul_f32 v212, v212, v220
    v_rcp_f32 v222, v222
    v_mul_f32 v213, v213, v221
    v_rcp_f32 v223, v223
    v_mul_f32 v214, v214, v222
    s_nop 0
    v_mul_f32 v215, v215, v223
    v_cvt_pk_bf16_f32 v208, v208, v209
    v_cvt_pk_bf16_f32 v209, v210, v211
    v_cvt_pk_bf16_f32 v210, v212, v213
    v_cvt_pk_bf16_f32 v211, v214, v215
    s_waitcnt lgkmcnt(0)
    s_barrier
    s_setpc_b64 s[50:51]
.p2align 6
k1_kernel_epi_z1_solo:
    s_mul_i32 s44, s40, 9
    s_lshr_b32 s44, s44, 1
    s_mul_i32 s44, s44, 131072
    s_lshl_b32 s35, s20, 13
    s_add_u32 s44, s44, s35
    s_lshl_b32 s35, s24, 11
    s_add_u32 s44, s44, s35
    s_add_u32 s44, s44, 18874368
    s_and_b32 s35, s40, 1
    s_cselect_b32 s99, 0, 524288
    s_add_u32 s99, s99, s44
    v_lshrrev_b32 v249, 7, v251
    v_sub_u32 v249, 0, v249
    v_and_b32 v249, 3, v249
    v_bfe_u32 v252, v251, 4, 1
    v_xor_b32 v249, v249, v252
    s_lshl_b32 s35, s35, 1
    v_xor_b32 v249, s35, v249
    v_lshlrev_b32 v249, 4, v249
    v_lshrrev_b32 v252, 5, v251
    v_lshl_add_u32 v249, v252, 6, v249
    s_mul_i32 s35, s35, 65536
    s_add_u32 s44, s44, s35
    v_pk_fma_f32 v[216:217], v[144:145], v[144:145], s[46:47] op_sel_hi:[1,1,0] neg_lo:[1,0,0] neg_hi:[1,0,0]
    v_pk_fma_f32 v[218:219], v[146:147], v[146:147], s[46:47] op_sel_hi:[1,1,0] neg_lo:[1,0,0] neg_hi:[1,0,0]
    v_pk_fma_f32 v[220:221], v[148:149], v[148:149], s[46:47] op_sel_hi:[1,1,0] neg_lo:[1,0,0] neg_hi:[1,0,0]
    v_pk_fma_f32 v[222:223], v[150:151], v[150:151], s[46:47] op_sel_hi:[1,1,0] neg_lo:[1,0,0] neg_hi:[1,0,0]
    v_pk_mul_f32 v[216:217], v[216:217], v[144:145]
    v_pk_mul_f32 v[218:219], v[218:219], v[146:147]
    v_pk_mul_f32 v[220:221], v[220:221], v[148:149]
    v_pk_mul_f32 v[222:223], v[222:223], v[150:151]
    v_exp_f32 v216, v216
    v_exp_f32 v217, v217
    v_exp_f32 v218, v218
    v_exp_f32 v219, v219
    v_pk_add_f32 v[216:217], v[216:217], 1.0 op_sel_hi:[1,0]
    v_exp_f32 v220, v220
    v_exp_f32 v221, v221
    v_pk_add_f32 v[218:219], v[218:219], 1.0 op_sel_hi:[1,0]
    v_exp_f32 v222, v222
    v_exp_f32 v223, v223
    v_pk_add_f32 v[220:221], v[220:221], 1.0 op_sel_hi:[1,0]
    v_rcp_f32 v216, v216
    v_pk_add_f32 v[222:223], v[222:223], 1.0 op_sel_hi:[1,0]
    v_rcp_f32 v217, v217
    v_rcp_f32 v218, v218
    v_pk_mul_f32 v[144:145], v[144:145], v[216:217]
    v_rcp_f32 v219, v219
    v_rcp_f32 v220, v220
    v_pk_mul_f32 v[146:147], v[146:147], v[218:219]
    v_rcp_f32 v221, v221
    v_rcp_f32 v222, v222
    v_pk_mul_f32 v[148:149], v[148:149], v[220:221]
    v_rcp_f32 v223, v223
    s_nop 0
    v_pk_mul_f32 v[150:151], v[150:151], v[222:223]
    v_cvt_pk_bf16_f32 v144, v144, v145
    v_cvt_pk_bf16_f32 v145, v146, v147
    v_cvt_pk_bf16_f32 v146, v148, v149
    v_cvt_pk_bf16_f32 v147, v150, v151
    buffer_store_dwordx4 v[144:147], v251, s[12:15], s44 offen offset:0
    v_pk_fma_f32 v[216:217], v[152:153], v[152:153], s[46:47] op_sel_hi:[1,1,0] neg_lo:[1,0,0] neg_hi:[1,0,0]
    v_pk_fma_f32 v[218:219], v[154:155], v[154:155], s[46:47] op_sel_hi:[1,1,0] neg_lo:[1,0,0] neg_hi:[1,0,0]
    v_pk_fma_f32 v[220:221], v[156:157], v[156:157], s[46:47] op_sel_hi:[1,1,0] neg_lo:[1,0,0] neg_hi:[1,0,0]
    v_pk_fma_f32 v[222:223], v[158:159], v[158:159], s[46:47] op_sel_hi:[1,1,0] neg_lo:[1,0,0] neg_hi:[1,0,0]
    v_pk_mul_f32 v[216:217], v[216:217], v[152:153]
    v_pk_mul_f32 v[218:219], v[218:219], v[154:155]
    v_pk_mul_f32 v[220:221], v[220:221], v[156:157]
    v_pk_mul_f32 v[222:223], v[222:223], v[158:159]
    v_exp_f32 v216, v216
    v_exp_f32 v217, v217
    v_exp_f32 v218, v218
    v_exp_f32 v219, v219
    v_pk_add_f32 v[216:217], v[216:217], 1.0 op_sel_hi:[1,0]
    v_exp_f32 v220, v220
    v_exp_f32 v221, v221
    v_pk_add_f32 v[218:219], v[218:219], 1.0 op_sel_hi:[1,0]
    v_exp_f32 v222, v222
    v_exp_f32 v223, v223
    v_pk_add_f32 v[220:221], v[220:221], 1.0 op_sel_hi:[1,0]
    v_rcp_f32 v216, v216
    v_pk_add_f32 v[222:223], v[222:223], 1.0 op_sel_hi:[1,0]
    v_rcp_f32 v217, v217
    v_rcp_f32 v218, v218
    v_pk_mul_f32 v[152:153], v[152:153], v[216:217]
    v_rcp_f32 v219, v219
    v_rcp_f32 v220, v220
    v_pk_mul_f32 v[154:155], v[154:155], v[218:219]
    v_rcp_f32 v221, v221
    v_rcp_f32 v222, v222
    v_pk_mul_f32 v[156:157], v[156:157], v[220:221]
    v_rcp_f32 v223, v223
    s_nop 0
    v_pk_mul_f32 v[158:159], v[158:159], v[222:223]
    v_cvt_pk_bf16_f32 v152, v152, v153
    v_cvt_pk_bf16_f32 v153, v154, v155
    v_cvt_pk_bf16_f32 v154, v156, v157
    v_cvt_pk_bf16_f32 v155, v158, v159
    buffer_store_dwordx4 v[152:155], v251, s[12:15], s44 offen offset:1024
    v_pk_fma_f32 v[216:217], v[160:161], v[160:161], s[46:47] op_sel_hi:[1,1,0] neg_lo:[1,0,0] neg_hi:[1,0,0]
    v_pk_fma_f32 v[218:219], v[162:163], v[162:163], s[46:47] op_sel_hi:[1,1,0] neg_lo:[1,0,0] neg_hi:[1,0,0]
    v_pk_fma_f32 v[220:221], v[164:165], v[164:165], s[46:47] op_sel_hi:[1,1,0] neg_lo:[1,0,0] neg_hi:[1,0,0]
    v_pk_fma_f32 v[222:223], v[166:167], v[166:167], s[46:47] op_sel_hi:[1,1,0] neg_lo:[1,0,0] neg_hi:[1,0,0]
    v_pk_mul_f32 v[216:217], v[216:217], v[160:161]
    v_pk_mul_f32 v[218:219], v[218:219], v[162:163]
    v_pk_mul_f32 v[220:221], v[220:221], v[164:165]
    v_pk_mul_f32 v[222:223], v[222:223], v[166:167]
    v_exp_f32 v216, v216
    v_exp_f32 v217, v217
    v_exp_f32 v218, v218
    v_exp_f32 v219, v219
    v_pk_add_f32 v[216:217], v[216:217], 1.0 op_sel_hi:[1,0]
    v_exp_f32 v220, v220
    v_exp_f32 v221, v221
    v_pk_add_f32 v[218:219], v[218:219], 1.0 op_sel_hi:[1,0]
    v_exp_f32 v222, v222
    v_exp_f32 v223, v223
    v_pk_add_f32 v[220:221], v[220:221], 1.0 op_sel_hi:[1,0]
    v_rcp_f32 v216, v216
    v_pk_add_f32 v[222:223], v[222:223], 1.0 op_sel_hi:[1,0]
    v_rcp_f32 v217, v217
    v_rcp_f32 v218, v218
    v_pk_mul_f32 v[160:161], v[160:161], v[216:217]
    v_rcp_f32 v219, v219
    v_rcp_f32 v220, v220
    v_pk_mul_f32 v[162:163], v[162:163], v[218:219]
    v_rcp_f32 v221, v221
    v_rcp_f32 v222, v222
    v_pk_mul_f32 v[164:165], v[164:165], v[220:221]
    v_rcp_f32 v223, v223
    s_nop 0
    v_pk_mul_f32 v[166:167], v[166:167], v[222:223]
    v_cvt_pk_bf16_f32 v160, v160, v161
    v_cvt_pk_bf16_f32 v161, v162, v163
    v_cvt_pk_bf16_f32 v162, v164, v165
    v_cvt_pk_bf16_f32 v163, v166, v167
    s_add_u32 s44, s44, 131072
    buffer_store_dwordx4 v[160:163], v251, s[12:15], s44 offen offset:0
    v_pk_fma_f32 v[216:217], v[168:169], v[168:169], s[46:47] op_sel_hi:[1,1,0] neg_lo:[1,0,0] neg_hi:[1,0,0]
    v_pk_fma_f32 v[218:219], v[170:171], v[170:171], s[46:47] op_sel_hi:[1,1,0] neg_lo:[1,0,0] neg_hi:[1,0,0]
    v_pk_fma_f32 v[220:221], v[172:173], v[172:173], s[46:47] op_sel_hi:[1,1,0] neg_lo:[1,0,0] neg_hi:[1,0,0]
    v_pk_fma_f32 v[222:223], v[174:175], v[174:175], s[46:47] op_sel_hi:[1,1,0] neg_lo:[1,0,0] neg_hi:[1,0,0]
    v_pk_mul_f32 v[216:217], v[216:217], v[168:169]
    v_pk_mul_f32 v[218:219], v[218:219], v[170:171]
    v_pk_mul_f32 v[220:221], v[220:221], v[172:173]
    v_pk_mul_f32 v[222:223], v[222:223], v[174:175]
    v_exp_f32 v216, v216
    v_exp_f32 v217, v217
    v_exp_f32 v218, v218
    v_exp_f32 v219, v219
    v_pk_add_f32 v[216:217], v[216:217], 1.0 op_sel_hi:[1,0]
    v_exp_f32 v220, v220
    v_exp_f32 v221, v221
    v_pk_add_f32 v[218:219], v[218:219], 1.0 op_sel_hi:[1,0]
    v_exp_f32 v222, v222
    v_exp_f32 v223, v223
    v_pk_add_f32 v[220:221], v[220:221], 1.0 op_sel_hi:[1,0]
    v_rcp_f32 v216, v216
    v_pk_add_f32 v[222:223], v[222:223], 1.0 op_sel_hi:[1,0]
    v_rcp_f32 v217, v217
    v_rcp_f32 v218, v218
    v_pk_mul_f32 v[168:169], v[168:169], v[216:217]
    v_rcp_f32 v219, v219
    v_rcp_f32 v220, v220
    v_pk_mul_f32 v[170:171], v[170:171], v[218:219]
    v_rcp_f32 v221, v221
    v_rcp_f32 v222, v222
    v_pk_mul_f32 v[172:173], v[172:173], v[220:221]
    v_rcp_f32 v223, v223
    s_nop 0
    v_pk_mul_f32 v[174:175], v[174:175], v[222:223]
    v_cvt_pk_bf16_f32 v168, v168, v169
    v_cvt_pk_bf16_f32 v169, v170, v171
    v_cvt_pk_bf16_f32 v170, v172, v173
    v_cvt_pk_bf16_f32 v171, v174, v175
    buffer_store_dwordx4 v[168:171], v251, s[12:15], s44 offen offset:1024
    v_pk_fma_f32 v[216:217], v[176:177], v[176:177], s[46:47] op_sel_hi:[1,1,0] neg_lo:[1,0,0] neg_hi:[1,0,0]
    v_pk_fma_f32 v[218:219], v[178:179], v[178:179], s[46:47] op_sel_hi:[1,1,0] neg_lo:[1,0,0] neg_hi:[1,0,0]
    v_pk_fma_f32 v[220:221], v[180:181], v[180:181], s[46:47] op_sel_hi:[1,1,0] neg_lo:[1,0,0] neg_hi:[1,0,0]
    v_pk_fma_f32 v[222:223], v[182:183], v[182:183], s[46:47] op_sel_hi:[1,1,0] neg_lo:[1,0,0] neg_hi:[1,0,0]
    v_pk_mul_f32 v[216:217], v[216:217], v[176:177]
    v_pk_mul_f32 v[218:219], v[218:219], v[178:179]
    v_pk_mul_f32 v[220:221], v[220:221], v[180:181]
    v_pk_mul_f32 v[222:223], v[222:223], v[182:183]
    v_exp_f32 v216, v216
    v_exp_f32 v217, v217
    v_exp_f32 v218, v218
    v_exp_f32 v219, v219
    v_pk_add_f32 v[216:217], v[216:217], 1.0 op_sel_hi:[1,0]
    v_exp_f32 v220, v220
    v_exp_f32 v221, v221
    v_pk_add_f32 v[218:219], v[218:219], 1.0 op_sel_hi:[1,0]
    v_exp_f32 v222, v222
    v_exp_f32 v223, v223
    v_pk_add_f32 v[220:221], v[220:221], 1.0 op_sel_hi:[1,0]
    v_rcp_f32 v216, v216
    v_pk_add_f32 v[222:223], v[222:223], 1.0 op_sel_hi:[1,0]
    v_rcp_f32 v217, v217
    v_rcp_f32 v218, v218
    v_pk_mul_f32 v[176:177], v[176:177], v[216:217]
    v_rcp_f32 v219, v219
    v_rcp_f32 v220, v220
    v_pk_mul_f32 v[178:179], v[178:179], v[218:219]
    v_rcp_f32 v221, v221
    v_rcp_f32 v222, v222
    v_pk_mul_f32 v[180:181], v[180:181], v[220:221]
    v_rcp_f32 v223, v223
    s_nop 0
    v_pk_mul_f32 v[182:183], v[182:183], v[222:223]
    v_cvt_pk_bf16_f32 v176, v176, v177
    v_cvt_pk_bf16_f32 v177, v178, v179
    v_cvt_pk_bf16_f32 v178, v180, v181
    v_cvt_pk_bf16_f32 v179, v182, v183
    s_add_u32 s44, s44, 131072
    buffer_store_dwordx4 v[176:179], v251, s[12:15], s44 offen offset:0
    v_pk_fma_f32 v[216:217], v[184:185], v[184:185], s[46:47] op_sel_hi:[1,1,0] neg_lo:[1,0,0] neg_hi:[1,0,0]
    v_pk_fma_f32 v[218:219], v[186:187], v[186:187], s[46:47] op_sel_hi:[1,1,0] neg_lo:[1,0,0] neg_hi:[1,0,0]
    v_pk_fma_f32 v[220:221], v[188:189], v[188:189], s[46:47] op_sel_hi:[1,1,0] neg_lo:[1,0,0] neg_hi:[1,0,0]
    v_pk_fma_f32 v[222:223], v[190:191], v[190:191], s[46:47] op_sel_hi:[1,1,0] neg_lo:[1,0,0] neg_hi:[1,0,0]
    v_pk_mul_f32 v[216:217], v[216:217], v[184:185]
    v_pk_mul_f32 v[218:219], v[218:219], v[186:187]
    v_pk_mul_f32 v[220:221], v[220:221], v[188:189]
    v_pk_mul_f32 v[222:223], v[222:223], v[190:191]
    v_exp_f32 v216, v216
    v_exp_f32 v217, v217
    v_exp_f32 v218, v218
    v_exp_f32 v219, v219
    v_pk_add_f32 v[216:217], v[216:217], 1.0 op_sel_hi:[1,0]
    v_exp_f32 v220, v220
    v_exp_f32 v221, v221
    v_pk_add_f32 v[218:219], v[218:219], 1.0 op_sel_hi:[1,0]
    v_exp_f32 v222, v222
    v_exp_f32 v223, v223
    v_pk_add_f32 v[220:221], v[220:221], 1.0 op_sel_hi:[1,0]
    v_rcp_f32 v216, v216
    v_pk_add_f32 v[222:223], v[222:223], 1.0 op_sel_hi:[1,0]
    v_rcp_f32 v217, v217
    v_rcp_f32 v218, v218
    v_pk_mul_f32 v[184:185], v[184:185], v[216:217]
    v_rcp_f32 v219, v219
    v_rcp_f32 v220, v220
    v_pk_mul_f32 v[186:187], v[186:187], v[218:219]
    v_rcp_f32 v221, v221
    v_rcp_f32 v222, v222
    v_pk_mul_f32 v[188:189], v[188:189], v[220:221]
    v_rcp_f32 v223, v223
    s_nop 0
    v_pk_mul_f32 v[190:191], v[190:191], v[222:223]
    v_cvt_pk_bf16_f32 v184, v184, v185
    v_cvt_pk_bf16_f32 v185, v186, v187
    v_cvt_pk_bf16_f32 v186, v188, v189
    v_cvt_pk_bf16_f32 v187, v190, v191
    buffer_store_dwordx4 v[184:187], v251, s[12:15], s44 offen offset:1024
    v_pk_fma_f32 v[216:217], v[192:193], v[192:193], s[46:47] op_sel_hi:[1,1,0] neg_lo:[1,0,0] neg_hi:[1,0,0]
    v_pk_fma_f32 v[218:219], v[194:195], v[194:195], s[46:47] op_sel_hi:[1,1,0] neg_lo:[1,0,0] neg_hi:[1,0,0]
    v_pk_fma_f32 v[220:221], v[196:197], v[196:197], s[46:47] op_sel_hi:[1,1,0] neg_lo:[1,0,0] neg_hi:[1,0,0]
    v_pk_fma_f32 v[222:223], v[198:199], v[198:199], s[46:47] op_sel_hi:[1,1,0] neg_lo:[1,0,0] neg_hi:[1,0,0]
    v_pk_mul_f32 v[216:217], v[216:217], v[192:193]
    v_pk_mul_f32 v[218:219], v[218:219], v[194:195]
    v_pk_mul_f32 v[220:221], v[220:221], v[196:197]
    v_pk_mul_f32 v[222:223], v[222:223], v[198:199]
    v_exp_f32 v216, v216
    v_exp_f32 v217, v217
    v_exp_f32 v218, v218
    v_exp_f32 v219, v219
    v_pk_add_f32 v[216:217], v[216:217], 1.0 op_sel_hi:[1,0]
    v_exp_f32 v220, v220
    v_exp_f32 v221, v221
    v_pk_add_f32 v[218:219], v[218:219], 1.0 op_sel_hi:[1,0]
    v_exp_f32 v222, v222
    v_exp_f32 v223, v223
    v_pk_add_f32 v[220:221], v[220:221], 1.0 op_sel_hi:[1,0]
    v_rcp_f32 v216, v216
    v_pk_add_f32 v[222:223], v[222:223], 1.0 op_sel_hi:[1,0]
    v_rcp_f32 v217, v217
    v_rcp_f32 v218, v218
    v_pk_mul_f32 v[192:193], v[192:193], v[216:217]
    v_rcp_f32 v219, v219
    v_rcp_f32 v220, v220
    v_pk_mul_f32 v[194:195], v[194:195], v[218:219]
    v_rcp_f32 v221, v221
    v_rcp_f32 v222, v222
    v_pk_mul_f32 v[196:197], v[196:197], v[220:221]
    v_rcp_f32 v223, v223
    s_nop 0
    v_pk_mul_f32 v[198:199], v[198:199], v[222:223]
    v_cvt_pk_bf16_f32 v192, v192, v193
    v_cvt_pk_bf16_f32 v193, v194, v195
    v_cvt_pk_bf16_f32 v194, v196, v197
    v_cvt_pk_bf16_f32 v195, v198, v199
    s_add_u32 s44, s44, 131072
    buffer_store_dwordx4 v[192:195], v251, s[12:15], s44 offen offset:0
    v_pk_fma_f32 v[216:217], v[200:201], v[200:201], s[46:47] op_sel_hi:[1,1,0] neg_lo:[1,0,0] neg_hi:[1,0,0]
    v_pk_fma_f32 v[218:219], v[202:203], v[202:203], s[46:47] op_sel_hi:[1,1,0] neg_lo:[1,0,0] neg_hi:[1,0,0]
    v_pk_fma_f32 v[220:221], v[204:205], v[204:205], s[46:47] op_sel_hi:[1,1,0] neg_lo:[1,0,0] neg_hi:[1,0,0]
    v_pk_fma_f32 v[222:223], v[206:207], v[206:207], s[46:47] op_sel_hi:[1,1,0] neg_lo:[1,0,0] neg_hi:[1,0,0]
    v_pk_mul_f32 v[216:217], v[216:217], v[200:201]
    v_pk_mul_f32 v[218:219], v[218:219], v[202:203]
    v_pk_mul_f32 v[220:221], v[220:221], v[204:205]
    v_pk_mul_f32 v[222:223], v[222:223], v[206:207]
    v_exp_f32 v216, v216
    v_exp_f32 v217, v217
    v_exp_f32 v218, v218
    v_exp_f32 v219, v219
    v_pk_add_f32 v[216:217], v[216:217], 1.0 op_sel_hi:[1,0]
    v_exp_f32 v220, v220
    v_exp_f32 v221, v221
    v_pk_add_f32 v[218:219], v[218:219], 1.0 op_sel_hi:[1,0]
    v_exp_f32 v222, v222
    v_exp_f32 v223, v223
    v_pk_add_f32 v[220:221], v[220:221], 1.0 op_sel_hi:[1,0]
    v_rcp_f32 v216, v216
    v_pk_add_f32 v[222:223], v[222:223], 1.0 op_sel_hi:[1,0]
    v_rcp_f32 v217, v217
    v_rcp_f32 v218, v218
    v_pk_mul_f32 v[200:201], v[200:201], v[216:217]
    v_rcp_f32 v219, v219
    v_rcp_f32 v220, v220
    v_pk_mul_f32 v[202:203], v[202:203], v[218:219]
    v_rcp_f32 v221, v221
    v_rcp_f32 v222, v222
    v_pk_mul_f32 v[204:205], v[204:205], v[220:221]
    v_rcp_f32 v223, v223
    s_nop 0
    v_pk_mul_f32 v[206:207], v[206:207], v[222:223]
    v_cvt_pk_bf16_f32 v200, v200, v201
    v_cvt_pk_bf16_f32 v201, v202, v203
    v_cvt_pk_bf16_f32 v202, v204, v205
    v_cvt_pk_bf16_f32 v203, v206, v207
    buffer_store_dwordx4 v[200:203], v251, s[12:15], s44 offen offset:1024
    v_pk_fma_f32 v[216:217], v[208:209], v[208:209], s[46:47] op_sel_hi:[1,1,0] neg_lo:[1,0,0] neg_hi:[1,0,0]
    v_pk_fma_f32 v[218:219], v[210:211], v[210:211], s[46:47] op_sel_hi:[1,1,0] neg_lo:[1,0,0] neg_hi:[1,0,0]
    v_pk_fma_f32 v[220:221], v[212:213], v[212:213], s[46:47] op_sel_hi:[1,1,0] neg_lo:[1,0,0] neg_hi:[1,0,0]
    v_pk_fma_f32 v[222:223], v[214:215], v[214:215], s[46:47] op_sel_hi:[1,1,0] neg_lo:[1,0,0] neg_hi:[1,0,0]
    v_pk_mul_f32 v[216:217], v[216:217], v[208:209]
    v_pk_mul_f32 v[218:219], v[218:219], v[210:211]
    v_pk_mul_f32 v[220:221], v[220:221], v[212:213]
    v_pk_mul_f32 v[222:223], v[222:223], v[214:215]
    v_exp_f32 v216, v216
    v_exp_f32 v217, v217
    v_exp_f32 v218, v218
    v_exp_f32 v219, v219
    v_pk_add_f32 v[216:217], v[216:217], 1.0 op_sel_hi:[1,0]
    v_exp_f32 v220, v220
    v_exp_f32 v221, v221
    v_pk_add_f32 v[218:219], v[218:219], 1.0 op_sel_hi:[1,0]
    v_exp_f32 v222, v222
    v_exp_f32 v223, v223
    v_pk_add_f32 v[220:221], v[220:221], 1.0 op_sel_hi:[1,0]
    v_rcp_f32 v216, v216
    v_pk_add_f32 v[222:223], v[222:223], 1.0 op_sel_hi:[1,0]
    v_rcp_f32 v217, v217
    v_rcp_f32 v218, v218
    v_pk_mul_f32 v[208:209], v[208:209], v[216:217]
    v_rcp_f32 v219, v219
    v_rcp_f32 v220, v220
    v_pk_mul_f32 v[210:211], v[210:211], v[218:219]
    v_rcp_f32 v221, v221
    v_rcp_f32 v222, v222
    v_pk_mul_f32 v[212:213], v[212:213], v[220:221]
    v_rcp_f32 v223, v223
    s_nop 0
    v_pk_mul_f32 v[214:215], v[214:215], v[222:223]
    v_cvt_pk_bf16_f32 v208, v208, v209
    v_cvt_pk_bf16_f32 v209, v210, v211
    v_cvt_pk_bf16_f32 v210, v212, v213
    v_cvt_pk_bf16_f32 v211, v214, v215
    buffer_store_dwordx4 v[208:211], v249, s[12:15], s99 offen
    s_setpc_b64 s[50:51]
.p2align 6
k1_kernel_epi_q:
    v_bfe_u32 v252, v251, 4, 4
    v_lshrrev_b32 v253, 8, v251
    v_lshlrev_b32 v249, 6, v252
    v_lshl_add_u32 v249, v253, 4, v249
    s_mul_i32 s35, s40, 655360
    s_lshl_b32 s36, s20, 13
    s_add_u32 s35, s35, s36
    s_lshl_b32 s36, s24, 11
    s_add_u32 s35, s35, s36
    s_add_u32 s35, s35, 30679040
    v_min_f32 v216, 0, v144
    v_min_f32 v217, 0, v145
    v_min_f32 v218, 0, v146
    v_min_f32 v219, 0, v147
    v_min_f32 v220, 0, v148
    v_min_f32 v221, 0, v149
    v_min_f32 v222, 0, v150
    v_min_f32 v223, 0, v151
    v_pk_mul_f32 v[216:217], v[216:217], s[48:49] op_sel_hi:[1,0]
    v_pk_mul_f32 v[218:219], v[218:219], s[48:49] op_sel_hi:[1,0]
    v_pk_mul_f32 v[220:221], v[220:221], s[48:49] op_sel_hi:[1,0]
    v_pk_mul_f32 v[222:223], v[222:223], s[48:49] op_sel_hi:[1,0]
    v_exp_f32 v216, v216
    v_max_f32 v144, 0, v144
    v_exp_f32 v217, v217
    v_max_f32 v145, 0, v145
    v_exp_f32 v218, v218
    v_max_f32 v146, 0, v146
    v_exp_f32 v219, v219
    v_max_f32 v147, 0, v147
    v_exp_f32 v220, v220
    v_max_f32 v148, 0, v148
    v_exp_f32 v221, v221
    v_max_f32 v149, 0, v149
    v_exp_f32 v222, v222
    v_max_f32 v150, 0, v150
    v_exp_f32 v223, v223
    v_max_f32 v151, 0, v151
    v_pk_add_f32 v[144:145], v[144:145], s[48:49] op_sel:[0,1] op_sel_hi:[1,1]
    v_pk_add_f32 v[146:147], v[146:147], s[48:49] op_sel:[0,1] op_sel_hi:[1,1]
    v_pk_add_f32 v[148:149], v[148:149], s[48:49] op_sel:[0,1] op_sel_hi:[1,1]
    v_pk_add_f32 v[150:151], v[150:151], s[48:49] op_sel:[0,1] op_sel_hi:[1,1]
    v_pk_add_f32 v[144:145], v[144:145], v[216:217]
    v_pk_add_f32 v[146:147], v[146:147], v[218:219]
    v_pk_add_f32 v[148:149], v[148:149], v[220:221]
    v_pk_add_f32 v[150:151], v[150:151], v[222:223]
    v_cvt_pk_bf16_f32 v224, v144, v145
    v_cvt_pk_bf16_f32 v225, v146, v147
    v_cvt_pk_bf16_f32 v228, v148, v149
    v_cvt_pk_bf16_f32 v229, v150, v151
    v_min_f32 v216, 0, v152
    v_min_f32 v217, 0, v153
    v_min_f32 v218, 0, v154
    v_min_f32 v219, 0, v155
    v_min_f32 v220, 0, v156
    v_min_f32 v221, 0, v157
    v_min_f32 v222, 0, v158
    v_min_f32 v223, 0, v159
    v_pk_mul_f32 v[216:217], v[216:217], s[48:49] op_sel_hi:[1,0]
    v_pk_mul_f32 v[218:219], v[218:219], s[48:49] op_sel_hi:[1,0]
    v_pk_mul_f32 v[220:221], v[220:221], s[48:49] op_sel_hi:[1,0]
    v_pk_mul_f32 v[222:223], v[222:223], s[48:49] op_sel_hi:[1,0]
    v_exp_f32 v216, v216
    v_max_f32 v152, 0, v152
    v_exp_f32 v217, v217
    v_max_f32 v153, 0, v153
    v_exp_f32 v218, v218
    v_max_f32 v154, 0, v154
    v_exp_f32 v219, v219
    v_max_f32 v155, 0, v155
    v_exp_f32 v220, v220
    v_max_f32 v156, 0, v156
    v_exp_f32 v221, v221
    v_max_f32 v157, 0, v157
    v_exp_f32 v222, v222
    v_max_f32 v158, 0, v158
    v_exp_f32 v223, v223
    v_max_f32 v159, 0, v159
    v_pk_add_f32 v[152:153], v[152:153], s[48:49] op_sel:[0,1] op_sel_hi:[1,1]
    v_pk_add_f32 v[154:155], v[154:155], s[48:49] op_sel:[0,1] op_sel_hi:[1,1]
    v_pk_add_f32 v[156:157], v[156:157], s[48:49] op_sel:[0,1] op_sel_hi:[1,1]
    v_pk_add_f32 v[158:159], v[158:159], s[48:49] op_sel:[0,1] op_sel_hi:[1,1]
    v_pk_add_f32 v[152:153], v[152:153], v[216:217]
    v_pk_add_f32 v[154:155], v[154:155], v[218:219]
    v_pk_add_f32 v[156:157], v[156:157], v[220:221]
    v_pk_add_f32 v[158:159], v[158:159], v[222:223]
    v_cvt_pk_bf16_f32 v226, v152, v153
    v_cvt_pk_bf16_f32 v227, v154, v155
    v_cvt_pk_bf16_f32 v230, v156, v157
    v_cvt_pk_bf16_f32 v231, v158, v159
    s_nop 1
    v_permlane32_swap_b32 v224, v226
    v_permlane32_swap_b32 v225, v227
    s_nop 0
    v_permlane16_swap_b32 v224, v226
    v_permlane16_swap_b32 v225, v227
    buffer_store_dwordx4 v[224:227], v249, s[12:15], s35 offen offset:0
    s_nop 1
    v_permlane32_swap_b32 v228, v230
    v_permlane32_swap_b32 v229, v231
    s_nop 0
    v_permlane16_swap_b32 v228, v230
    v_permlane16_swap_b32 v229, v231
    buffer_store_dwordx4 v[228:231], v249, s[12:15], s35 offen offset:1024
    s_add_u32 s35, s35, 131072
    v_min_f32 v216, 0, v160
    v_min_f32 v217, 0, v161
    v_min_f32 v218, 0, v162
    v_min_f32 v219, 0, v163
    v_min_f32 v220, 0, v164
    v_min_f32 v221, 0, v165
    v_min_f32 v222, 0, v166
    v_min_f32 v223, 0, v167
    v_pk_mul_f32 v[216:217], v[216:217], s[48:49] op_sel_hi:[1,0]
    v_pk_mul_f32 v[218:219], v[218:219], s[48:49] op_sel_hi:[1,0]
    v_pk_mul_f32 v[220:221], v[220:221], s[48:49] op_sel_hi:[1,0]
    v_pk_mul_f32 v[222:223], v[222:223], s[48:49] op_sel_hi:[1,0]
    v_exp_f32 v216, v216
    v_max_f32 v160, 0, v160
    v_exp_f32 v217, v217
    v_max_f32 v161, 0, v161
    v_exp_f32 v218, v218
    v_max_f32 v162, 0, v162
    v_exp_f32 v219, v219
    v_max_f32 v163, 0, v163
    v_exp_f32 v220, v220
    v_max_f32 v164, 0, v164
    v_exp_f32 v221, v221
    v_max_f32 v165, 0, v165
    v_exp_f32 v222, v222
    v_max_f32 v166, 0, v166
    v_exp_f32 v223, v223
    v_max_f32 v167, 0, v167
    v_pk_add_f32 v[160:161], v[160:161], s[48:49] op_sel:[0,1] op_sel_hi:[1,1]
    v_pk_add_f32 v[162:163], v[162:163], s[48:49] op_sel:[0,1] op_sel_hi:[1,1]
    v_pk_add_f32 v[164:165], v[164:165], s[48:49] op_sel:[0,1] op_sel_hi:[1,1]
    v_pk_add_f32 v[166:167], v[166:167], s[48:49] op_sel:[0,1] op_sel_hi:[1,1]
    v_pk_add_f32 v[160:161], v[160:161], v[216:217]
    v_pk_add_f32 v[162:163], v[162:163], v[218:219]
    v_pk_add_f32 v[164:165], v[164:165], v[220:221]
    v_pk_add_f32 v[166:167], v[166:167], v[222:223]
    v_cvt_pk_bf16_f32 v232, v160, v161
    v_cvt_pk_bf16_f32 v233, v162, v163
    v_cvt_pk_bf16_f32 v236, v164, v165
    v_cvt_pk_bf16_f32 v237, v166, v167
    v_min_f32 v216, 0, v168
    v_min_f32 v217, 0, v169
    v_min_f32 v218, 0, v170
    v_min_f32 v219, 0, v171
    v_min_f32 v220, 0, v172
    v_min_f32 v221, 0, v173
    v_min_f32 v222, 0, v174
    v_min_f32 v223, 0, v175
    v_pk_mul_f32 v[216:217], v[216:217], s[48:49] op_sel_hi:[1,0]
    v_pk_mul_f32 v[218:219], v[218:219], s[48:49] op_sel_hi:[1,0]
    v_pk_mul_f32 v[220:221], v[220:221], s[48:49] op_sel_hi:[1,0]
    v_pk_mul_f32 v[222:223], v[222:223], s[48:49] op_sel_hi:[1,0]
    v_exp_f32 v216, v216
    v_max_f32 v168, 0, v168
    v_exp_f32 v217, v217
    v_max_f32 v169, 0, v169
    v_exp_f32 v218, v218
    v_max_f32 v170, 0, v170
    v_exp_f32 v219, v219
    v_max_f32 v171, 0, v171
    v_exp_f32 v220, v220
    v_max_f32 v172, 0, v172
    v_exp_f32 v221, v221
    v_max_f32 v173, 0, v173
    v_exp_f32 v222, v222
    v_max_f32 v174, 0, v174
    v_exp_f32 v223, v223
    v_max_f32 v175, 0, v175
    v_pk_add_f32 v[168:169], v[168:169], s[48:49] op_sel:[0,1] op_sel_hi:[1,1]
    v_pk_add_f32 v[170:171], v[170:171], s[48:49] op_sel:[0,1] op_sel_hi:[1,1]
    v_pk_add_f32 v[172:173], v[172:173], s[48:49] op_sel:[0,1] op_sel_hi:[1,1]
    v_pk_add_f32 v[174:175], v[174:175], s[48:49] op_sel:[0,1] op_sel_hi:[1,1]
    v_pk_add_f32 v[168:169], v[168:169], v[216:217]
    v_pk_add_f32 v[170:171], v[170:171], v[218:219]
    v_pk_add_f32 v[172:173], v[172:173], v[220:221]
    v_pk_add_f32 v[174:175], v[174:175], v[222:223]
    v_cvt_pk_bf16_f32 v234, v168, v169
    v_cvt_pk_bf16_f32 v235, v170, v171
    v_cvt_pk_bf16_f32 v238, v172, v173
    v_cvt_pk_bf16_f32 v239, v174, v175
    s_nop 1
    v_permlane32_swap_b32 v232, v234
    v_permlane32_swap_b32 v233, v235
    s_nop 0
    v_permlane16_swap_b32 v232, v234
    v_permlane16_swap_b32 v233, v235
    buffer_store_dwordx4 v[232:235], v249, s[12:15], s35 offen offset:0
    s_nop 1
    v_permlane32_swap_b32 v236, v238
    v_permlane32_swap_b32 v237, v239
    s_nop 0
    v_permlane16_swap_b32 v236, v238
    v_permlane16_swap_b32 v237, v239
    buffer_store_dwordx4 v[236:239], v249, s[12:15], s35 offen offset:1024
    s_add_u32 s35, s35, 131072
    v_min_f32 v216, 0, v176
    v_min_f32 v217, 0, v177
    v_min_f32 v218, 0, v178
    v_min_f32 v219, 0, v179
    v_min_f32 v220, 0, v180
    v_min_f32 v221, 0, v181
    v_min_f32 v222, 0, v182
    v_min_f32 v223, 0, v183
    v_pk_mul_f32 v[216:217], v[216:217], s[48:49] op_sel_hi:[1,0]
    v_pk_mul_f32 v[218:219], v[218:219], s[48:49] op_sel_hi:[1,0]
    v_pk_mul_f32 v[220:221], v[220:221], s[48:49] op_sel_hi:[1,0]
    v_pk_mul_f32 v[222:223], v[222:223], s[48:49] op_sel_hi:[1,0]
    v_exp_f32 v216, v216
    v_max_f32 v176, 0, v176
    v_exp_f32 v217, v217
    v_max_f32 v177, 0, v177
    v_exp_f32 v218, v218
    v_max_f32 v178, 0, v178
    v_exp_f32 v219, v219
    v_max_f32 v179, 0, v179
    v_exp_f32 v220, v220
    v_max_f32 v180, 0, v180
    v_exp_f32 v221, v221
    v_max_f32 v181, 0, v181
    v_exp_f32 v222, v222
    v_max_f32 v182, 0, v182
    v_exp_f32 v223, v223
    v_max_f32 v183, 0, v183
    v_pk_add_f32 v[176:177], v[176:177], s[48:49] op_sel:[0,1] op_sel_hi:[1,1]
    v_pk_add_f32 v[178:179], v[178:179], s[48:49] op_sel:[0,1] op_sel_hi:[1,1]
    v_pk_add_f32 v[180:181], v[180:181], s[48:49] op_sel:[0,1] op_sel_hi:[1,1]
    v_pk_add_f32 v[182:183], v[182:183], s[48:49] op_sel:[0,1] op_sel_hi:[1,1]
    v_pk_add_f32 v[176:177], v[176:177], v[216:217]
    v_pk_add_f32 v[178:179], v[178:179], v[218:219]
    v_pk_add_f32 v[180:181], v[180:181], v[220:221]
    v_pk_add_f32 v[182:183], v[182:183], v[222:223]
    v_cvt_pk_bf16_f32 v224, v176, v177
    v_cvt_pk_bf16_f32 v225, v178, v179
    v_cvt_pk_bf16_f32 v228, v180, v181
    v_cvt_pk_bf16_f32 v229, v182, v183
    v_min_f32 v216, 0, v184
    v_min_f32 v217, 0, v185
    v_min_f32 v218, 0, v186
    v_min_f32 v219, 0, v187
    v_min_f32 v220, 0, v188
    v_min_f32 v221, 0, v189
    v_min_f32 v222, 0, v190
    v_min_f32 v223, 0, v191
    v_pk_mul_f32 v[216:217], v[216:217], s[48:49] op_sel_hi:[1,0]
    v_pk_mul_f32 v[218:219], v[218:219], s[48:49] op_sel_hi:[1,0]
    v_pk_mul_f32 v[220:221], v[220:221], s[48:49] op_sel_hi:[1,0]
    v_pk_mul_f32 v[222:223], v[222:223], s[48:49] op_sel_hi:[1,0]
    v_exp_f32 v216, v216
    v_max_f32 v184, 0, v184
    v_exp_f32 v217, v217
    v_max_f32 v185, 0, v185
    v_exp_f32 v218, v218
    v_max_f32 v186, 0, v186
    v_exp_f32 v219, v219
    v_max_f32 v187, 0, v187
    v_exp_f32 v220, v220
    v_max_f32 v188, 0, v188
    v_exp_f32 v221, v221
    v_max_f32 v189, 0, v189
    v_exp_f32 v222, v222
    v_max_f32 v190, 0, v190
    v_exp_f32 v223, v223
    v_max_f32 v191, 0, v191
    v_pk_add_f32 v[184:185], v[184:185], s[48:49] op_sel:[0,1] op_sel_hi:[1,1]
    v_pk_add_f32 v[186:187], v[186:187], s[48:49] op_sel:[0,1] op_sel_hi:[1,1]
    v_pk_add_f32 v[188:189], v[188:189], s[48:49] op_sel:[0,1] op_sel_hi:[1,1]
    v_pk_add_f32 v[190:191], v[190:191], s[48:49] op_sel:[0,1] op_sel_hi:[1,1]
    v_pk_add_f32 v[184:185], v[184:185], v[216:217]
    v_pk_add_f32 v[186:187], v[186:187], v[218:219]
    v_pk_add_f32 v[188:189], v[188:189], v[220:221]
    v_pk_add_f32 v[190:191], v[190:191], v[222:223]
    v_cvt_pk_bf16_f32 v226, v184, v185
    v_cvt_pk_bf16_f32 v227, v186, v187
    v_cvt_pk_bf16_f32 v230, v188, v189
    v_cvt_pk_bf16_f32 v231, v190, v191
    s_nop 1
    v_permlane32_swap_b32 v224, v226
    v_permlane32_swap_b32 v225, v227
    s_nop 0
    v_permlane16_swap_b32 v224, v226
    v_permlane16_swap_b32 v225, v227
    buffer_store_dwordx4 v[224:227], v249, s[12:15], s35 offen offset:0
    s_nop 1
    v_permlane32_swap_b32 v228, v230
    v_permlane32_swap_b32 v229, v231
    s_nop 0
    v_permlane16_swap_b32 v228, v230
    v_permlane16_swap_b32 v229, v231
    buffer_store_dwordx4 v[228:231], v249, s[12:15], s35 offen offset:1024
    s_add_u32 s35, s35, 131072
    v_min_f32 v216, 0, v192
    v_min_f32 v217, 0, v193
    v_min_f32 v218, 0, v194
    v_min_f32 v219, 0, v195
    v_min_f32 v220, 0, v196
    v_min_f32 v221, 0, v197
    v_min_f32 v222, 0, v198
    v_min_f32 v223, 0, v199
    v_pk_mul_f32 v[216:217], v[216:217], s[48:49] op_sel_hi:[1,0]
    v_pk_mul_f32 v[218:219], v[218:219], s[48:49] op_sel_hi:[1,0]
    v_pk_mul_f32 v[220:221], v[220:221], s[48:49] op_sel_hi:[1,0]
    v_pk_mul_f32 v[222:223], v[222:223], s[48:49] op_sel_hi:[1,0]
    v_exp_f32 v216, v216
    v_max_f32 v192, 0, v192
    v_exp_f32 v217, v217
    v_max_f32 v193, 0, v193
    v_exp_f32 v218, v218
    v_max_f32 v194, 0, v194
    v_exp_f32 v219, v219
    v_max_f32 v195, 0, v195
    v_exp_f32 v220, v220
    v_max_f32 v196, 0, v196
    v_exp_f32 v221, v221
    v_max_f32 v197, 0, v197
    v_exp_f32 v222, v222
    v_max_f32 v198, 0, v198
    v_exp_f32 v223, v223
    v_max_f32 v199, 0, v199
    v_pk_add_f32 v[192:193], v[192:193], s[48:49] op_sel:[0,1] op_sel_hi:[1,1]
    v_pk_add_f32 v[194:195], v[194:195], s[48:49] op_sel:[0,1] op_sel_hi:[1,1]
    v_pk_add_f32 v[196:197], v[196:197], s[48:49] op_sel:[0,1] op_sel_hi:[1,1]
    v_pk_add_f32 v[198:199], v[198:199], s[48:49] op_sel:[0,1] op_sel_hi:[1,1]
    v_pk_add_f32 v[192:193], v[192:193], v[216:217]
    v_pk_add_f32 v[194:195], v[194:195], v[218:219]
    v_pk_add_f32 v[196:197], v[196:197], v[220:221]
    v_pk_add_f32 v[198:199], v[198:199], v[222:223]
    v_cvt_pk_bf16_f32 v232, v192, v193
    v_cvt_pk_bf16_f32 v233, v194, v195
    v_cvt_pk_bf16_f32 v236, v196, v197
    v_cvt_pk_bf16_f32 v237, v198, v199
    v_min_f32 v216, 0, v200
    v_min_f32 v217, 0, v201
    v_min_f32 v218, 0, v202
    v_min_f32 v219, 0, v203
    v_min_f32 v220, 0, v204
    v_min_f32 v221, 0, v205
    v_min_f32 v222, 0, v206
    v_min_f32 v223, 0, v207
    v_pk_mul_f32 v[216:217], v[216:217], s[48:49] op_sel_hi:[1,0]
    v_pk_mul_f32 v[218:219], v[218:219], s[48:49] op_sel_hi:[1,0]
    v_pk_mul_f32 v[220:221], v[220:221], s[48:49] op_sel_hi:[1,0]
    v_pk_mul_f32 v[222:223], v[222:223], s[48:49] op_sel_hi:[1,0]
    v_exp_f32 v216, v216
    v_max_f32 v200, 0, v200
    v_exp_f32 v217, v217
    v_max_f32 v201, 0, v201
    v_exp_f32 v218, v218
    v_max_f32 v202, 0, v202
    v_exp_f32 v219, v219
    v_max_f32 v203, 0, v203
    v_exp_f32 v220, v220
    v_max_f32 v204, 0, v204
    v_exp_f32 v221, v221
    v_max_f32 v205, 0, v205
    v_exp_f32 v222, v222
    v_max_f32 v206, 0, v206
    v_exp_f32 v223, v223
    v_max_f32 v207, 0, v207
    v_pk_add_f32 v[200:201], v[200:201], s[48:49] op_sel:[0,1] op_sel_hi:[1,1]
    v_pk_add_f32 v[202:203], v[202:203], s[48:49] op_sel:[0,1] op_sel_hi:[1,1]
    v_pk_add_f32 v[204:205], v[204:205], s[48:49] op_sel:[0,1] op_sel_hi:[1,1]
    v_pk_add_f32 v[206:207], v[206:207], s[48:49] op_sel:[0,1] op_sel_hi:[1,1]
    v_pk_add_f32 v[200:201], v[200:201], v[216:217]
    v_pk_add_f32 v[202:203], v[202:203], v[218:219]
    v_pk_add_f32 v[204:205], v[204:205], v[220:221]
    v_pk_add_f32 v[206:207], v[206:207], v[222:223]
    v_cvt_pk_bf16_f32 v234, v200, v201
    v_cvt_pk_bf16_f32 v235, v202, v203
    v_cvt_pk_bf16_f32 v238, v204, v205
    v_cvt_pk_bf16_f32 v239, v206, v207
    s_nop 1
    v_permlane32_swap_b32 v232, v234
    v_permlane32_swap_b32 v233, v235
    s_nop 0
    v_permlane16_swap_b32 v232, v234
    v_permlane16_swap_b32 v233, v235
    buffer_store_dwordx4 v[232:235], v249, s[12:15], s35 offen offset:0
    s_nop 1
    v_permlane32_swap_b32 v236, v238
    v_permlane32_swap_b32 v237, v239
    s_nop 0
    v_permlane16_swap_b32 v236, v238
    v_permlane16_swap_b32 v237, v239
    buffer_store_dwordx4 v[236:239], v249, s[12:15], s35 offen offset:1024
    s_add_u32 s35, s35, 131072
    v_min_f32 v216, 0, v208
    v_min_f32 v217, 0, v209
    v_min_f32 v218, 0, v210
    v_min_f32 v219, 0, v211
    v_min_f32 v220, 0, v212
    v_min_f32 v221, 0, v213
    v_min_f32 v222, 0, v214
    v_min_f32 v223, 0, v215
    v_pk_mul_f32 v[216:217], v[216:217], s[48:49] op_sel_hi:[1,0]
    v_pk_mul_f32 v[218:219], v[218:219], s[48:49] op_sel_hi:[1,0]
    v_pk_mul_f32 v[220:221], v[220:221], s[48:49] op_sel_hi:[1,0]
    v_pk_mul_f32 v[222:223], v[222:223], s[48:49] op_sel_hi:[1,0]
    v_exp_f32 v216, v216
    v_max_f32 v208, 0, v208
    v_exp_f32 v217, v217
    v_max_f32 v209, 0, v209
    v_exp_f32 v218, v218
    v_max_f32 v210, 0, v210
    v_exp_f32 v219, v219
    v_max_f32 v211, 0, v211
    v_exp_f32 v220, v220
    v_max_f32 v212, 0, v212
    v_exp_f32 v221, v221
    v_max_f32 v213, 0, v213
    v_exp_f32 v222, v222
    v_max_f32 v214, 0, v214
    v_exp_f32 v223, v223
    v_max_f32 v215, 0, v215
    v_pk_add_f32 v[208:209], v[208:209], s[48:49] op_sel:[0,1] op_sel_hi:[1,1]
    v_pk_add_f32 v[210:211], v[210:211], s[48:49] op_sel:[0,1] op_sel_hi:[1,1]
    v_pk_add_f32 v[212:213], v[212:213], s[48:49] op_sel:[0,1] op_sel_hi:[1,1]
    v_pk_add_f32 v[214:215], v[214:215], s[48:49] op_sel:[0,1] op_sel_hi:[1,1]
    v_pk_add_f32 v[208:209], v[208:209], v[216:217]
    v_pk_add_f32 v[210:211], v[210:211], v[218:219]
    v_pk_add_f32 v[212:213], v[212:213], v[220:221]
    v_pk_add_f32 v[214:215], v[214:215], v[222:223]
    v_cvt_pk_bf16_f32 v224, v208, v209
    v_cvt_pk_bf16_f32 v225, v210, v211
    v_cvt_pk_bf16_f32 v228, v212, v213
    v_cvt_pk_bf16_f32 v229, v214, v215
    v_mov_b32 v226, 0
    v_mov_b32 v227, 0
    v_mov_b32 v230, 0
    v_mov_b32 v231, 0
    s_nop 1
    v_permlane32_swap_b32 v224, v226
    v_permlane32_swap_b32 v225, v227
    s_nop 0
    v_permlane16_swap_b32 v224, v226
    v_permlane16_swap_b32 v225, v227
    buffer_store_dwordx4 v[224:227], v249, s[12:15], s35 offen offset:0
    s_nop 1
    v_permlane32_swap_b32 v228, v230
    v_permlane32_swap_b32 v229, v231
    s_nop 0
    v_permlane16_swap_b32 v228, v230
    v_permlane16_swap_b32 v229, v231
    buffer_store_dwordx4 v[228:231], v249, s[12:15], s35 offen offset:1024
    s_add_u32 s35, s35, 131072
    s_setpc_b64 s[50:51]
.p2align 6
k1_kernel_final:
    v_bfe_u32 v252, v251, 4, 4
    v_lshrrev_b32 v253, 8, v251
    v_lshrrev_b32 v254, 2, v252
    v_lshl_add_u32 v254, v253, 3, v254
    v_mul_u32_u24 v254, 296, v254
    v_and_b32 v255, 3, v252
    v_lshl_add_u32 v254, v255, 3, v254
    s_mul_i32 s33, s24, 9472
    s_add_u32 s33, s33, s41
    v_add_u32 v249, s33, v254
    ds_read_b64_tr_b16 v[0:1], v249 offset:0
    ds_read_b64_tr_b16 v[2:3], v249 offset:1184
    ds_read_b64_tr_b16 v[4:5], v249 offset:32
    ds_read_b64_tr_b16 v[6:7], v249 offset:1216
    ds_read_b64_tr_b16 v[8:9], v249 offset:64
    ds_read_b64_tr_b16 v[10:11], v249 offset:1248
    ds_read_b64_tr_b16 v[12:13], v249 offset:96
    ds_read_b64_tr_b16 v[14:15], v249 offset:1280
    ds_read_b64_tr_b16 v[16:17], v249 offset:128
    ds_read_b64_tr_b16 v[18:19], v249 offset:1312
    ds_read_b64_tr_b16 v[20:21], v249 offset:160
    ds_read_b64_tr_b16 v[22:23], v249 offset:1344
    s_waitcnt lgkmcnt(4)
    ds_read_b64_tr_b16 v[24:25], v249 offset:192
    ds_read_b64_tr_b16 v[26:27], v249 offset:1376
    ds_read_b64_tr_b16 v[28:29], v249 offset:224
    ds_read_b64_tr_b16 v[30:31], v249 offset:1408
    ds_read_b64_tr_b16 v[32:33], v249 offset:256
    ds_read_b64_tr_b16 v[34:35], v249 offset:1440
    v_mov_b32 v255, 157696
    ds_read_b32 v255, v255
    s_waitcnt lgkmcnt(0)
    v_readfirstlane_b32 s84, v255
    s_mul_i32 s85, s84, 0x9e3779b1
    s_xor_b32 s85, s85, 0x5bd1e995
    s_mov_b32 s55, 0
    s_cmp_eq_u32 s96, 1
    s_cbranch_scc0 k1_kernel_fload0
    s_mul_i32 s44, s53, 9
    s_lshr_b32 s44, s44, 1
    s_mul_i32 s44, s44, 131072
    s_lshl_b32 s35, s20, 13
    s_add_u32 s44, s44, s35
    s_lshl_b32 s35, s24, 11
    s_add_u32 s44, s44, s35
    s_add_u32 s44, s44, 18874368
    s_and_b32 s35, s53, 1
    s_cselect_b32 s99, 0, 524288
    s_add_u32 s99, s99, s44
    v_lshrrev_b32 v98, 7, v251
    v_sub_u32 v98, 0, v98
    v_and_b32 v98, 3, v98
    v_bfe_u32 v99, v251, 4, 1
    v_xor_b32 v98, v98, v99
    s_lshl_b32 s35, s35, 1
    v_xor_b32 v98, s35, v98
    v_lshlrev_b32 v98, 4, v98
    v_lshrrev_b32 v99, 5, v251
    v_lshl_add_u32 v98, v99, 6, v98
    s_mul_i32 s35, s35, 65536
    s_add_u32 s44, s44, s35
    buffer_store_dwordx4 v[144:147], v251, s[12:15], s44 offen offset:0
    buffer_store_dwordx4 v[152:155], v251, s[12:15], s44 offen offset:1024
    s_add_u32 s44, s44, 131072
    buffer_store_dwordx4 v[160:163], v251, s[12:15], s44 offen offset:0
    buffer_store_dwordx4 v[168:171], v251, s[12:15], s44 offen offset:1024
    s_add_u32 s44, s44, 131072
    buffer_store_dwordx4 v[176:179], v251, s[12:15], s44 offen offset:0
    buffer_store_dwordx4 v[184:187], v251, s[12:15], s44 offen offset:1024
    s_add_u32 s44, s44, 131072
    buffer_store_dwordx4 v[192:195], v251, s[12:15], s44 offen offset:0
    buffer_store_dwordx4 v[200:203], v251, s[12:15], s44 offen offset:1024
    buffer_store_dwordx4 v[208:211], v98, s[12:15], s99 offen
k1_kernel_fhave:
    v_and_b32 v255, 0x1f0, v251
    s_and_b32 s34, s24, 1
    s_lshl_b32 s34, s34, 2
    v_or_b32 v219, s34, v253
    v_and_b32 v220, 7, v252
    v_xor_b32 v219, v219, v220
    v_lshlrev_b32 v219, 4, v219
    v_lshl_add_u32 v249, v252, 7, v219
    s_lshl_b32 s33, s40, 5
    s_lshl_b32 s34, s20, 1
    s_add_u32 s33, s33, s34
    s_lshr_b32 s34, s24, 1
    s_add_u32 s33, s33, s34
    s_mul_i32 s33, s33, 18432
    s_add_u32 s33, s33, 0
    s_lshl_b32 s34, s23, 8
    s_add_u32 s34, s34, 157760
    v_lshrrev_b32 v221, 2, v255
    v_add_u32 v221, s34, v221
    v_lshlrev_b32 v222, 5, v253
    v_add_u32 v222, s34, v222
    s_waitcnt vmcnt(9)
k1_kernel_fchk:
    v_xor_b32 v66, s84, v66
    v_xor_b32 v67, s85, v67
    v_xor_b32 v70, s84, v70
    v_xor_b32 v71, s85, v71
    v_xor_b32 v74, s84, v74
    v_xor_b32 v75, s85, v75
    v_xor_b32 v78, s84, v78
    v_xor_b32 v79, s85, v79
    v_xor_b32 v82, s84, v82
    v_xor_b32 v83, s85, v83
    v_xor_b32 v86, s84, v86
    v_xor_b32 v87, s85, v87
    v_xor_b32 v90, s84, v90
    v_xor_b32 v91, s85, v91
    v_xor_b32 v94, s84, v94
    v_xor_b32 v95, s85, v95
    v_or_b32 v66, v66, v67
    v_or3_b32 v66, v66, v70, v71
    v_pk_add_f32 v[64:65], v[64:65], v[68:69]
    v_or3_b32 v66, v66, v74, v75
    v_pk_add_f32 v[64:65], v[64:65], v[72:73]
    v_or3_b32 v66, v66, v78, v79
    v_pk_add_f32 v[64:65], v[64:65], v[76:77]
    v_or3_b32 v66, v66, v82, v83
    v_pk_add_f32 v[64:65], v[64:65], v[80:81]
    v_or3_b32 v66, v66, v86, v87
    v_pk_add_f32 v[64:65], v[64:65], v[84:85]
    v_or3_b32 v66, v66, v90, v91
    v_pk_add_f32 v[64:65], v[64:65], v[88:89]
    v_or3_b32 v66, v66, v94, v95
    v_pk_add_f32 v[64:65], v[64:65], v[92:93]
    v_cmp_ne_u32 vcc, 0, v66
    v_mov_b32 v68, v64
    v_mov_b32 v69, v65
    s_nop 2
    s_cmp_lg_u64 vcc, 0
    s_cbranch_scc1 k1_kernel_fwait
k1_kernel_fgo:
    v_permlane32_swap_b32 v64, v68
    v_permlane32_swap_b32 v65, v69
    s_nop 1
    v_pk_add_f32 v[64:65], v[64:65], v[68:69]
    v_mul_f32 v64, 0x39e38e39, v64
    v_mul_f32 v65, 0x39e38e39, v65
    v_fma_f32 v65, -v64, v64, v65
    v_max_f32 v65, 0, v65
    v_add_f32 v65, 0x361367a4, v65
    v_rsq_f32 v65, v65
    s_nop 0
    v_mul_f32 v65, 0x40088e99, v65
    v_mul_f32 v64, v64, v65
    v_sub_f32 v64, 0, v64
    ds_write_b32 v221, v65
    ds_write_b32 v221, v64 offset:128
    ds_read_b128 v[40:43], v222 offset:0
    ds_read_b128 v[44:47], v222 offset:16
    ds_read_b128 v[48:51], v222 offset:128
    ds_read_b128 v[52:55], v222 offset:144
    s_waitcnt lgkmcnt(0)
    v_lshlrev_b32 v216, 16, v0
    v_and_b32 v217, 0xffff0000, v0
    v_lshlrev_b32 v218, 16, v1
    v_and_b32 v219, 0xffff0000, v1
    v_lshlrev_b32 v220, 16, v2
    v_and_b32 v221, 0xffff0000, v2
    v_lshlrev_b32 v222, 16, v3
    v_and_b32 v223, 0xffff0000, v3
    v_pk_fma_f32 v[216:217], v[216:217], v[40:41], v[48:49]
    v_pk_fma_f32 v[218:219], v[218:219], v[42:43], v[50:51]
    v_pk_fma_f32 v[220:221], v[220:221], v[44:45], v[52:53]
    v_pk_fma_f32 v[222:223], v[222:223], v[46:47], v[54:55]
    v_cvt_pk_bf16_f32 v0, v216, v217
    v_cvt_pk_bf16_f32 v1, v218, v219
    v_cvt_pk_bf16_f32 v2, v220, v221
    v_cvt_pk_bf16_f32 v3, v222, v223
    buffer_store_dwordx4 v[0:3], v249, s[12:15], s33 offen offset:0
    v_lshlrev_b32 v216, 16, v4
    v_and_b32 v217, 0xffff0000, v4
    v_lshlrev_b32 v218, 16, v5
    v_and_b32 v219, 0xffff0000, v5
    v_lshlrev_b32 v220, 16, v6
    v_and_b32 v221, 0xffff0000, v6
    v_lshlrev_b32 v222, 16, v7
    v_and_b32 v223, 0xffff0000, v7
    v_pk_fma_f32 v[216:217], v[216:217], v[40:41], v[48:49]
    v_pk_fma_f32 v[218:219], v[218:219], v[42:43], v[50:51]
    v_pk_fma_f32 v[220:221], v[220:221], v[44:45], v[52:53]
    v_pk_fma_f32 v[222:223], v[222:223], v[46:47], v[54:55]
    v_cvt_pk_bf16_f32 v4, v216, v217
    v_cvt_pk_bf16_f32 v5, v218, v219
    v_cvt_pk_bf16_f32 v6, v220, v221
    v_cvt_pk_bf16_f32 v7, v222, v223
    buffer_store_dwordx4 v[4:7], v249, s[12:15], s33 offen offset:2048
    s_add_u32 s33, s33, 4096
    v_lshlrev_b32 v216, 16, v8
    v_and_b32 v217, 0xffff0000, v8
    v_lshlrev_b32 v218, 16, v9
    v_and_b32 v219, 0xffff0000, v9
    v_lshlrev_b32 v220, 16, v10
    v_and_b32 v221, 0xffff0000, v10
    v_lshlrev_b32 v222, 16, v11
    v_and_b32 v223, 0xffff0000, v11
    v_pk_fma_f32 v[216:217], v[216:217], v[40:41], v[48:49]
    v_pk_fma_f32 v[218:219], v[218:219], v[42:43], v[50:51]
    v_pk_fma_f32 v[220:221], v[220:221], v[44:45], v[52:53]
    v_pk_fma_f32 v[222:223], v[222:223], v[46:47], v[54:55]
    v_cvt_pk_bf16_f32 v8, v216, v217
    v_cvt_pk_bf16_f32 v9, v218, v219
    v_cvt_pk_bf16_f32 v10, v220, v221
    v_cvt_pk_bf16_f32 v11, v222, v223
    buffer_store_dwordx4 v[8:11], v249, s[12:15], s33 offen offset:0
    v_lshlrev_b32 v216, 16, v12
    v_and_b32 v217, 0xffff0000, v12
    v_lshlrev_b32 v218, 16, v13
    v_and_b32 v219, 0xffff0000, v13
    v_lshlrev_b32 v220, 16, v14
    v_and_b32 v221, 0xffff0000, v14
    v_lshlrev_b32 v222, 16, v15
    v_and_b32 v223, 0xffff0000, v15
    v_pk_fma_f32 v[216:217], v[216:217], v[40:41], v[48:49]
    v_pk_fma_f32 v[218:219], v[218:219], v[42:43], v[50:51]
    v_pk_fma_f32 v[220:221], v[220:221], v[44:45], v[52:53]
    v_pk_fma_f32 v[222:223], v[222:223], v[46:47], v[54:55]
    v_cvt_pk_bf16_f32 v12, v216, v217
    v_cvt_pk_bf16_f32 v13, v218, v219
    v_cvt_pk_bf16_f32 v14, v220, v221
    v_cvt_pk_bf16_f32 v15, v222, v223
    buffer_store_dwordx4 v[12:15], v249, s[12:15], s33 offen offset:2048
    s_add_u32 s33, s33, 4096
    v_lshlrev_b32 v216, 16, v16
    v_and_b32 v217, 0xffff0000, v16
    v_lshlrev_b32 v218, 16, v17
    v_and_b32 v219, 0xffff0000, v17
    v_lshlrev_b32 v220, 16, v18
    v_and_b32 v221, 0xffff0000, v18
    v_lshlrev_b32 v222, 16, v19
    v_and_b32 v223, 0xffff0000, v19
    v_pk_fma_f32 v[216:217], v[216:217], v[40:41], v[48:49]
    v_pk_fma_f32 v[218:219], v[218:219], v[42:43], v[50:51]
    v_pk_fma_f32 v[220:221], v[220:221], v[44:45], v[52:53]
    v_pk_fma_f32 v[222:223], v[222:223], v[46:47], v[54:55]
    v_cvt_pk_bf16_f32 v16, v216, v217
    v_cvt_pk_bf16_f32 v17, v218, v219
    v_cvt_pk_bf16_f32 v18, v220, v221
    v_cvt_pk_bf16_f32 v19, v222, v223
    buffer_store_dwordx4 v[16:19], v249, s[12:15], s33 offen offset:0
    v_lshlrev_b32 v216, 16, v20
    v_and_b32 v217, 0xffff0000, v20
    v_lshlrev_b32 v218, 16, v21
    v_and_b32 v219, 0xffff0000, v21
    v_lshlrev_b32 v220, 16, v22
    v_and_b32 v221, 0xffff0000, v22
    v_lshlrev_b32 v222, 16, v23
    v_and_b32 v223, 0xffff0000, v23
    v_pk_fma_f32 v[216:217], v[216:217], v[40:41], v[48:49]
    v_pk_fma_f32 v[218:219], v[218:219], v[42:43], v[50:51]
    v_pk_fma_f32 v[220:221], v[220:221], v[44:45], v[52:53]
    v_pk_fma_f32 v[222:223], v[222:223], v[46:47], v[54:55]
    v_cvt_pk_bf16_f32 v20, v216, v217
    v_cvt_pk_bf16_f32 v21, v218, v219
    v_cvt_pk_bf16_f32 v22, v220, v221
    v_cvt_pk_bf16_f32 v23, v222, v223
    buffer_store_dwordx4 v[20:23], v249, s[12:15], s33 offen offset:2048
    s_add_u32 s33, s33, 4096
    v_lshlrev_b32 v216, 16, v24
    v_and_b32 v217, 0xffff0000, v24
    v_lshlrev_b32 v218, 16, v25
    v_and_b32 v219, 0xffff0000, v25
    v_lshlrev_b32 v220, 16, v26
    v_and_b32 v221, 0xffff0000, v26
    v_lshlrev_b32 v222, 16, v27
    v_and_b32 v223, 0xffff0000, v27
    v_pk_fma_f32 v[216:217], v[216:217], v[40:41], v[48:49]
    v_pk_fma_f32 v[218:219], v[218:219], v[42:43], v[50:51]
    v_pk_fma_f32 v[220:221], v[220:221], v[44:45], v[52:53]
    v_pk_fma_f32 v[222:223], v[222:223], v[46:47], v[54:55]
    v_cvt_pk_bf16_f32 v24, v216, v217
    v_cvt_pk_bf16_f32 v25, v218, v219
    v_cvt_pk_bf16_f32 v26, v220, v221
    v_cvt_pk_bf16_f32 v27, v222, v223
    buffer_store_dwordx4 v[24:27], v249, s[12:15], s33 offen offset:0
    v_lshlrev_b32 v216, 16, v28
    v_and_b32 v217, 0xffff0000, v28
    v_lshlrev_b32 v218, 16, v29
    v_and_b32 v219, 0xffff0000, v29
    v_lshlrev_b32 v220, 16, v30
    v_and_b32 v221, 0xffff0000, v30
    v_lshlrev_b32 v222, 16, v31
    v_and_b32 v223, 0xffff0000, v31
    v_pk_fma_f32 v[216:217], v[216:217], v[40:41], v[48:49]
    v_pk_fma_f32 v[218:219], v[218:219], v[42:43], v[50:51]
    v_pk_fma_f32 v[220:221], v[220:221], v[44:45], v[52:53]
    v_pk_fma_f32 v[222:223], v[222:223], v[46:47], v[54:55]
    v_cvt_pk_bf16_f32 v28, v216, v217
    v_cvt_pk_bf16_f32 v29, v218, v219
    v_cvt_pk_bf16_f32 v30, v220, v221
    v_cvt_pk_bf16_f32 v31, v222, v223
    buffer_store_dwordx4 v[28:31], v249, s[12:15], s33 offen offset:2048
    s_add_u32 s33, s33, 4096
    v_lshlrev_b32 v216, 16, v32
    v_and_b32 v217, 0xffff0000, v32
    v_lshlrev_b32 v218, 16, v33
    v_and_b32 v219, 0xffff0000, v33
    v_lshlrev_b32 v220, 16, v34
    v_and_b32 v221, 0xffff0000, v34
    v_lshlrev_b32 v222, 16, v35
    v_and_b32 v223, 0xffff0000, v35
    v_pk_fma_f32 v[216:217], v[216:217], v[40:41], v[48:49]
    v_pk_fma_f32 v[218:219], v[218:219], v[42:43], v[50:51]
    v_pk_fma_f32 v[220:221], v[220:221], v[44:45], v[52:53]
    v_pk_fma_f32 v[222:223], v[222:223], v[46:47], v[54:55]
    v_cvt_pk_bf16_f32 v32, v216, v217
    v_cvt_pk_bf16_f32 v33, v218, v219
    v_cvt_pk_bf16_f32 v34, v220, v221
    v_cvt_pk_bf16_f32 v35, v222, v223
    buffer_store_dwordx4 v[32:35], v249, s[12:15], s33 offen offset:0
    s_setpc_b64 s[50:51]
.p2align 6
k1_kernel_epi_v:
    s_lshl_b32 s33, s24, 10
    s_add_u32 s33, s33, 119808
    v_add_u32 v249, s33, v251
    v_cvt_pk_bf16_f32 v144, v144, v145
    v_cvt_pk_bf16_f32 v145, v146, v147
    v_cvt_pk_bf16_f32 v146, v148, v149
    v_cvt_pk_bf16_f32 v147, v150, v151
    ds_write_b128 v249, v[144:147] offset:0
    v_cvt_pk_bf16_f32 v152, v152, v153
    v_cvt_pk_bf16_f32 v153, v154, v155
    v_cvt_pk_bf16_f32 v154, v156, v157
    v_cvt_pk_bf16_f32 v155, v158, v159
    ds_write_b128 v249, v[152:155] offset:4096
    v_cvt_pk_bf16_f32 v160, v160, v161
    v_cvt_pk_bf16_f32 v161, v162, v163
    v_cvt_pk_bf16_f32 v162, v164, v165
    v_cvt_pk_bf16_f32 v163, v166, v167
    ds_write_b128 v249, v[160:163] offset:8192
    v_cvt_pk_bf16_f32 v168, v168, v169
    v_cvt_pk_bf16_f32 v169, v170, v171
    v_cvt_pk_bf16_f32 v170, v172, v173
    v_cvt_pk_bf16_f32 v171, v174, v175
    ds_write_b128 v249, v[168:171] offset:12288
    v_cvt_pk_bf16_f32 v176, v176, v177
    v_cvt_pk_bf16_f32 v177, v178, v179
    v_cvt_pk_bf16_f32 v178, v180, v181
    v_cvt_pk_bf16_f32 v179, v182, v183
    ds_write_b128 v249, v[176:179] offset:16384
    v_cvt_pk_bf16_f32 v184, v184, v185
    v_cvt_pk_bf16_f32 v185, v186, v187
    v_cvt_pk_bf16_f32 v186, v188, v189
    v_cvt_pk_bf16_f32 v187, v190, v191
    ds_write_b128 v249, v[184:187] offset:20480
    v_cvt_pk_bf16_f32 v192, v192, v193
    v_cvt_pk_bf16_f32 v193, v194, v195
    v_cvt_pk_bf16_f32 v194, v196, v197
    v_cvt_pk_bf16_f32 v195, v198, v199
    ds_write_b128 v249, v[192:195] offset:24576
    v_cvt_pk_bf16_f32 v200, v200, v201
    v_cvt_pk_bf16_f32 v201, v202, v203
    v_cvt_pk_bf16_f32 v202, v204, v205
    v_cvt_pk_bf16_f32 v203, v206, v207
    ds_write_b128 v249, v[200:203] offset:28672
    v_cvt_pk_bf16_f32 v208, v208, v209
    v_cvt_pk_bf16_f32 v209, v210, v211
    v_cvt_pk_bf16_f32 v210, v212, v213
    v_cvt_pk_bf16_f32 v211, v214, v215
    ds_write_b128 v249, v[208:211] offset:32768
    s_waitcnt lgkmcnt(0)
    s_barrier
    s_add_u32 m0, s31, s43
    s_add_u32 s31, s31, 20480
    buffer_load_dwordx4 v244, s[8:11], s30 offen lds
    buffer_load_dwordx4 v245, s[8:11], s30 offen offset:1024 lds
    buffer_load_dwordx4 v246, s[8:11], s30 offen offset:2048 lds
    buffer_load_dwordx4 v247, s[8:11], s30 offen offset:3072 lds
    s_add_u32 m0, m0, 4096
    s_cmp_ge_u32 s31, 81920
    s_cselect_b32 s31, 0, s31
    buffer_load_dwordx4 v248, s[8:11], s30 offen lds
    s_add_u32 s30, s30, s26
    s_lshl_b32 s33, s24, 13
    s_add_u32 s34, s33, 77824
    v_add_u32 v253, s34, v251
    s_add_u32 s34, s33, 119808
    v_add_u32 v254, s34, v251
    ds_read_b128 v[0:3], v253 offset:0
    ds_read_b128 v[4:7], v253 offset:1024
    ds_read_b128 v[8:11], v253 offset:2048
    ds_read_b128 v[12:15], v253 offset:3072
    ds_read_b128 v[16:19], v253 offset:4096
    ds_read_b128 v[20:23], v253 offset:5120
    ds_read_b128 v[24:27], v253 offset:6144
    ds_read_b128 v[28:31], v253 offset:7168
    ds_read_b128 v[32:35], v253 offset:8192
    ds_read_b128 v[36:39], v253 offset:9216
    ds_read_b128 v[40:43], v253 offset:10240
    ds_read_b128 v[44:47], v253 offset:11264
    s_waitcnt lgkmcnt(0)
    ds_read_b128 v[48:51], v253 offset:12288
    ds_read_b128 v[52:55], v253 offset:13312
    ds_read_b128 v[56:59], v253 offset:14336
    ds_read_b128 v[60:63], v253 offset:15360
    s_waitcnt lgkmcnt(0)
    ds_read_b128 v[64:67], v254 offset:0
    ds_read_b128 v[68:71], v254 offset:1024
    ds_read_b128 v[72:75], v254 offset:2048
    ds_read_b128 v[76:79], v254 offset:3072
    ds_read_b128 v[80:83], v254 offset:4096
    ds_read_b128 v[84:87], v254 offset:5120
    ds_read_b128 v[88:91], v254 offset:6144
    ds_read_b128 v[92:95], v254 offset:7168
    ds_read_b128 v[96:99], v254 offset:8192
    ds_read_b128 v[100:103], v254 offset:9216
    ds_read_b128 v[104:107], v254 offset:10240
    ds_read_b128 v[108:111], v254 offset:11264
    v_mov_b32 v216, 0x3f803f80
    v_mov_b32 v217, 0x3f803f80
    v_mov_b32 v218, 0x3f803f80
    v_mov_b32 v219, 0x3f803f80
    s_waitcnt lgkmcnt(0)
    s_barrier
    s_add_u32 m0, s31, s43
    s_add_u32 s31, s31, 20480
    buffer_load_dwordx4 v244, s[8:11], s30 offen lds
    v_mfma_f32_16x16x32_bf16 v[144:147], v[0:3], v[64:67], 0
    v_mfma_f32_16x16x32_bf16 v[148:151], v[16:19], v[64:67], 0
    v_mfma_f32_16x16x32_bf16 v[152:155], v[32:35], v[64:67], 0
    v_mfma_f32_16x16x32_bf16 v[156:159], v[16:19], v[80:83], 0
    v_mfma_f32_16x16x32_bf16 v[160:163], v[32:35], v[80:83], 0
    buffer_load_dwordx4 v245, s[8:11], s30 offen offset:1024 lds
    v_mfma_f32_16x16x32_bf16 v[164:167], v[48:51], v[80:83], 0
    v_mfma_f32_16x16x32_bf16 v[168:171], v[32:35], v[96:99], 0
    v_mfma_f32_16x16x32_bf16 v[172:175], v[48:51], v[96:99], 0
    v_mfma_f32_16x16x32_bf16 v[176:179], v[16:19], v[216:219], 0
    buffer_load_dwordx4 v246, s[8:11], s30 offen offset:2048 lds
    v_mfma_f32_16x16x32_bf16 v[180:183], v[32:35], v[216:219], 0
    v_mfma_f32_16x16x32_bf16 v[184:187], v[48:51], v[216:219], 0
    v_mfma_f32_16x16x32_bf16 v[144:147], v[4:7], v[68:71], v[144:147]
    v_mfma_f32_16x16x32_bf16 v[148:151], v[20:23], v[68:71], v[148:151]
    buffer_load_dwordx4 v247, s[8:11], s30 offen offset:3072 lds
    v_mfma_f32_16x16x32_bf16 v[152:155], v[36:39], v[68:71], v[152:155]
    v_mfma_f32_16x16x32_bf16 v[156:159], v[20:23], v[84:87], v[156:159]
    v_mfma_f32_16x16x32_bf16 v[160:163], v[36:39], v[84:87], v[160:163]
    v_mfma_f32_16x16x32_bf16 v[164:167], v[52:55], v[84:87], v[164:167]
    s_add_u32 m0, m0, 4096
    s_cmp_ge_u32 s31, 81920
    s_cselect_b32 s31, 0, s31
    buffer_load_dwordx4 v248, s[8:11], s30 offen lds
    s_add_u32 s30, s30, s26
    v_mfma_f32_16x16x32_bf16 v[168:171], v[36:39], v[100:103], v[168:171]
    v_mfma_f32_16x16x32_bf16 v[172:175], v[52:55], v[100:103], v[172:175]
    v_mfma_f32_16x16x32_bf16 v[176:179], v[20:23], v[216:219], v[176:179]
    v_mfma_f32_16x16x32_bf16 v[180:183], v[36:39], v[216:219], v[180:183]
    v_mfma_f32_16x16x32_bf16 v[184:187], v[52:55], v[216:219], v[184:187]
    s_waitcnt vmcnt(5)
    s_barrier
    s_add_u32 m0, s31, s43
    s_add_u32 s31, s31, 20480
    buffer_load_dwordx4 v244, s[8:11], s30 offen lds
    v_mfma_f32_16x16x32_bf16 v[144:147], v[8:11], v[72:75], v[144:147]
    v_mfma_f32_16x16x32_bf16 v[148:151], v[24:27], v[72:75], v[148:151]
    v_mfma_f32_16x16x32_bf16 v[152:155], v[40:43], v[72:75], v[152:155]
    v_mfma_f32_16x16x32_bf16 v[156:159], v[24:27], v[88:91], v[156:159]
    v_mfma_f32_16x16x32_bf16 v[160:163], v[40:43], v[88:91], v[160:163]
    buffer_load_dwordx4 v245, s[8:11], s30 offen offset:1024 lds
    v_mfma_f32_16x16x32_bf16 v[164:167], v[56:59], v[88:91], v[164:167]
    v_mfma_f32_16x16x32_bf16 v[168:171], v[40:43], v[104:107], v[168:171]
    v_mfma_f32_16x16x32_bf16 v[172:175], v[56:59], v[104:107], v[172:175]
    v_mfma_f32_16x16x32_bf16 v[176:179], v[24:27], v[216:219], v[176:179]
    buffer_load_dwordx4 v246, s[8:11], s30 offen offset:2048 lds
    v_mfma_f32_16x16x32_bf16 v[180:183], v[40:43], v[216:219], v[180:183]
    v_mfma_f32_16x16x32_bf16 v[184:187], v[56:59], v[216:219], v[184:187]
    v_mfma_f32_16x16x32_bf16 v[144:147], v[12:15], v[76:79], v[144:147]
    v_mfma_f32_16x16x32_bf16 v[148:151], v[28:31], v[76:79], v[148:151]
    buffer_load_dwordx4 v247, s[8:11], s30 offen offset:3072 lds
    v_mfma_f32_16x16x32_bf16 v[152:155], v[44:47], v[76:79], v[152:155]
    v_mfma_f32_16x16x32_bf16 v[156:159], v[28:31], v[92:95], v[156:159]
    v_mfma_f32_16x16x32_bf16 v[160:163], v[44:47], v[92:95], v[160:163]
    v_mfma_f32_16x16x32_bf16 v[164:167], v[60:63], v[92:95], v[164:167]
    s_add_u32 m0, m0, 4096
    s_cmp_ge_u32 s31, 81920
    s_cselect_b32 s31, 0, s31
    buffer_load_dwordx4 v248, s[8:11], s30 offen lds
    s_add_u32 s30, s30, s26
    v_mfma_f32_16x16x32_bf16 v[168:171], v[44:47], v[108:111], v[168:171]
    v_mfma_f32_16x16x32_bf16 v[172:175], v[60:63], v[108:111], v[172:175]
    v_mfma_f32_16x16x32_bf16 v[176:179], v[28:31], v[216:219], v[176:179]
    v_mfma_f32_16x16x32_bf16 v[180:183], v[44:47], v[216:219], v[180:183]
    v_mfma_f32_16x16x32_bf16 v[184:187], v[60:63], v[216:219], v[184:187]
    s_lshl_b32 s33, s21, 4
    s_add_u32 s33, s33, s20
    s_mul_i32 s33, s33, 36864
    s_add_u32 s33, s33, 33841152
    s_mul_i32 s34, s24, 6144
    s_add_u32 s34, s34, s33
    s_lshl_b32 s35, s24, 11
    s_add_u32 s35, s35, s33
    s_add_u32 s35, s35, 27648
    s_nop 4
    buffer_store_dwordx4 v[144:147], v251, s[12:15], s34 offen offset:0 sc1
    buffer_store_dwordx4 v[148:151], v251, s[12:15], s34 offen offset:1024 sc1
    buffer_store_dwordx4 v[152:155], v251, s[12:15], s34 offen offset:2048 sc1
    buffer_store_dwordx4 v[156:159], v251, s[12:15], s34 offen offset:3072 sc1
    s_add_u32 s34, s34, 4096
    buffer_store_dwordx4 v[160:163], v251, s[12:15], s34 offen offset:0 sc1
    buffer_store_dwordx4 v[164:167], v251, s[12:15], s34 offen offset:1024 sc1
    buffer_store_dwordx4 v[176:179], v251, s[12:15], s35 offen offset:0 sc1
    buffer_store_dwordx4 v[180:183], v251, s[12:15], s35 offen offset:1024 sc1
    s_cmp_lg_u32 s24, 3
    s_cbranch_scc1 k1_kernel_kv3
    buffer_store_dwordx4 v[168:171], v251, s[12:15], s34 offen offset:2048 sc1
    buffer_store_dwordx4 v[172:175], v251, s[12:15], s34 offen offset:3072 sc1
    buffer_store_dwordx4 v[184:187], v251, s[12:15], s35 offen offset:2048 sc1
k1_kernel_kv3:
    s_waitcnt vmcnt(13)
    s_barrier
    s_add_u32 m0, s31, s43
    s_add_u32 s31, s31, 20480
    buffer_load_dwordx4 v244, s[8:11], s30 offen lds
    buffer_load_dwordx4 v245, s[8:11], s30 offen offset:1024 lds
    buffer_load_dwordx4 v246, s[8:11], s30 offen offset:2048 lds
    buffer_load_dwordx4 v247, s[8:11], s30 offen offset:3072 lds
    s_add_u32 m0, m0, 4096
    s_cmp_ge_u32 s31, 81920
    s_cselect_b32 s31, 0, s31
    buffer_load_dwordx4 v248, s[8:11], s30 offen lds
    s_add_u32 s30, s30, s26
    s_waitcnt vmcnt(13)
    s_barrier
    s_add_u32 m0, s31, s43
    s_add_u32 s31, s31, 20480
    buffer_load_dwordx4 v244, s[8:11], s30 offen lds
    buffer_load_dwordx4 v245, s[8:11], s30 offen offset:1024 lds
    buffer_load_dwordx4 v246, s[8:11], s30 offen offset:2048 lds
    buffer_load_dwordx4 v247, s[8:11], s30 offen offset:3072 lds
    s_add_u32 m0, m0, 4096
    s_cmp_ge_u32 s31, 81920
    s_cselect_b32 s31, 0, s31
    buffer_load_dwordx4 v248, s[8:11], s30 offen lds
    s_add_u32 s30, s30, s26
    s_waitcnt vmcnt(5)
    s_barrier
    s_add_u32 m0, s31, s43
    s_add_u32 s31, s31, 20480
    buffer_load_dwordx4 v244, s[8:11], s30 offen lds
    buffer_load_dwordx4 v245, s[8:11], s30 offen offset:1024 lds
    buffer_load_dwordx4 v246, s[8:11], s30 offen offset:2048 lds
    buffer_load_dwordx4 v247, s[8:11], s30 offen offset:3072 lds
    s_add_u32 m0, m0, 4096
    s_cmp_ge_u32 s31, 81920
    s_cselect_b32 s31, 0, s31
    buffer_load_dwordx4 v248, s[8:11], s30 offen lds
    s_add_u32 s30, s30, s26
    s_waitcnt vmcnt(5)
    s_barrier
    s_waitcnt vmcnt(0)
    s_barrier
    s_barrier
    s_branch k1_kernel_done
k1_kernel_kvred:
    s_cmp_ge_u32 s20, 9
    s_cbranch_scc1 k1_kernel_done
    v_bfe_u32 v253, v251, 4, 4
    v_lshrrev_b32 v254, 8, v251
    v_mov_b32 v255, 157696
    ds_read_b32 v255, v255
    s_waitcnt lgkmcnt(0)
    v_readfirstlane_b32 s84, v255
    s_mul_i32 s85, s84, 0x9e3779b1
    s_xor_b32 s85, s85, 0x5bd1e995
    v_lshlrev_b32 v216, 8, v253
    s_lshl_b32 s33, s21, 12
    s_add_u32 s33, s33, 33824768
    s_mov_b32 s55, 0
k1_kernel_kpoll:
    buffer_load_dword v217, v216, s[12:15], s33 offen sc1
    s_add_u32 s55, s55, 1
    s_waitcnt vmcnt(0)
    v_cmp_eq_u32 vcc, s84, v217
    s_nop 4
    s_cmp_eq_u64 vcc, -1
    s_cbranch_scc1 k1_kernel_kgo
    s_sleep 8
    s_cmp_lt_u32 s55, 0x20000
    s_cbranch_scc1 k1_kernel_kpoll
k1_kernel_kgo:
    s_lshl_b32 s33, s20, 1
    s_lshr_b32 s33, 0x3e940, s33
    s_and_b32 s33, s33, 3
    s_and_b32 s34, s24, 1
    s_add_u32 s33, s33, s34
    s_lshl_b32 s33, s33, 1
    s_mul_i32 s37, s21, 589824
    s_add_u32 s37, s37, 33841152
    s_add_u32 s34, s33, 0
    s_sub_u32 s35, s34, s20
    s_add_u32 s35, s35, 1
    s_mul_i32 s36, s20, 3
    s_add_u32 s36, s36, s35
    s_add_u32 s39, s34, 27
    s_cmp_ge_u32 s24, 2
    s_cselect_b32 s36, s39, s36
    s_lshl_b32 s36, s36, 10
    s_add_u32 s36, s36, s37
    s_cmp_lt_u32 s35, 3
    s_cselect_b32 s36, s36, 2130706432
    s_cmp_lt_u32 s34, 9
    s_cselect_b32 s36, s36, 2130706432
    buffer_load_dwordx4 v[0:3], v251, s[12:15], s36 offen sc1
    s_add_u32 s36, s36, 36864
    buffer_load_dwordx4 v[4:7], v251, s[12:15], s36 offen sc1
    s_add_u32 s36, s36, 36864
    buffer_load_dwordx4 v[8:11], v251, s[12:15], s36 offen sc1
    s_add_u32 s36, s36, 36864
    buffer_load_dwordx4 v[12:15], v251, s[12:15], s36 offen sc1
    s_add_u32 s36, s36, 36864
    buffer_load_dwordx4 v[16:19], v251, s[12:15], s36 offen sc1
    s_add_u32 s36, s36, 36864
    buffer_load_dwordx4 v[20:23], v251, s[12:15], s36 offen sc1
    s_add_u32 s36, s36, 36864
    buffer_load_dwordx4 v[24:27], v251, s[12:15], s36 offen sc1
    s_add_u32 s36, s36, 36864
    buffer_load_dwordx4 v[28:31], v251, s[12:15], s36 offen sc1
    s_add_u32 s36, s36, 36864
    buffer_load_dwordx4 v[32:35], v251, s[12:15], s36 offen sc1
    s_add_u32 s36, s36, 36864
    buffer_load_dwordx4 v[36:39], v251, s[12:15], s36 offen sc1
    s_add_u32 s36, s36, 36864
    buffer_load_dwordx4 v[40:43], v251, s[12:15], s36 offen sc1
    s_add_u32 s36, s36, 36864
    buffer_load_dwordx4 v[44:47], v251, s[12:15], s36 offen sc1
    s_add_u32 s36, s36, 36864
    buffer_load_dwordx4 v[48:51], v251, s[12:15], s36 offen sc1
    s_add_u32 s36, s36, 36864
    buffer_load_dwordx4 v[52:55], v251, s[12:15], s36 offen sc1
    s_add_u32 s36, s36, 36864
    buffer_load_dwordx4 v[56:59], v251, s[12:15], s36 offen sc1
    s_add_u32 s36, s36, 36864
    buffer_load_dwordx4 v[60:63], v251, s[12:15], s36 offen sc1
    s_add_u32 s36, s36, 36864
    s_add_u32 s34, s33, 1
    s_sub_u32 s35, s34, s20
    s_add_u32 s35, s35, 1
    s_mul_i32 s36, s20, 3
    s_add_u32 s36, s36, s35
    s_add_u32 s39, s34, 27
    s_cmp_ge_u32 s24, 2
    s_cselect_b32 s36, s39, s36
    s_lshl_b32 s36, s36, 10
    s_add_u32 s36, s36, s37
    s_cmp_lt_u32 s35, 3
    s_cselect_b32 s36, s36, 2130706432
    s_cmp_lt_u32 s34, 9
    s_cselect_b32 s36, s36, 2130706432
    buffer_load_dwordx4 v[64:67], v251, s[12:15], s36 offen sc1
    s_add_u32 s36, s36, 36864
    buffer_load_dwordx4 v[68:71], v251, s[12:15], s36 offen sc1
    s_add_u32 s36, s36, 36864
    buffer_load_dwordx4 v[72:75], v251, s[12:15], s36 offen sc1
    s_add_u32 s36, s36, 36864
    buffer_load_dwordx4 v[76:79], v251, s[12:15], s36 offen sc1
    s_add_u32 s36, s36, 36864
    buffer_load_dwordx4 v[80:83], v251, s[12:15], s36 offen sc1
    s_add_u32 s36, s36, 36864
    buffer_load_dwordx4 v[84:87], v251, s[12:15], s36 offen sc1
    s_add_u32 s36, s36, 36864
    buffer_load_dwordx4 v[88:91], v251, s[12:15], s36 offen sc1
    s_add_u32 s36, s36, 36864
    buffer_load_dwordx4 v[92:95], v251, s[12:15], s36 offen sc1
    s_add_u32 s36, s36, 36864
    buffer_load_dwordx4 v[96:99], v251, s[12:15], s36 offen sc1
    s_add_u32 s36, s36, 36864
    buffer_load_dwordx4 v[100:103], v251, s[12:15], s36 offen sc1
    s_add_u32 s36, s36, 36864
    buffer_load_dwordx4 v[104:107], v251, s[12:15], s36 offen sc1
    s_add_u32 s36, s36, 36864
    buffer_load_dwordx4 v[108:111], v251, s[12:15], s36 offen sc1
    s_add_u32 s36, s36, 36864
    buffer_load_dwordx4 v[112:115], v251, s[12:15], s36 offen sc1
    s_add_u32 s36, s36, 36864
    buffer_load_dwordx4 v[116:119], v251, s[12:15], s36 offen sc1
    s_add_u32 s36, s36, 36864
    buffer_load_dwordx4 v[120:123], v251, s[12:15], s36 offen sc1
    s_add_u32 s36, s36, 36864
    buffer_load_dwordx4 v[124:127], v251, s[12:15], s36 offen sc1
    s_add_u32 s36, s36, 36864
    s_lshl_b32 s34, s20, 4
    v_add_u32 v216, s34, v253
    v_mul_u32_u24 v216, 3641, v216
    v_lshrrev_b32 v216, 16, v216
    s_lshl_b32 s34, s33, 4
    v_lshlrev_b32 v217, 2, v254
    v_add_u32 v217, s34, v217
    s_waitcnt vmcnt(30)
    v_pk_add_f32 v[0:1], v[0:1], v[4:5]
    v_pk_add_f32 v[2:3], v[2:3], v[6:7]
    s_waitcnt vmcnt(29)
    v_pk_add_f32 v[0:1], v[0:1], v[8:9]
    v_pk_add_f32 v[2:3], v[2:3], v[10:11]
    s_waitcnt vmcnt(28)
    v_pk_add_f32 v[0:1], v[0:1], v[12:13]
    v_pk_add_f32 v[2:3], v[2:3], v[14:15]
    s_waitcnt vmcnt(27)
    v_pk_add_f32 v[0:1], v[0:1], v[16:17]
    v_pk_add_f32 v[2:3], v[2:3], v[18:19]
    s_waitcnt vmcnt(26)
    v_pk_add_f32 v[0:1], v[0:1], v[20:21]
    v_pk_add_f32 v[2:3], v[2:3], v[22:23]
    s_waitcnt vmcnt(25)
    v_pk_add_f32 v[0:1], v[0:1], v[24:25]
    v_pk_add_f32 v[2:3], v[2:3], v[26:27]
    s_waitcnt vmcnt(24)
    v_pk_add_f32 v[0:1], v[0:1], v[28:29]
    v_pk_add_f32 v[2:3], v[2:3], v[30:31]
    s_waitcnt vmcnt(23)
    v_pk_add_f32 v[0:1], v[0:1], v[32:33]
    v_pk_add_f32 v[2:3], v[2:3], v[34:35]
    s_waitcnt vmcnt(22)
    v_pk_add_f32 v[0:1], v[0:1], v[36:37]
    v_pk_add_f32 v[2:3], v[2:3], v[38:39]
    s_waitcnt vmcnt(21)
    v_pk_add_f32 v[0:1], v[0:1], v[40:41]
    v_pk_add_f32 v[2:3], v[2:3], v[42:43]
    s_waitcnt vmcnt(20)
    v_pk_add_f32 v[0:1], v[0:1], v[44:45]
    v_pk_add_f32 v[2:3], v[2:3], v[46:47]
    s_waitcnt vmcnt(19)
    v_pk_add_f32 v[0:1], v[0:1], v[48:49]
    v_pk_add_f32 v[2:3], v[2:3], v[50:51]
    s_waitcnt vmcnt(18)
    v_pk_add_f32 v[0:1], v[0:1], v[52:53]
    v_pk_add_f32 v[2:3], v[2:3], v[54:55]
    s_waitcnt vmcnt(17)
    v_pk_add_f32 v[0:1], v[0:1], v[56:57]
    v_pk_add_f32 v[2:3], v[2:3], v[58:59]
    s_waitcnt vmcnt(16)
    v_pk_add_f32 v[0:1], v[0:1], v[60:61]
    v_pk_add_f32 v[2:3], v[2:3], v[62:63]
    v_add_u32 v218, 0, v217
    v_mul_u32_u24 v218, 3641, v218
    v_lshrrev_b32 v218, 16, v218
    v_cmp_eq_u32 vcc, v218, v216
    s_nop 1
    v_cndmask_b32 v0, 0, v0, vcc
    v_add_u32 v218, 1, v217
    v_mul_u32_u24 v218, 3641, v218
    v_lshrrev_b32 v218, 16, v218
    v_cmp_eq_u32 vcc, v218, v216
    s_nop 1
    v_cndmask_b32 v1, 0, v1, vcc
    v_add_u32 v218, 2, v217
    v_mul_u32_u24 v218, 3641, v218
    v_lshrrev_b32 v218, 16, v218
    v_cmp_eq_u32 vcc, v218, v216
    s_nop 1
    v_cndmask_b32 v2, 0, v2, vcc
    v_add_u32 v218, 3, v217
    v_mul_u32_u24 v218, 3641, v218
    v_lshrrev_b32 v218, 16, v218
    v_cmp_eq_u32 vcc, v218, v216
    s_nop 1
    v_cndmask_b32 v3, 0, v3, vcc
    v_cvt_pk_bf16_f32 v224, v0, v1
    v_cvt_pk_bf16_f32 v225, v2, v3
    s_waitcnt vmcnt(14)
    v_pk_add_f32 v[64:65], v[64:65], v[68:69]
    v_pk_add_f32 v[66:67], v[66:67], v[70:71]
    s_waitcnt vmcnt(13)
    v_pk_add_f32 v[64:65], v[64:65], v[72:73]
    v_pk_add_f32 v[66:67], v[66:67], v[74:75]
    s_waitcnt vmcnt(12)
    v_pk_add_f32 v[64:65], v[64:65], v[76:77]
    v_pk_add_f32 v[66:67], v[66:67], v[78:79]
    s_waitcnt vmcnt(11)
    v_pk_add_f32 v[64:65], v[64:65], v[80:81]
    v_pk_add_f32 v[66:67], v[66:67], v[82:83]
    s_waitcnt vmcnt(10)
    v_pk_add_f32 v[64:65], v[64:65], v[84:85]
    v_pk_add_f32 v[66:67], v[66:67], v[86:87]
    s_waitcnt vmcnt(9)
    v_pk_add_f32 v[64:65], v[64:65], v[88:89]
    v_pk_add_f32 v[66:67], v[66:67], v[90:91]
    s_waitcnt vmcnt(8)
    v_pk_add_f32 v[64:65], v[64:65], v[92:93]
    v_pk_add_f32 v[66:67], v[66:67], v[94:95]
    s_waitcnt vmcnt(7)
    v_pk_add_f32 v[64:65], v[64:65], v[96:97]
    v_pk_add_f32 v[66:67], v[66:67], v[98:99]
    s_waitcnt vmcnt(6)
    v_pk_add_f32 v[64:65], v[64:65], v[100:101]
    v_pk_add_f32 v[66:67], v[66:67], v[102:103]
    s_waitcnt vmcnt(5)
    v_pk_add_f32 v[64:65], v[64:65], v[104:105]
    v_pk_add_f32 v[66:67], v[66:67], v[106:107]
    s_waitcnt vmcnt(4)
    v_pk_add_f32 v[64:65], v[64:65], v[108:109]
    v_pk_add_f32 v[66:67], v[66:67], v[110:111]
    s_waitcnt vmcnt(3)
    v_pk_add_f32 v[64:65], v[64:65], v[112:113]
    v_pk_add_f32 v[66:67], v[66:67], v[114:115]
    s_waitcnt vmcnt(2)
    v_pk_add_f32 v[64:65], v[64:65], v[116:117]
    v_pk_add_f32 v[66:67], v[66:67], v[118:119]
    s_waitcnt vmcnt(1)
    v_pk_add_f32 v[64:65], v[64:65], v[120:121]
    v_pk_add_f32 v[66:67], v[66:67], v[122:123]
    s_waitcnt vmcnt(0)
    v_pk_add_f32 v[64:65], v[64:65], v[124:125]
    v_pk_add_f32 v[66:67], v[66:67], v[126:127]
    v_add_u32 v218, 16, v217
    v_mul_u32_u24 v218, 3641, v218
    v_lshrrev_b32 v218, 16, v218
    v_cmp_eq_u32 vcc, v218, v216
    s_nop 1
    v_cndmask_b32 v64, 0, v64, vcc
    v_add_u32 v218, 17, v217
    v_mul_u32_u24 v218, 3641, v218
    v_lshrrev_b32 v218, 16, v218
    v_cmp_eq_u32 vcc, v218, v216
    s_nop 1
    v_cndmask_b32 v65, 0, v65, vcc
    v_add_u32 v218, 18, v217
    v_mul_u32_u24 v218, 3641, v218
    v_lshrrev_b32 v218, 16, v218
    v_cmp_eq_u32 vcc, v218, v216
    s_nop 1
    v_cndmask_b32 v66, 0, v66, vcc
    v_add_u32 v218, 19, v217
    v_mul_u32_u24 v218, 3641, v218
    v_lshrrev_b32 v218, 16, v218
    v_cmp_eq_u32 vcc, v218, v216
    s_nop 1
    v_cndmask_b32 v67, 0, v67, vcc
    v_cvt_pk_bf16_f32 v226, v64, v65
    v_cvt_pk_bf16_f32 v227, v66, v67
    s_nop 1
    v_permlane32_swap_b32 v224, v226
    v_permlane32_swap_b32 v225, v227
    s_nop 0
    v_permlane16_swap_b32 v224, v226
    v_permlane16_swap_b32 v225, v227
    s_mul_i32 s34, s21, 36864
    s_lshl_b32 s35, s20, 12
    s_add_u32 s34, s34, s35
    s_lshl_b32 s35, s24, 10
    s_add_u32 s34, s34, s35
    s_add_u32 s34, s34, 36200448
    buffer_store_dwordx4 v[224:227], v251, s[12:15], s34 offen
    s_branch k1_kernel_done
k1_kernel_fload0:
    v_lshrrev_b32 v96, 9, v251
    v_lshlrev_b32 v96, 11, v96
    v_and_b32 v97, 0x1f0, v251
    v_add_u32 v96, v96, v97
    s_lshl_b32 s97, s20, 15
    s_lshl_b32 s36, s24, 9
    s_add_u32 s97, s97, s36
    s_add_u32 s97, s97, 33300480
    s_mov_b32 s36, s97
    buffer_load_dwordx4 v[64:67], v96, s[12:15], s36 offen sc1
    s_add_u32 s36, s36, 4096
    buffer_load_dwordx4 v[68:71], v96, s[12:15], s36 offen sc1
    s_add_u32 s36, s36, 4096
    buffer_load_dwordx4 v[72:75], v96, s[12:15], s36 offen sc1
    s_add_u32 s36, s36, 4096
    buffer_load_dwordx4 v[76:79], v96, s[12:15], s36 offen sc1
    s_add_u32 s36, s36, 4096
    buffer_load_dwordx4 v[80:83], v96, s[12:15], s36 offen sc1
    s_add_u32 s36, s36, 4096
    buffer_load_dwordx4 v[84:87], v96, s[12:15], s36 offen sc1
    s_add_u32 s36, s36, 4096
    buffer_load_dwordx4 v[88:91], v96, s[12:15], s36 offen sc1
    s_add_u32 s36, s36, 4096
    buffer_load_dwordx4 v[92:95], v96, s[12:15], s36 offen sc1
    s_mov_b32 s36, 2130706432
    buffer_load_dword v98, v251, s[12:15], s36 offen
    buffer_load_dword v98, v251, s[12:15], s36 offen
    buffer_load_dword v98, v251, s[12:15], s36 offen
    buffer_load_dword v98, v251, s[12:15], s36 offen
    buffer_load_dword v98, v251, s[12:15], s36 offen
    buffer_load_dword v98, v251, s[12:15], s36 offen
    buffer_load_dword v98, v251, s[12:15], s36 offen
    buffer_load_dword v98, v251, s[12:15], s36 offen
    buffer_load_dword v98, v251, s[12:15], s36 offen
    s_branch k1_kernel_fhave
k1_kernel_fload:
    v_lshrrev_b32 v96, 9, v251
    v_lshlrev_b32 v96, 11, v96
    v_and_b32 v97, 0x1f0, v251
    v_add_u32 v96, v96, v97
    s_lshl_b32 s97, s20, 15
    s_lshl_b32 s36, s24, 9
    s_add_u32 s97, s97, s36
    s_add_u32 s97, s97, 33300480
    s_mov_b32 s36, s97
    buffer_load_dwordx4 v[64:67], v96, s[12:15], s36 offen sc1
    s_add_u32 s36, s36, 4096
    buffer_load_dwordx4 v[68:71], v96, s[12:15], s36 offen sc1
    s_add_u32 s36, s36, 4096
    buffer_load_dwordx4 v[72:75], v96, s[12:15], s36 offen sc1
    s_add_u32 s36, s36, 4096
    buffer_load_dwordx4 v[76:79], v96, s[12:15], s36 offen sc1
    s_add_u32 s36, s36, 4096
    buffer_load_dwordx4 v[80:83], v96, s[12:15], s36 offen sc1
    s_add_u32 s36, s36, 4096
    buffer_load_dwordx4 v[84:87], v96, s[12:15], s36 offen sc1
    s_add_u32 s36, s36, 4096
    buffer_load_dwordx4 v[88:91], v96, s[12:15], s36 offen sc1
    s_add_u32 s36, s36, 4096
    buffer_load_dwordx4 v[92:95], v96, s[12:15], s36 offen sc1
    s_waitcnt vmcnt(0)
    s_branch k1_kernel_fchk
k1_kernel_fwait:
    v_lshlrev_b32 v216, 11, v252
    s_cmp_eq_u32 s96, 1
    s_mov_b32 s96, 0
    s_cbranch_scc1 k1_kernel_fload
k1_kernel_fpoll:
    s_sleep 16
    buffer_load_dword v217, v216, s[12:15], s97 offen offset:8 sc1
    s_add_u32 s55, s55, 1
    s_waitcnt vmcnt(0)
    v_cmp_ne_u32 vcc, s84, v217
    s_cmp_gt_u32 s55, 0x20000
    s_cbranch_scc1 k1_kernel_fgo
    s_nop 2
    s_cmp_lg_u64 vcc, 0
    s_cbranch_scc1 k1_kernel_fpoll
    s_branch k1_kernel_fload
k1_kernel_mflag:
    s_lshl_b32 s33, s21, 4
    s_add_u32 s33, s33, s20
    s_lshl_b32 s33, s33, 8
    s_add_u32 s33, s33, 33824768
    v_mov_b32 v252, s84
    v_lshrrev_b32 v253, 2, v251
    buffer_store_dword v252, v253, s[12:15], s33 offen sc1
    s_branch k1_kernel_mflagback
k1_kernel_nonce:
    s_memrealtime s[84:85]
    v_mov_b32 v217, 0
    s_waitcnt lgkmcnt(0)
    s_or_b32 s84, s84, 1
    v_mov_b32 v216, s84
    s_mov_b64 exec, 1
    buffer_store_dword v216, v217, s[16:19], s3 offen sc1
    s_mov_b32 s33, 41066496
    buffer_store_dword v216, v217, s[12:15], s33 offen sc1
    s_mov_b64 exec, -1
    s_branch k1_kernel_nonceback
k1_kernel_nonce2:
    s_mov_b32 s55, 0
k1_kernel_nonce3:
    s_waitcnt vmcnt(0)
    v_readfirstlane_b32 s33, v252
    s_add_u32 s55, s55, 1
    s_cmp_lg_u32 s33, 0
    s_cbranch_scc1 k1_kernel_nonce4
    s_cmp_gt_u32 s55, 0x20000
    s_cbranch_scc1 k1_kernel_nonce4
    s_sleep 8
    buffer_load_dword v252, v253, s[16:19], s3 offen sc1
    s_branch k1_kernel_nonce3
k1_kernel_nonce4:
    v_mov_b32 v253, 157696
    ds_write_b32 v253, v252
    s_waitcnt lgkmcnt(0)
    s_branch k1_kernel_nonce2back
.globl k2_kernel
.p2align 8
.type k2_kernel,@function
k2_kernel:
    s_cmp_ge_u32 s2, 256
    s_cbranch_scc1 k2_kernel_end
    s_load_dwordx4 s[4:7], s[0:1], 40
    s_load_dwordx2 s[8:9], s[0:1], 80
    s_load_dwordx2 s[56:57], s[0:1], 56
    s_load_dwordx2 s[58:59], s[0:1], 16
    v_lshrrev_b32 v204, 6, v0
    v_and_b32 v208, 63, v0
    v_readfirstlane_b32 s29, v204
    s_and_b32 s24, s2, 7
    s_lshr_b32 s25, s2, 3
    s_and_b32 s26, s24, 1
    s_lshl_b32 s26, s26, 3
    s_and_b32 s27, s25, 7
    s_add_u32 s26, s26, s27
    s_lshr_b32 s27, s24, 1
    s_lshl_b32 s27, s27, 2
    s_lshr_b32 s28, s25, 3
    s_add_u32 s27, s27, s28
    s_lshl_b32 s30, s24, 2
    s_lshr_b32 s39, s24, 1
    s_lshl_b32 s39, s39, 2
    s_and_b32 s30, s24, 1
    s_lshl_b32 s30, s30, 4
    v_and_b32 v209, 15, v208
    v_lshrrev_b32 v210, 4, v208
    v_lshrrev_b32 v204, 2, v209
    v_sub_u32 v204, 0, v204
    v_and_b32 v204, 3, v204
    v_xor_b32 v205, v204, v210
    v_lshlrev_b32 v205, 4, v205
    v_lshl_add_u32 v211, v209, 6, v205
    v_lshrrev_b32 v205, 1, v210
    v_xor_b32 v205, v204, v205
    v_lshlrev_b32 v205, 4, v205
    v_lshl_add_u32 v212, v209, 6, v205
    v_and_b32 v205, 1, v210
    v_lshl_add_u32 v212, v205, 3, v212
    s_waitcnt lgkmcnt(0)
    s_mov_b32 s12, s4
    s_and_b32 s13, s5, 0xffff
    s_mov_b32 s14, 8388608
    s_mov_b32 s15, 0x00020000
    s_mov_b32 s16, s8
    s_and_b32 s17, s9, 0xffff
    s_mov_b32 s18, 41263360
    s_mov_b32 s19, 0x00020000
    s_mov_b32 s20, s6
    s_and_b32 s21, s7, 0xffff
    s_mov_b32 s22, 4096
    s_mov_b32 s23, 0x00020000
    s_add_u32 s60, s8, 41066496
    s_addc_u32 s61, s9, 0
    s_load_dword s62, s[60:61], 0
    s_cmp_ge_u32 s29, 4
    s_cbranch_scc1 k2_kernel_loader
    s_lshl_b32 s32, s26, 7
    s_lshl_b32 s33, s29, 5
    s_add_u32 s32, s32, s33
    v_add_u32 v205, s32, v209
    v_lshlrev_b32 v206, 1, v205
    buffer_load_ushort v214, v206, s[20:23], 0 offen
    buffer_load_ushort v215, v206, s[20:23], 0 offen offset:32
    s_mul_i32 s35, s27, 9
    s_lshr_b32 s35, s35, 1
    s_mul_i32 s35, s35, 131072
    s_lshl_b32 s33, s32, 6
    s_add_u32 s35, s35, s33
    s_add_u32 s35, s35, 18874368
    v_and_b32 v204, 7, v209
    v_xor_b32 v204, v204, v210
    v_lshlrev_b32 v204, 4, v204
    v_lshl_add_u32 v204, v209, 7, v204
    v_xor_b32 v206, 64, v204
    s_lshl_b32 s33, s29, 12
    v_add_u32 v200, s33, v204
    v_add_u32 v201, s33, v206
    v_add_u32 v202, 16384, v204
    v_add_u32 v203, 16384, v206
    v_lshlrev_b32 v207, 4, v208
    s_mul_i32 s31, s27, 9
    s_lshr_b32 s31, s31, 1
    s_mul_i32 s31, s31, 131072
    s_lshl_b32 s33, s26, 13
    s_add_u32 s31, s31, s33
    s_lshl_b32 s33, s29, 11
    s_add_u32 s31, s31, s33
    s_add_u32 s31, s31, 18874368
    s_and_b32 s33, s27, 1
    s_cselect_b32 s38, 0, 524288
    s_add_u32 s38, s38, s31
    v_lshrrev_b32 v213, 7, v207
    v_sub_u32 v213, 0, v213
    v_and_b32 v213, 3, v213
    v_bfe_u32 v204, v207, 4, 1
    v_xor_b32 v213, v213, v204
    s_lshl_b32 s33, s33, 1
    v_xor_b32 v213, s33, v213
    v_lshlrev_b32 v213, 4, v213
    v_lshrrev_b32 v204, 5, v207
    v_lshl_add_u32 v213, v204, 6, v213
    s_mul_i32 s33, s33, 65536
    s_add_u32 s31, s31, s33
    s_waitcnt vmcnt(0) lgkmcnt(0)
    v_lshlrev_b32 v214, 16, v214
    v_lshlrev_b32 v215, 16, v215
    v_mul_f32 v214, 0x40088e99, v214
    v_mul_f32 v215, 0x40088e99, v215
    v_mov_b32 v0, v214
    v_mov_b32 v1, v214
    v_mov_b32 v2, v214
    v_mov_b32 v3, v214
    v_mov_b32 v4, v214
    v_mov_b32 v5, v214
    v_mov_b32 v6, v214
    v_mov_b32 v7, v214
    v_mov_b32 v8, v214
    v_mov_b32 v9, v214
    v_mov_b32 v10, v214
    v_mov_b32 v11, v214
    v_mov_b32 v12, v214
    v_mov_b32 v13, v214
    v_mov_b32 v14, v214
    v_mov_b32 v15, v214
    v_mov_b32 v16, v214
    v_mov_b32 v17, v214
    v_mov_b32 v18, v214
    v_mov_b32 v19, v214
    v_mov_b32 v20, v214
    v_mov_b32 v21, v214
    v_mov_b32 v22, v214
    v_mov_b32 v23, v214
    v_mov_b32 v24, v214
    v_mov_b32 v25, v214
    v_mov_b32 v26, v214
    v_mov_b32 v27, v214
    v_mov_b32 v28, v214
    v_mov_b32 v29, v214
    v_mov_b32 v30, v214
    v_mov_b32 v31, v214
    v_mov_b32 v32, v214
    v_mov_b32 v33, v214
    v_mov_b32 v34, v214
    v_mov_b32 v35, v214
    v_mov_b32 v36, v215
    v_mov_b32 v37, v215
    v_mov_b32 v38, v215
    v_mov_b32 v39, v215
    v_mov_b32 v40, v215
    v_mov_b32 v41, v215
    v_mov_b32 v42, v215
    v_mov_b32 v43, v215
    v_mov_b32 v44, v215
    v_mov_b32 v45, v215
    v_mov_b32 v46, v215
    v_mov_b32 v47, v215
    v_mov_b32 v48, v215
    v_mov_b32 v49, v215
    v_mov_b32 v50, v215
    v_mov_b32 v51, v215
    v_mov_b32 v52, v215
    v_mov_b32 v53, v215
    v_mov_b32 v54, v215
    v_mov_b32 v55, v215
    v_mov_b32 v56, v215
    v_mov_b32 v57, v215
    v_mov_b32 v58, v215
    v_mov_b32 v59, v215
    v_mov_b32 v60, v215
    v_mov_b32 v61, v215
    v_mov_b32 v62, v215
    v_mov_b32 v63, v215
    v_mov_b32 v64, v215
    v_mov_b32 v65, v215
    v_mov_b32 v66, v215
    v_mov_b32 v67, v215
    v_mov_b32 v68, v215
    v_mov_b32 v69, v215
    v_mov_b32 v70, v215
    v_mov_b32 v71, v215
    s_mov_b32 s36, 0
    s_barrier
    ds_read_b128 v[72:75], v200 offset:0
    ds_read_b128 v[76:79], v200 offset:2048
    ds_read_b128 v[80:83], v202 offset:0
    ds_read_b128 v[84:87], v202 offset:2048
    ds_read_b128 v[88:91], v202 offset:4096
    ds_read_b128 v[92:95], v202 offset:6144
    ds_read_b128 v[96:99], v202 offset:8192
    ds_read_b128 v[100:103], v202 offset:10240
    ds_read_b128 v[104:107], v202 offset:12288
    ds_read_b128 v[108:111], v202 offset:14336
    ds_read_b128 v[112:115], v202 offset:16384
    s_mov_b32 s37, 8
    v_mov_b32 v197, v201
    v_mov_b32 v199, v203
.p2align 6
k2_kernel_loop:
    s_waitcnt lgkmcnt(8)
    v_mfma_f32_16x16x32_bf16 v[0:3], v[80:83], v[72:75], v[0:3]
    ds_read_b128 v[116:119], v197 offset:0
    v_mfma_f32_16x16x32_bf16 v[36:39], v[80:83], v[76:79], v[36:39]
    ds_read_b128 v[120:123], v197 offset:2048
    s_waitcnt lgkmcnt(9)
    v_mfma_f32_16x16x32_bf16 v[4:7], v[84:87], v[72:75], v[4:7]
    ds_read_b128 v[124:127], v199 offset:0
    v_mfma_f32_16x16x32_bf16 v[40:43], v[84:87], v[76:79], v[40:43]
    ds_read_b128 v[128:131], v199 offset:2048
    s_waitcnt lgkmcnt(10)
    v_mfma_f32_16x16x32_bf16 v[8:11], v[88:91], v[72:75], v[8:11]
    ds_read_b128 v[132:135], v199 offset:4096
    v_mfma_f32_16x16x32_bf16 v[44:47], v[88:91], v[76:79], v[44:47]
    ds_read_b128 v[136:139], v199 offset:6144
    s_waitcnt lgkmcnt(11)
    v_mfma_f32_16x16x32_bf16 v[12:15], v[92:95], v[72:75], v[12:15]
    ds_read_b128 v[140:143], v199 offset:8192
    v_mfma_f32_16x16x32_bf16 v[48:51], v[92:95], v[76:79], v[48:51]
    ds_read_b128 v[144:147], v199 offset:10240
    s_waitcnt lgkmcnt(12)
    v_mfma_f32_16x16x32_bf16 v[16:19], v[96:99], v[72:75], v[16:19]
    ds_read_b128 v[148:151], v199 offset:12288
    v_mfma_f32_16x16x32_bf16 v[52:55], v[96:99], v[76:79], v[52:55]
    ds_read_b128 v[152:155], v199 offset:14336
    s_waitcnt lgkmcnt(13)
    v_mfma_f32_16x16x32_bf16 v[20:23], v[100:103], v[72:75], v[20:23]
    ds_read_b128 v[156:159], v199 offset:16384
    v_mfma_f32_16x16x32_bf16 v[56:59], v[100:103], v[76:79], v[56:59]
    s_add_u32 s36, s36, 34816
    s_cmp_ge_u32 s36, 139264
    s_cselect_b32 s36, 0, s36
    s_waitcnt lgkmcnt(13)
    v_mfma_f32_16x16x32_bf16 v[24:27], v[104:107], v[72:75], v[24:27]
    v_add_u32 v196, s36, v200
    v_mfma_f32_16x16x32_bf16 v[60:63], v[104:107], v[76:79], v[60:63]
    v_add_u32 v198, s36, v202
    s_waitcnt lgkmcnt(12)
    v_mfma_f32_16x16x32_bf16 v[28:31], v[108:111], v[72:75], v[28:31]
    v_mfma_f32_16x16x32_bf16 v[64:67], v[108:111], v[76:79], v[64:67]
    s_waitcnt lgkmcnt(11)
    v_mfma_f32_16x16x32_bf16 v[32:35], v[112:115], v[72:75], v[32:35]
    v_mfma_f32_16x16x32_bf16 v[68:71], v[112:115], v[76:79], v[68:71]
    s_waitcnt lgkmcnt(0)
    s_barrier
    s_cmp_eq_u32 s37, 1
    s_cbranch_scc1 k2_kernel_z1
k2_kernel_z1back:
    s_waitcnt lgkmcnt(8)
    v_mfma_f32_16x16x32_bf16 v[0:3], v[124:127], v[116:119], v[0:3]
    ds_read_b128 v[72:75], v196 offset:0
    v_mfma_f32_16x16x32_bf16 v[36:39], v[124:127], v[120:123], v[36:39]
    ds_read_b128 v[76:79], v196 offset:2048
    s_waitcnt lgkmcnt(9)
    v_mfma_f32_16x16x32_bf16 v[4:7], v[128:131], v[116:119], v[4:7]
    ds_read_b128 v[80:83], v198 offset:0
    v_mfma_f32_16x16x32_bf16 v[40:43], v[128:131], v[120:123], v[40:43]
    ds_read_b128 v[84:87], v198 offset:2048
    s_waitcnt lgkmcnt(10)
    v_mfma_f32_16x16x32_bf16 v[8:11], v[132:135], v[116:119], v[8:11]
    ds_read_b128 v[88:91], v198 offset:4096
    v_mfma_f32_16x16x32_bf16 v[44:47], v[132:135], v[120:123], v[44:47]
    ds_read_b128 v[92:95], v198 offset:6144
    s_waitcnt lgkmcnt(11)
    v_mfma_f32_16x16x32_bf16 v[12:15], v[136:139], v[116:119], v[12:15]
    ds_read_b128 v[96:99], v198 offset:8192
    v_mfma_f32_16x16x32_bf16 v[48:51], v[136:139], v[120:123], v[48:51]
    ds_read_b128 v[100:103], v198 offset:10240
    s_waitcnt lgkmcnt(12)
    v_mfma_f32_16x16x32_bf16 v[16:19], v[140:143], v[116:119], v[16:19]
    ds_read_b128 v[104:107], v198 offset:12288
    v_mfma_f32_16x16x32_bf16 v[52:55], v[140:143], v[120:123], v[52:55]
    ds_read_b128 v[108:111], v198 offset:14336
    s_waitcnt lgkmcnt(13)
    v_mfma_f32_16x16x32_bf16 v[20:23], v[144:147], v[116:119], v[20:23]
    ds_read_b128 v[112:115], v198 offset:16384
    v_mfma_f32_16x16x32_bf16 v[56:59], v[144:147], v[120:123], v[56:59]
    v_add_u32 v197, s36, v201
    s_waitcnt lgkmcnt(13)
    v_mfma_f32_16x16x32_bf16 v[24:27], v[148:151], v[116:119], v[24:27]
    v_add_u32 v199, s36, v203
    v_mfma_f32_16x16x32_bf16 v[60:63], v[148:151], v[120:123], v[60:63]
    s_waitcnt lgkmcnt(12)
    v_mfma_f32_16x16x32_bf16 v[28:31], v[152:155], v[116:119], v[28:31]
    v_mfma_f32_16x16x32_bf16 v[64:67], v[152:155], v[120:123], v[64:67]
    s_waitcnt lgkmcnt(11)
    v_mfma_f32_16x16x32_bf16 v[32:35], v[156:159], v[116:119], v[32:35]
    v_mfma_f32_16x16x32_bf16 v[68:71], v[156:159], v[120:123], v[68:71]
    s_waitcnt lgkmcnt(8)
    v_mfma_f32_16x16x32_bf16 v[0:3], v[80:83], v[72:75], v[0:3]
    ds_read_b128 v[116:119], v197 offset:0
    v_mfma_f32_16x16x32_bf16 v[36:39], v[80:83], v[76:79], v[36:39]
    ds_read_b128 v[120:123], v197 offset:2048
    s_waitcnt lgkmcnt(9)
    v_mfma_f32_16x16x32_bf16 v[4:7], v[84:87], v[72:75], v[4:7]
    ds_read_b128 v[124:127], v199 offset:0
    v_mfma_f32_16x16x32_bf16 v[40:43], v[84:87], v[76:79], v[40:43]
    ds_read_b128 v[128:131], v199 offset:2048
    s_waitcnt lgkmcnt(10)
    v_mfma_f32_16x16x32_bf16 v[8:11], v[88:91], v[72:75], v[8:11]
    ds_read_b128 v[132:135], v199 offset:4096
    v_mfma_f32_16x16x32_bf16 v[44:47], v[88:91], v[76:79], v[44:47]
    ds_read_b128 v[136:139], v199 offset:6144
    s_waitcnt lgkmcnt(11)
    v_mfma_f32_16x16x32_bf16 v[12:15], v[92:95], v[72:75], v[12:15]
    ds_read_b128 v[140:143], v199 offset:8192
    v_mfma_f32_16x16x32_bf16 v[48:51], v[92:95], v[76:79], v[48:51]
    ds_read_b128 v[144:147], v199 offset:10240
    s_waitcnt lgkmcnt(12)
    v_mfma_f32_16x16x32_bf16 v[16:19], v[96:99], v[72:75], v[16:19]
    ds_read_b128 v[148:151], v199 offset:12288
    v_mfma_f32_16x16x32_bf16 v[52:55], v[96:99], v[76:79], v[52:55]
    ds_read_b128 v[152:155], v199 offset:14336
    s_waitcnt lgkmcnt(13)
    v_mfma_f32_16x16x32_bf16 v[20:23], v[100:103], v[72:75], v[20:23]
    ds_read_b128 v[156:159], v199 offset:16384
    v_mfma_f32_16x16x32_bf16 v[56:59], v[100:103], v[76:79], v[56:59]
    s_add_u32 s36, s36, 34816
    s_cmp_ge_u32 s36, 139264
    s_cselect_b32 s36, 0, s36
    s_waitcnt lgkmcnt(13)
    v_mfma_f32_16x16x32_bf16 v[24:27], v[104:107], v[72:75], v[24:27]
    v_add_u32 v196, s36, v200
    v_mfma_f32_16x16x32_bf16 v[60:63], v[104:107], v[76:79], v[60:63]
    v_add_u32 v198, s36, v202
    s_waitcnt lgkmcnt(12)
    v_mfma_f32_16x16x32_bf16 v[28:31], v[108:111], v[72:75], v[28:31]
    v_mfma_f32_16x16x32_bf16 v[64:67], v[108:111], v[76:79], v[64:67]
    s_waitcnt lgkmcnt(11)
    v_mfma_f32_16x16x32_bf16 v[32:35], v[112:115], v[72:75], v[32:35]
    v_mfma_f32_16x16x32_bf16 v[68:71], v[112:115], v[76:79], v[68:71]
    s_waitcnt lgkmcnt(0)
    s_barrier
    s_waitcnt lgkmcnt(8)
    v_mfma_f32_16x16x32_bf16 v[0:3], v[124:127], v[116:119], v[0:3]
    ds_read_b128 v[72:75], v196 offset:0
    v_mfma_f32_16x16x32_bf16 v[36:39], v[124:127], v[120:123], v[36:39]
    ds_read_b128 v[76:79], v196 offset:2048
    s_waitcnt lgkmcnt(9)
    v_mfma_f32_16x16x32_bf16 v[4:7], v[128:131], v[116:119], v[4:7]
    ds_read_b128 v[80:83], v198 offset:0
    v_mfma_f32_16x16x32_bf16 v[40:43], v[128:131], v[120:123], v[40:43]
    ds_read_b128 v[84:87], v198 offset:2048
    s_waitcnt lgkmcnt(10)
    v_mfma_f32_16x16x32_bf16 v[8:11], v[132:135], v[116:119], v[8:11]
    ds_read_b128 v[88:91], v198 offset:4096
    v_mfma_f32_16x16x32_bf16 v[44:47], v[132:135], v[120:123], v[44:47]
    ds_read_b128 v[92:95], v198 offset:6144
    s_waitcnt lgkmcnt(11)
    v_mfma_f32_16x16x32_bf16 v[12:15], v[136:139], v[116:119], v[12:15]
    ds_read_b128 v[96:99], v198 offset:8192
    v_mfma_f32_16x16x32_bf16 v[48:51], v[136:139], v[120:123], v[48:51]
    ds_read_b128 v[100:103], v198 offset:10240
    s_waitcnt lgkmcnt(12)
    v_mfma_f32_16x16x32_bf16 v[16:19], v[140:143], v[116:119], v[16:19]
    ds_read_b128 v[104:107], v198 offset:12288
    v_mfma_f32_16x16x32_bf16 v[52:55], v[140:143], v[120:123], v[52:55]
    ds_read_b128 v[108:111], v198 offset:14336
    s_waitcnt lgkmcnt(13)
    v_mfma_f32_16x16x32_bf16 v[20:23], v[144:147], v[116:119], v[20:23]
    ds_read_b128 v[112:115], v198 offset:16384
    v_mfma_f32_16x16x32_bf16 v[56:59], v[144:147], v[120:123], v[56:59]
    v_add_u32 v197, s36, v201
    s_waitcnt lgkmcnt(13)
    v_mfma_f32_16x16x32_bf16 v[24:27], v[148:151], v[116:119], v[24:27]
    v_add_u32 v199, s36, v203
    v_mfma_f32_16x16x32_bf16 v[60:63], v[148:151], v[120:123], v[60:63]
    s_waitcnt lgkmcnt(12)
    v_mfma_f32_16x16x32_bf16 v[28:31], v[152:155], v[116:119], v[28:31]
    v_mfma_f32_16x16x32_bf16 v[64:67], v[152:155], v[120:123], v[64:67]
    s_waitcnt lgkmcnt(11)
    v_mfma_f32_16x16x32_bf16 v[32:35], v[156:159], v[116:119], v[32:35]
    v_mfma_f32_16x16x32_bf16 v[68:71], v[156:159], v[120:123], v[68:71]
    s_waitcnt lgkmcnt(8)
    v_mfma_f32_16x16x32_bf16 v[0:3], v[80:83], v[72:75], v[0:3]
    ds_read_b128 v[116:119], v197 offset:0
    v_mfma_f32_16x16x32_bf16 v[36:39], v[80:83], v[76:79], v[36:39]
    ds_read_b128 v[120:123], v197 offset:2048
    s_waitcnt lgkmcnt(9)
    v_mfma_f32_16x16x32_bf16 v[4:7], v[84:87], v[72:75], v[4:7]
    ds_read_b128 v[124:127], v199 offset:0
    v_mfma_f32_16x16x32_bf16 v[40:43], v[84:87], v[76:79], v[40:43]
    ds_read_b128 v[128:131], v199 offset:2048
    s_waitcnt lgkmcnt(10)
    v_mfma_f32_16x16x32_bf16 v[8:11], v[88:91], v[72:75], v[8:11]
    ds_read_b128 v[132:135], v199 offset:4096
    v_mfma_f32_16x16x32_bf16 v[44:47], v[88:91], v[76:79], v[44:47]
    ds_read_b128 v[136:139], v199 offset:6144
    s_waitcnt lgkmcnt(11)
    v_mfma_f32_16x16x32_bf16 v[12:15], v[92:95], v[72:75], v[12:15]
    ds_read_b128 v[140:143], v199 offset:8192
    v_mfma_f32_16x16x32_bf16 v[48:51], v[92:95], v[76:79], v[48:51]
    ds_read_b128 v[144:147], v199 offset:10240
    s_waitcnt lgkmcnt(12)
    v_mfma_f32_16x16x32_bf16 v[16:19], v[96:99], v[72:75], v[16:19]
    ds_read_b128 v[148:151], v199 offset:12288
    v_mfma_f32_16x16x32_bf16 v[52:55], v[96:99], v[76:79], v[52:55]
    ds_read_b128 v[152:155], v199 offset:14336
    s_waitcnt lgkmcnt(13)
    v_mfma_f32_16x16x32_bf16 v[20:23], v[100:103], v[72:75], v[20:23]
    ds_read_b128 v[156:159], v199 offset:16384
    v_mfma_f32_16x16x32_bf16 v[56:59], v[100:103], v[76:79], v[56:59]
    s_add_u32 s36, s36, 34816
    s_cmp_ge_u32 s36, 139264
    s_cselect_b32 s36, 0, s36
    s_waitcnt lgkmcnt(13)
    v_mfma_f32_16x16x32_bf16 v[24:27], v[104:107], v[72:75], v[24:27]
    v_add_u32 v196, s36, v200
    v_mfma_f32_16x16x32_bf16 v[60:63], v[104:107], v[76:79], v[60:63]
    v_add_u32 v198, s36, v202
    s_waitcnt lgkmcnt(12)
    v_mfma_f32_16x16x32_bf16 v[28:31], v[108:111], v[72:75], v[28:31]
    v_mfma_f32_16x16x32_bf16 v[64:67], v[108:111], v[76:79], v[64:67]
    s_waitcnt lgkmcnt(11)
    v_mfma_f32_16x16x32_bf16 v[32:35], v[112:115], v[72:75], v[32:35]
    v_mfma_f32_16x16x32_bf16 v[68:71], v[112:115], v[76:79], v[68:71]
    s_waitcnt lgkmcnt(0)
    s_barrier
    s_waitcnt lgkmcnt(8)
    v_mfma_f32_16x16x32_bf16 v[0:3], v[124:127], v[116:119], v[0:3]
    ds_read_b128 v[72:75], v196 offset:0
    v_mfma_f32_16x16x32_bf16 v[36:39], v[124:127], v[120:123], v[36:39]
    ds_read_b128 v[76:79], v196 offset:2048
    s_waitcnt lgkmcnt(9)
    v_mfma_f32_16x16x32_bf16 v[4:7], v[128:131], v[116:119], v[4:7]
    ds_read_b128 v[80:83], v198 offset:0
    v_mfma_f32_16x16x32_bf16 v[40:43], v[128:131], v[120:123], v[40:43]
    ds_read_b128 v[84:87], v198 offset:2048
    s_waitcnt lgkmcnt(10)
    v_mfma_f32_16x16x32_bf16 v[8:11], v[132:135], v[116:119], v[8:11]
    ds_read_b128 v[88:91], v198 offset:4096
    v_mfma_f32_16x16x32_bf16 v[44:47], v[132:135], v[120:123], v[44:47]
    ds_read_b128 v[92:95], v198 offset:6144
    s_waitcnt lgkmcnt(11)
    v_mfma_f32_16x16x32_bf16 v[12:15], v[136:139], v[116:119], v[12:15]
    ds_read_b128 v[96:99], v198 offset:8192
    v_mfma_f32_16x16x32_bf16 v[48:51], v[136:139], v[120:123], v[48:51]
    ds_read_b128 v[100:103], v198 offset:10240
    s_waitcnt lgkmcnt(12)
    v_mfma_f32_16x16x32_bf16 v[16:19], v[140:143], v[116:119], v[16:19]
    ds_read_b128 v[104:107], v198 offset:12288
    v_mfma_f32_16x16x32_bf16 v[52:55], v[140:143], v[120:123], v[52:55]
    ds_read_b128 v[108:111], v198 offset:14336
    s_waitcnt lgkmcnt(13)
    v_mfma_f32_16x16x32_bf16 v[20:23], v[144:147], v[116:119], v[20:23]
    ds_read_b128 v[112:115], v198 offset:16384
    v_mfma_f32_16x16x32_bf16 v[56:59], v[144:147], v[120:123], v[56:59]
    v_add_u32 v197, s36, v201
    s_waitcnt lgkmcnt(13)
    v_mfma_f32_16x16x32_bf16 v[24:27], v[148:151], v[116:119], v[24:27]
    v_add_u32 v199, s36, v203
    v_mfma_f32_16x16x32_bf16 v[60:63], v[148:151], v[120:123], v[60:63]
    s_waitcnt lgkmcnt(12)
    v_mfma_f32_16x16x32_bf16 v[28:31], v[152:155], v[116:119], v[28:31]
    v_mfma_f32_16x16x32_bf16 v[64:67], v[152:155], v[120:123], v[64:67]
    s_waitcnt lgkmcnt(11)
    v_mfma_f32_16x16x32_bf16 v[32:35], v[156:159], v[116:119], v[32:35]
    v_mfma_f32_16x16x32_bf16 v[68:71], v[156:159], v[120:123], v[68:71]
    s_waitcnt lgkmcnt(8)
    v_mfma_f32_16x16x32_bf16 v[0:3], v[80:83], v[72:75], v[0:3]
    ds_read_b128 v[116:119], v197 offset:0
    v_mfma_f32_16x16x32_bf16 v[36:39], v[80:83], v[76:79], v[36:39]
    ds_read_b128 v[120:123], v197 offset:2048
    s_waitcnt lgkmcnt(9)
    v_mfma_f32_16x16x32_bf16 v[4:7], v[84:87], v[72:75], v[4:7]
    ds_read_b128 v[124:127], v199 offset:0
    v_mfma_f32_16x16x32_bf16 v[40:43], v[84:87], v[76:79], v[40:43]
    ds_read_b128 v[128:131], v199 offset:2048
    s_waitcnt lgkmcnt(10)
    v_mfma_f32_16x16x32_bf16 v[8:11], v[88:91], v[72:75], v[8:11]
    ds_read_b128 v[132:135], v199 offset:4096
    v_mfma_f32_16x16x32_bf16 v[44:47], v[88:91], v[76:79], v[44:47]
    ds_read_b128 v[136:139], v199 offset:6144
    s_waitcnt lgkmcnt(11)
    v_mfma_f32_16x16x32_bf16 v[12:15], v[92:95], v[72:75], v[12:15]
    ds_read_b128 v[140:143], v199 offset:8192
    v_mfma_f32_16x16x32_bf16 v[48:51], v[92:95], v[76:79], v[48:51]
    ds_read_b128 v[144:147], v199 offset:10240
    s_waitcnt lgkmcnt(12)
    v_mfma_f32_16x16x32_bf16 v[16:19], v[96:99], v[72:75], v[16:19]
    ds_read_b128 v[148:151], v199 offset:12288
    v_mfma_f32_16x16x32_bf16 v[52:55], v[96:99], v[76:79], v[52:55]
    ds_read_b128 v[152:155], v199 offset:14336
    s_waitcnt lgkmcnt(13)
    v_mfma_f32_16x16x32_bf16 v[20:23], v[100:103], v[72:75], v[20:23]
    ds_read_b128 v[156:159], v199 offset:16384
    v_mfma_f32_16x16x32_bf16 v[56:59], v[100:103], v[76:79], v[56:59]
    s_add_u32 s36, s36, 34816
    s_cmp_ge_u32 s36, 139264
    s_cselect_b32 s36, 0, s36
    s_waitcnt lgkmcnt(13)
    v_mfma_f32_16x16x32_bf16 v[24:27], v[104:107], v[72:75], v[24:27]
    v_add_u32 v196, s36, v200
    v_mfma_f32_16x16x32_bf16 v[60:63], v[104:107], v[76:79], v[60:63]
    v_add_u32 v198, s36, v202
    s_waitcnt lgkmcnt(12)
    v_mfma_f32_16x16x32_bf16 v[28:31], v[108:111], v[72:75], v[28:31]
    v_mfma_f32_16x16x32_bf16 v[64:67], v[108:111], v[76:79], v[64:67]
    s_waitcnt lgkmcnt(11)
    v_mfma_f32_16x16x32_bf16 v[32:35], v[112:115], v[72:75], v[32:35]
    v_mfma_f32_16x16x32_bf16 v[68:71], v[112:115], v[76:79], v[68:71]
    s_waitcnt lgkmcnt(0)
    s_barrier
    s_waitcnt lgkmcnt(8)
    v_mfma_f32_16x16x32_bf16 v[0:3], v[124:127], v[116:119], v[0:3]
    ds_read_b128 v[72:75], v196 offset:0
    v_mfma_f32_16x16x32_bf16 v[36:39], v[124:127], v[120:123], v[36:39]
    ds_read_b128 v[76:79], v196 offset:2048
    s_waitcnt lgkmcnt(9)
    v_mfma_f32_16x16x32_bf16 v[4:7], v[128:131], v[116:119], v[4:7]
    ds_read_b128 v[80:83], v198 offset:0
    v_mfma_f32_16x16x32_bf16 v[40:43], v[128:131], v[120:123], v[40:43]
    ds_read_b128 v[84:87], v198 offset:2048
    s_waitcnt lgkmcnt(10)
    v_mfma_f32_16x16x32_bf16 v[8:11], v[132:135], v[116:119], v[8:11]
    ds_read_b128 v[88:91], v198 offset:4096
    v_mfma_f32_16x16x32_bf16 v[44:47], v[132:135], v[120:123], v[44:47]
    ds_read_b128 v[92:95], v198 offset:6144
    s_waitcnt lgkmcnt(11)
    v_mfma_f32_16x16x32_bf16 v[12:15], v[136:139], v[116:119], v[12:15]
    ds_read_b128 v[96:99], v198 offset:8192
    v_mfma_f32_16x16x32_bf16 v[48:51], v[136:139], v[120:123], v[48:51]
    ds_read_b128 v[100:103], v198 offset:10240
    s_waitcnt lgkmcnt(12)
    v_mfma_f32_16x16x32_bf16 v[16:19], v[140:143], v[116:119], v[16:19]
    ds_read_b128 v[104:107], v198 offset:12288
    v_mfma_f32_16x16x32_bf16 v[52:55], v[140:143], v[120:123], v[52:55]
    ds_read_b128 v[108:111], v198 offset:14336
    s_waitcnt lgkmcnt(13)
    v_mfma_f32_16x16x32_bf16 v[20:23], v[144:147], v[116:119], v[20:23]
    ds_read_b128 v[112:115], v198 offset:16384
    v_mfma_f32_16x16x32_bf16 v[56:59], v[144:147], v[120:123], v[56:59]
    v_add_u32 v197, s36, v201
    s_waitcnt lgkmcnt(13)
    v_mfma_f32_16x16x32_bf16 v[24:27], v[148:151], v[116:119], v[24:27]
    v_add_u32 v199, s36, v203
    v_mfma_f32_16x16x32_bf16 v[60:63], v[148:151], v[120:123], v[60:63]
    s_waitcnt lgkmcnt(12)
    v_mfma_f32_16x16x32_bf16 v[28:31], v[152:155], v[116:119], v[28:31]
    v_mfma_f32_16x16x32_bf16 v[64:67], v[152:155], v[120:123], v[64:67]
    s_waitcnt lgkmcnt(11)
    v_mfma_f32_16x16x32_bf16 v[32:35], v[156:159], v[116:119], v[32:35]
    v_mfma_f32_16x16x32_bf16 v[68:71], v[156:159], v[120:123], v[68:71]
    s_sub_u32 s37, s37, 1
    s_cmp_lg_u32 s37, 0
    s_cbranch_scc1 k2_kernel_loop
    s_waitcnt vmcnt(0) lgkmcnt(0)
    s_bitcmp1_b32 s27, 0
    s_cbranch_scc1 k2_kernel_epi1
    v_lshlrev_b32 v204, 16, v160
    v_and_b32 v205, 0xffff0000, v160
    v_pk_mul_f32 v[0:1], v[0:1], v[204:205]
    v_cvt_pk_bf16_f32 v72, v0, v1
    v_lshlrev_b32 v204, 16, v161
    v_and_b32 v205, 0xffff0000, v161
    v_pk_mul_f32 v[2:3], v[2:3], v[204:205]
    v_cvt_pk_bf16_f32 v73, v2, v3
    v_lshlrev_b32 v204, 16, v164
    v_and_b32 v205, 0xffff0000, v164
    v_pk_mul_f32 v[4:5], v[4:5], v[204:205]
    v_cvt_pk_bf16_f32 v74, v4, v5
    v_lshlrev_b32 v204, 16, v165
    v_and_b32 v205, 0xffff0000, v165
    v_pk_mul_f32 v[6:7], v[6:7], v[204:205]
    v_cvt_pk_bf16_f32 v75, v6, v7
    s_add_u32 s34, s35, 0
    s_nop 1
    v_permlane32_swap_b32 v72, v74
    v_permlane32_swap_b32 v73, v75
    s_nop 0
    v_permlane16_swap_b32 v72, v74
    v_permlane16_swap_b32 v73, v75
    buffer_store_dwordx4 v[72:75], v211, s[16:19], s34 offen sc1
    v_lshlrev_b32 v204, 16, v168
    v_and_b32 v205, 0xffff0000, v168
    v_pk_mul_f32 v[8:9], v[8:9], v[204:205]
    v_cvt_pk_bf16_f32 v76, v8, v9
    v_lshlrev_b32 v204, 16, v169
    v_and_b32 v205, 0xffff0000, v169
    v_pk_mul_f32 v[10:11], v[10:11], v[204:205]
    v_cvt_pk_bf16_f32 v77, v10, v11
    v_lshlrev_b32 v204, 16, v172
    v_and_b32 v205, 0xffff0000, v172
    v_pk_mul_f32 v[12:13], v[12:13], v[204:205]
    v_cvt_pk_bf16_f32 v78, v12, v13
    v_lshlrev_b32 v204, 16, v173
    v_and_b32 v205, 0xffff0000, v173
    v_pk_mul_f32 v[14:15], v[14:15], v[204:205]
    v_cvt_pk_bf16_f32 v79, v14, v15
    s_add_u32 s34, s35, 131072
    s_nop 1
    v_permlane32_swap_b32 v76, v78
    v_permlane32_swap_b32 v77, v79
    s_nop 0
    v_permlane16_swap_b32 v76, v78
    v_permlane16_swap_b32 v77, v79
    buffer_store_dwordx4 v[76:79], v211, s[16:19], s34 offen sc1
    v_lshlrev_b32 v204, 16, v176
    v_and_b32 v205, 0xffff0000, v176
    v_pk_mul_f32 v[16:17], v[16:17], v[204:205]
    v_cvt_pk_bf16_f32 v80, v16, v17
    v_lshlrev_b32 v204, 16, v177
    v_and_b32 v205, 0xffff0000, v177
    v_pk_mul_f32 v[18:19], v[18:19], v[204:205]
    v_cvt_pk_bf16_f32 v81, v18, v19
    v_lshlrev_b32 v204, 16, v180
    v_and_b32 v205, 0xffff0000, v180
    v_pk_mul_f32 v[20:21], v[20:21], v[204:205]
    v_cvt_pk_bf16_f32 v82, v20, v21
    v_lshlrev_b32 v204, 16, v181
    v_and_b32 v205, 0xffff0000, v181
    v_pk_mul_f32 v[22:23], v[22:23], v[204:205]
    v_cvt_pk_bf16_f32 v83, v22, v23
    s_add_u32 s34, s35, 262144
    s_nop 1
    v_permlane32_swap_b32 v80, v82
    v_permlane32_swap_b32 v81, v83
    s_nop 0
    v_permlane16_swap_b32 v80, v82
    v_permlane16_swap_b32 v81, v83
    buffer_store_dwordx4 v[80:83], v211, s[16:19], s34 offen sc1
    v_lshlrev_b32 v204, 16, v184
    v_and_b32 v205, 0xffff0000, v184
    v_pk_mul_f32 v[24:25], v[24:25], v[204:205]
    v_cvt_pk_bf16_f32 v84, v24, v25
    v_lshlrev_b32 v204, 16, v185
    v_and_b32 v205, 0xffff0000, v185
    v_pk_mul_f32 v[26:27], v[26:27], v[204:205]
    v_cvt_pk_bf16_f32 v85, v26, v27
    v_lshlrev_b32 v204, 16, v188
    v_and_b32 v205, 0xffff0000, v188
    v_pk_mul_f32 v[28:29], v[28:29], v[204:205]
    v_cvt_pk_bf16_f32 v86, v28, v29
    v_lshlrev_b32 v204, 16, v189
    v_and_b32 v205, 0xffff0000, v189
    v_pk_mul_f32 v[30:31], v[30:31], v[204:205]
    v_cvt_pk_bf16_f32 v87, v30, v31
    s_add_u32 s34, s35, 393216
    s_nop 1
    v_permlane32_swap_b32 v84, v86
    v_permlane32_swap_b32 v85, v87
    s_nop 0
    v_permlane16_swap_b32 v84, v86
    v_permlane16_swap_b32 v85, v87
    buffer_store_dwordx4 v[84:87], v211, s[16:19], s34 offen sc1
    v_lshlrev_b32 v204, 16, v192
    v_and_b32 v205, 0xffff0000, v192
    v_pk_mul_f32 v[32:33], v[32:33], v[204:205]
    v_cvt_pk_bf16_f32 v88, v32, v33
    v_lshlrev_b32 v204, 16, v193
    v_and_b32 v205, 0xffff0000, v193
    v_pk_mul_f32 v[34:35], v[34:35], v[204:205]
    v_cvt_pk_bf16_f32 v89, v34, v35
    s_add_u32 s34, s35, 524288
    buffer_store_dwordx2 v[88:89], v212, s[16:19], s34 offen sc1
    v_lshlrev_b32 v204, 16, v162
    v_and_b32 v205, 0xffff0000, v162
    v_pk_mul_f32 v[36:37], v[36:37], v[204:205]
    v_cvt_pk_bf16_f32 v90, v36, v37
    v_lshlrev_b32 v204, 16, v163
    v_and_b32 v205, 0xffff0000, v163
    v_pk_mul_f32 v[38:39], v[38:39], v[204:205]
    v_cvt_pk_bf16_f32 v91, v38, v39
    v_lshlrev_b32 v204, 16, v166
    v_and_b32 v205, 0xffff0000, v166
    v_pk_mul_f32 v[40:41], v[40:41], v[204:205]
    v_cvt_pk_bf16_f32 v92, v40, v41
    v_lshlrev_b32 v204, 16, v167
    v_and_b32 v205, 0xffff0000, v167
    v_pk_mul_f32 v[42:43], v[42:43], v[204:205]
    v_cvt_pk_bf16_f32 v93, v42, v43
    s_add_u32 s34, s35, 1024
    s_nop 1
    v_permlane32_swap_b32 v90, v92
    v_permlane32_swap_b32 v91, v93
    s_nop 0
    v_permlane16_swap_b32 v90, v92
    v_permlane16_swap_b32 v91, v93
    buffer_store_dwordx4 v[90:93], v211, s[16:19], s34 offen sc1
    v_lshlrev_b32 v204, 16, v170
    v_and_b32 v205, 0xffff0000, v170
    v_pk_mul_f32 v[44:45], v[44:45], v[204:205]
    v_cvt_pk_bf16_f32 v94, v44, v45
    v_lshlrev_b32 v204, 16, v171
    v_and_b32 v205, 0xffff0000, v171
    v_pk_mul_f32 v[46:47], v[46:47], v[204:205]
    v_cvt_pk_bf16_f32 v95, v46, v47
    v_lshlrev_b32 v204, 16, v174
    v_and_b32 v205, 0xffff0000, v174
    v_pk_mul_f32 v[48:49], v[48:49], v[204:205]
    v_cvt_pk_bf16_f32 v96, v48, v49
    v_lshlrev_b32 v204, 16, v175
    v_and_b32 v205, 0xffff0000, v175
    v_pk_mul_f32 v[50:51], v[50:51], v[204:205]
    v_cvt_pk_bf16_f32 v97, v50, v51
    s_add_u32 s34, s35, 132096
    s_nop 1
    v_permlane32_swap_b32 v94, v96
    v_permlane32_swap_b32 v95, v97
    s_nop 0
    v_permlane16_swap_b32 v94, v96
    v_permlane16_swap_b32 v95, v97
    buffer_store_dwordx4 v[94:97], v211, s[16:19], s34 offen sc1
    v_lshlrev_b32 v204, 16, v178
    v_and_b32 v205, 0xffff0000, v178
    v_pk_mul_f32 v[52:53], v[52:53], v[204:205]
    v_cvt_pk_bf16_f32 v98, v52, v53
    v_lshlrev_b32 v204, 16, v179
    v_and_b32 v205, 0xffff0000, v179
    v_pk_mul_f32 v[54:55], v[54:55], v[204:205]
    v_cvt_pk_bf16_f32 v99, v54, v55
    v_lshlrev_b32 v204, 16, v182
    v_and_b32 v205, 0xffff0000, v182
    v_pk_mul_f32 v[56:57], v[56:57], v[204:205]
    v_cvt_pk_bf16_f32 v100, v56, v57
    v_lshlrev_b32 v204, 16, v183
    v_and_b32 v205, 0xffff0000, v183
    v_pk_mul_f32 v[58:59], v[58:59], v[204:205]
    v_cvt_pk_bf16_f32 v101, v58, v59
    s_add_u32 s34, s35, 263168
    s_nop 1
    v_permlane32_swap_b32 v98, v100
    v_permlane32_swap_b32 v99, v101
    s_nop 0
    v_permlane16_swap_b32 v98, v100
    v_permlane16_swap_b32 v99, v101
    buffer_store_dwordx4 v[98:101], v211, s[16:19], s34 offen sc1
    v_lshlrev_b32 v204, 16, v186
    v_and_b32 v205, 0xffff0000, v186
    v_pk_mul_f32 v[60:61], v[60:61], v[204:205]
    v_cvt_pk_bf16_f32 v102, v60, v61
    v_lshlrev_b32 v204, 16, v187
    v_and_b32 v205, 0xffff0000, v187
    v_pk_mul_f32 v[62:63], v[62:63], v[204:205]
    v_cvt_pk_bf16_f32 v103, v62, v63
    v_lshlrev_b32 v204, 16, v190
    v_and_b32 v205, 0xffff0000, v190
    v_pk_mul_f32 v[64:65], v[64:65], v[204:205]
    v_cvt_pk_bf16_f32 v104, v64, v65
    v_lshlrev_b32 v204, 16, v191
    v_and_b32 v205, 0xffff0000, v191
    v_pk_mul_f32 v[66:67], v[66:67], v[204:205]
    v_cvt_pk_bf16_f32 v105, v66, v67
    s_add_u32 s34, s35, 394240
    s_nop 1
    v_permlane32_swap_b32 v102, v104
    v_permlane32_swap_b32 v103, v105
    s_nop 0
    v_permlane16_swap_b32 v102, v104
    v_permlane16_swap_b32 v103, v105
    buffer_store_dwordx4 v[102:105], v211, s[16:19], s34 offen sc1
    v_lshlrev_b32 v204, 16, v194
    v_and_b32 v205, 0xffff0000, v194
    v_pk_mul_f32 v[68:69], v[68:69], v[204:205]
    v_cvt_pk_bf16_f32 v106, v68, v69
    v_lshlrev_b32 v204, 16, v195
    v_and_b32 v205, 0xffff0000, v195
    v_pk_mul_f32 v[70:71], v[70:71], v[204:205]
    v_cvt_pk_bf16_f32 v107, v70, v71
    s_add_u32 s34, s35, 525312
    buffer_store_dwordx2 v[106:107], v212, s[16:19], s34 offen sc1
    s_branch k2_kernel_hflag
k2_kernel_epi1:
    v_xor_b32 v212, 32, v212
    v_lshlrev_b32 v204, 16, v160
    v_and_b32 v205, 0xffff0000, v160
    v_pk_mul_f32 v[0:1], v[0:1], v[204:205]
    v_cvt_pk_bf16_f32 v72, v0, v1
    v_lshlrev_b32 v204, 16, v161
    v_and_b32 v205, 0xffff0000, v161
    v_pk_mul_f32 v[2:3], v[2:3], v[204:205]
    v_cvt_pk_bf16_f32 v73, v2, v3
    s_add_u32 s34, s35, 0
    buffer_store_dwordx2 v[72:73], v212, s[16:19], s34 offen sc1
    v_lshlrev_b32 v204, 16, v164
    v_and_b32 v205, 0xffff0000, v164
    v_pk_mul_f32 v[4:5], v[4:5], v[204:205]
    v_cvt_pk_bf16_f32 v74, v4, v5
    v_lshlrev_b32 v204, 16, v165
    v_and_b32 v205, 0xffff0000, v165
    v_pk_mul_f32 v[6:7], v[6:7], v[204:205]
    v_cvt_pk_bf16_f32 v75, v6, v7
    v_lshlrev_b32 v204, 16, v168
    v_and_b32 v205, 0xffff0000, v168
    v_pk_mul_f32 v[8:9], v[8:9], v[204:205]
    v_cvt_pk_bf16_f32 v76, v8, v9
    v_lshlrev_b32 v204, 16, v169
    v_and_b32 v205, 0xffff0000, v169
    v_pk_mul_f32 v[10:11], v[10:11], v[204:205]
    v_cvt_pk_bf16_f32 v77, v10, v11
    s_add_u32 s34, s35, 131072
    s_nop 1
    v_permlane32_swap_b32 v74, v76
    v_permlane32_swap_b32 v75, v77
    s_nop 0
    v_permlane16_swap_b32 v74, v76
    v_permlane16_swap_b32 v75, v77
    buffer_store_dwordx4 v[74:77], v211, s[16:19], s34 offen sc1
    v_lshlrev_b32 v204, 16, v172
    v_and_b32 v205, 0xffff0000, v172
    v_pk_mul_f32 v[12:13], v[12:13], v[204:205]
    v_cvt_pk_bf16_f32 v78, v12, v13
    v_lshlrev_b32 v204, 16, v173
    v_and_b32 v205, 0xffff0000, v173
    v_pk_mul_f32 v[14:15], v[14:15], v[204:205]
    v_cvt_pk_bf16_f32 v79, v14, v15
    v_lshlrev_b32 v204, 16, v176
    v_and_b32 v205, 0xffff0000, v176
    v_pk_mul_f32 v[16:17], v[16:17], v[204:205]
    v_cvt_pk_bf16_f32 v80, v16, v17
    v_lshlrev_b32 v204, 16, v177
    v_and_b32 v205, 0xffff0000, v177
    v_pk_mul_f32 v[18:19], v[18:19], v[204:205]
    v_cvt_pk_bf16_f32 v81, v18, v19
    s_add_u32 s34, s35, 262144
    s_nop 1
    v_permlane32_swap_b32 v78, v80
    v_permlane32_swap_b32 v79, v81
    s_nop 0
    v_permlane16_swap_b32 v78, v80
    v_permlane16_swap_b32 v79, v81
    buffer_store_dwordx4 v[78:81], v211, s[16:19], s34 offen sc1
    v_lshlrev_b32 v204, 16, v180
    v_and_b32 v205, 0xffff0000, v180
    v_pk_mul_f32 v[20:21], v[20:21], v[204:205]
    v_cvt_pk_bf16_f32 v82, v20, v21
    v_lshlrev_b32 v204, 16, v181
    v_and_b32 v205, 0xffff0000, v181
    v_pk_mul_f32 v[22:23], v[22:23], v[204:205]
    v_cvt_pk_bf16_f32 v83, v22, v23
    v_lshlrev_b32 v204, 16, v184
    v_and_b32 v205, 0xffff0000, v184
    v_pk_mul_f32 v[24:25], v[24:25], v[204:205]
    v_cvt_pk_bf16_f32 v84, v24, v25
    v_lshlrev_b32 v204, 16, v185
    v_and_b32 v205, 0xffff0000, v185
    v_pk_mul_f32 v[26:27], v[26:27], v[204:205]
    v_cvt_pk_bf16_f32 v85, v26, v27
    s_add_u32 s34, s35, 393216
    s_nop 1
    v_permlane32_swap_b32 v82, v84
    v_permlane32_swap_b32 v83, v85
    s_nop 0
    v_permlane16_swap_b32 v82, v84
    v_permlane16_swap_b32 v83, v85
    buffer_store_dwordx4 v[82:85], v211, s[16:19], s34 offen sc1
    v_lshlrev_b32 v204, 16, v188
    v_and_b32 v205, 0xffff0000, v188
    v_pk_mul_f32 v[28:29], v[28:29], v[204:205]
    v_cvt_pk_bf16_f32 v86, v28, v29
    v_lshlrev_b32 v204, 16, v189
    v_and_b32 v205, 0xffff0000, v189
    v_pk_mul_f32 v[30:31], v[30:31], v[204:205]
    v_cvt_pk_bf16_f32 v87, v30, v31
    v_lshlrev_b32 v204, 16, v192
    v_and_b32 v205, 0xffff0000, v192
    v_pk_mul_f32 v[32:33], v[32:33], v[204:205]
    v_cvt_pk_bf16_f32 v88, v32, v33
    v_lshlrev_b32 v204, 16, v193
    v_and_b32 v205, 0xffff0000, v193
    v_pk_mul_f32 v[34:35], v[34:35], v[204:205]
    v_cvt_pk_bf16_f32 v89, v34, v35
    s_add_u32 s34, s35, 524288
    s_nop 1
    v_permlane32_swap_b32 v86, v88
    v_permlane32_swap_b32 v87, v89
    s_nop 0
    v_permlane16_swap_b32 v86, v88
    v_permlane16_swap_b32 v87, v89
    buffer_store_dwordx4 v[86:89], v211, s[16:19], s34 offen sc1
    v_lshlrev_b32 v204, 16, v162
    v_and_b32 v205, 0xffff0000, v162
    v_pk_mul_f32 v[36:37], v[36:37], v[204:205]
    v_cvt_pk_bf16_f32 v90, v36, v37
    v_lshlrev_b32 v204, 16, v163
    v_and_b32 v205, 0xffff0000, v163
    v_pk_mul_f32 v[38:39], v[38:39], v[204:205]
    v_cvt_pk_bf16_f32 v91, v38, v39
    s_add_u32 s34, s35, 1024
    buffer_store_dwordx2 v[90:91], v212, s[16:19], s34 offen sc1
    v_lshlrev_b32 v204, 16, v166
    v_and_b32 v205, 0xffff0000, v166
    v_pk_mul_f32 v[40:41], v[40:41], v[204:205]
    v_cvt_pk_bf16_f32 v92, v40, v41
    v_lshlrev_b32 v204, 16, v167
    v_and_b32 v205, 0xffff0000, v167
    v_pk_mul_f32 v[42:43], v[42:43], v[204:205]
    v_cvt_pk_bf16_f32 v93, v42, v43
    v_lshlrev_b32 v204, 16, v170
    v_and_b32 v205, 0xffff0000, v170
    v_pk_mul_f32 v[44:45], v[44:45], v[204:205]
    v_cvt_pk_bf16_f32 v94, v44, v45
    v_lshlrev_b32 v204, 16, v171
    v_and_b32 v205, 0xffff0000, v171
    v_pk_mul_f32 v[46:47], v[46:47], v[204:205]
    v_cvt_pk_bf16_f32 v95, v46, v47
    s_add_u32 s34, s35, 132096
    s_nop 1
    v_permlane32_swap_b32 v92, v94
    v_permlane32_swap_b32 v93, v95
    s_nop 0
    v_permlane16_swap_b32 v92, v94
    v_permlane16_swap_b32 v93, v95
    buffer_store_dwordx4 v[92:95], v211, s[16:19], s34 offen sc1
    v_lshlrev_b32 v204, 16, v174
    v_and_b32 v205, 0xffff0000, v174
    v_pk_mul_f32 v[48:49], v[48:49], v[204:205]
    v_cvt_pk_bf16_f32 v96, v48, v49
    v_lshlrev_b32 v204, 16, v175
    v_and_b32 v205, 0xffff0000, v175
    v_pk_mul_f32 v[50:51], v[50:51], v[204:205]
    v_cvt_pk_bf16_f32 v97, v50, v51
    v_lshlrev_b32 v204, 16, v178
    v_and_b32 v205, 0xffff0000, v178
    v_pk_mul_f32 v[52:53], v[52:53], v[204:205]
    v_cvt_pk_bf16_f32 v98, v52, v53
    v_lshlrev_b32 v204, 16, v179
    v_and_b32 v205, 0xffff0000, v179
    v_pk_mul_f32 v[54:55], v[54:55], v[204:205]
    v_cvt_pk_bf16_f32 v99, v54, v55
    s_add_u32 s34, s35, 263168
    s_nop 1
    v_permlane32_swap_b32 v96, v98
    v_permlane32_swap_b32 v97, v99
    s_nop 0
    v_permlane16_swap_b32 v96, v98
    v_permlane16_swap_b32 v97, v99
    buffer_store_dwordx4 v[96:99], v211, s[16:19], s34 offen sc1
    v_lshlrev_b32 v204, 16, v182
    v_and_b32 v205, 0xffff0000, v182
    v_pk_mul_f32 v[56:57], v[56:57], v[204:205]
    v_cvt_pk_bf16_f32 v100, v56, v57
    v_lshlrev_b32 v204, 16, v183
    v_and_b32 v205, 0xffff0000, v183
    v_pk_mul_f32 v[58:59], v[58:59], v[204:205]
    v_cvt_pk_bf16_f32 v101, v58, v59
    v_lshlrev_b32 v204, 16, v186
    v_and_b32 v205, 0xffff0000, v186
    v_pk_mul_f32 v[60:61], v[60:61], v[204:205]
    v_cvt_pk_bf16_f32 v102, v60, v61
    v_lshlrev_b32 v204, 16, v187
    v_and_b32 v205, 0xffff0000, v187
    v_pk_mul_f32 v[62:63], v[62:63], v[204:205]
    v_cvt_pk_bf16_f32 v103, v62, v63
    s_add_u32 s34, s35, 394240
    s_nop 1
    v_permlane32_swap_b32 v100, v102
    v_permlane32_swap_b32 v101, v103
    s_nop 0
    v_permlane16_swap_b32 v100, v102
    v_permlane16_swap_b32 v101, v103
    buffer_store_dwordx4 v[100:103], v211, s[16:19], s34 offen sc1
    v_lshlrev_b32 v204, 16, v190
    v_and_b32 v205, 0xffff0000, v190
    v_pk_mul_f32 v[64:65], v[64:65], v[204:205]
    v_cvt_pk_bf16_f32 v104, v64, v65
    v_lshlrev_b32 v204, 16, v191
    v_and_b32 v205, 0xffff0000, v191
    v_pk_mul_f32 v[66:67], v[66:67], v[204:205]
    v_cvt_pk_bf16_f32 v105, v66, v67
    v_lshlrev_b32 v204, 16, v194
    v_and_b32 v205, 0xffff0000, v194
    v_pk_mul_f32 v[68:69], v[68:69], v[204:205]
    v_cvt_pk_bf16_f32 v106, v68, v69
    v_lshlrev_b32 v204, 16, v195
    v_and_b32 v205, 0xffff0000, v195
    v_pk_mul_f32 v[70:71], v[70:71], v[204:205]
    v_cvt_pk_bf16_f32 v107, v70, v71
    s_add_u32 s34, s35, 525312
    s_nop 1
    v_permlane32_swap_b32 v104, v106
    v_permlane32_swap_b32 v105, v107
    s_nop 0
    v_permlane16_swap_b32 v104, v106
    v_permlane16_swap_b32 v105, v107
    buffer_store_dwordx4 v[104:107], v211, s[16:19], s34 offen sc1
    s_branch k2_kernel_hflag
k2_kernel_hflag:
    s_lshl_b32 s33, s26, 4
    s_add_u32 s33, s33, s27
    s_lshl_b32 s33, s33, 2
    s_add_u32 s33, s33, s29
k2_kernel_flag:
    s_lshl_b32 s33, s33, 7
    s_add_u32 s33, s33, 41066752
    v_lshlrev_b32 v1, 2, v208
    s_waitcnt vmcnt(0) lgkmcnt(0)
    v_mov_b32 v0, s62
    s_mov_b64 exec, 0xffffffff
    buffer_store_dword v0, v1, s[16:19], s33 offen sc1
    s_mov_b64 exec, -1
    s_branch k3f_entry
k2_kernel_z1:
    buffer_load_dwordx4 v[160:163], v207, s[16:19], s31 offen offset:0
    buffer_load_dwordx4 v[164:167], v207, s[16:19], s31 offen offset:1024
    s_add_u32 s31, s31, 131072
    buffer_load_dwordx4 v[168:171], v207, s[16:19], s31 offen offset:0
    buffer_load_dwordx4 v[172:175], v207, s[16:19], s31 offen offset:1024
    s_add_u32 s31, s31, 131072
    buffer_load_dwordx4 v[176:179], v207, s[16:19], s31 offen offset:0
    buffer_load_dwordx4 v[180:183], v207, s[16:19], s31 offen offset:1024
    s_add_u32 s31, s31, 131072
    buffer_load_dwordx4 v[184:187], v207, s[16:19], s31 offen offset:0
    buffer_load_dwordx4 v[188:191], v207, s[16:19], s31 offen offset:1024
    buffer_load_dwordx4 v[192:195], v213, s[16:19], s38 offen
    s_branch k2_kernel_z1back
k2_kernel_loader:
    v_lshrrev_b32 v204, 3, v208
    v_and_b32 v205, 7, v208
    v_xor_b32 v205, v205, v204
    v_lshlrev_b32 v205, 4, v205
    s_lshl_b32 s31, s26, 7
    v_add_u32 v204, s31, v204
    v_lshl_add_u32 v196, v204, 12, v205
    v_add_u32 v197, 31744, v196
    v_add_u32 v198, 63488, v196
    v_add_u32 v199, 95232, v196
    v_lshlrev_b32 v200, 4, v208
    s_mul_i32 s32, s27, 589824
    s_add_u32 s32, s32, 0
    s_mov_b32 s36, 0
    s_cmp_eq_u32 s29, 5
    s_cbranch_scc1 k2_kernel_loader1
    s_add_u32 s35, s30, s39
    s_and_b32 s35, s35, 15
    s_and_b32 s33, s30, 16
    s_or_b32 s35, s35, s33
    s_lshl_b32 s33, s35, 7
    s_mul_i32 s34, s35, 18432
    s_add_u32 s34, s34, s32
    s_add_u32 m0, s36, 0
    s_nop 0
    buffer_load_dwordx4 v196, s[12:15], s33 offen offset:0 lds
    buffer_load_dwordx4 v197, s[12:15], s33 offen offset:1024 lds
    buffer_load_dwordx4 v198, s[12:15], s33 offen offset:2048 lds
    buffer_load_dwordx4 v199, s[12:15], s33 offen offset:3072 lds
    s_add_u32 m0, s36, 4096
    s_add_u32 s33, s33, 131072
    buffer_load_dwordx4 v196, s[12:15], s33 offen offset:0 lds
    buffer_load_dwordx4 v197, s[12:15], s33 offen offset:1024 lds
    buffer_load_dwordx4 v198, s[12:15], s33 offen offset:2048 lds
    buffer_load_dwordx4 v199, s[12:15], s33 offen offset:3072 lds
    s_add_u32 m0, s36, 8192
    s_add_u32 s33, s33, 131072
    buffer_load_dwordx4 v196, s[12:15], s33 offen offset:0 lds
    buffer_load_dwordx4 v197, s[12:15], s33 offen offset:1024 lds
    buffer_load_dwordx4 v198, s[12:15], s33 offen offset:2048 lds
    buffer_load_dwordx4 v199, s[12:15], s33 offen offset:3072 lds
    s_add_u32 m0, s36, 12288
    s_add_u32 s33, s33, 131072
    buffer_load_dwordx4 v196, s[12:15], s33 offen offset:0 lds
    buffer_load_dwordx4 v197, s[12:15], s33 offen offset:1024 lds
    buffer_load_dwordx4 v198, s[12:15], s33 offen offset:2048 lds
    buffer_load_dwordx4 v199, s[12:15], s33 offen offset:3072 lds
    s_add_u32 m0, s36, 32768
    s_add_u32 s34, s34, 16384
    buffer_load_dwordx4 v200, s[16:19], s34 offen offset:1024 lds
    s_add_u32 s30, s30, 1
    s_and_b32 s30, s30, 31
    s_add_u32 s36, s36, 34816
    s_cmp_ge_u32 s36, 139264
    s_cselect_b32 s36, 0, s36
    s_add_u32 s35, s30, s39
    s_and_b32 s35, s35, 15
    s_and_b32 s33, s30, 16
    s_or_b32 s35, s35, s33
    s_lshl_b32 s33, s35, 7
    s_mul_i32 s34, s35, 18432
    s_add_u32 s34, s34, s32
    s_add_u32 m0, s36, 0
    s_nop 0
    buffer_load_dwordx4 v196, s[12:15], s33 offen offset:0 lds
    buffer_load_dwordx4 v197, s[12:15], s33 offen offset:1024 lds
    buffer_load_dwordx4 v198, s[12:15], s33 offen offset:2048 lds
    buffer_load_dwordx4 v199, s[12:15], s33 offen offset:3072 lds
    s_add_u32 m0, s36, 4096
    s_add_u32 s33, s33, 131072
    buffer_load_dwordx4 v196, s[12:15], s33 offen offset:0 lds
    buffer_load_dwordx4 v197, s[12:15], s33 offen offset:1024 lds
    buffer_load_dwordx4 v198, s[12:15], s33 offen offset:2048 lds
    buffer_load_dwordx4 v199, s[12:15], s33 offen offset:3072 lds
    s_add_u32 m0, s36, 8192
    s_add_u32 s33, s33, 131072
    buffer_load_dwordx4 v196, s[12:15], s33 offen offset:0 lds
    buffer_load_dwordx4 v197, s[12:15], s33 offen offset:1024 lds
    buffer_load_dwordx4 v198, s[12:15], s33 offen offset:2048 lds
    buffer_load_dwordx4 v199, s[12:15], s33 offen offset:3072 lds
    s_add_u32 m0, s36, 12288
    s_add_u32 s33, s33, 131072
    buffer_load_dwordx4 v196, s[12:15], s33 offen offset:0 lds
    buffer_load_dwordx4 v197, s[12:15], s33 offen offset:1024 lds
    buffer_load_dwordx4 v198, s[12:15], s33 offen offset:2048 lds
    buffer_load_dwordx4 v199, s[12:15], s33 offen offset:3072 lds
    s_add_u32 m0, s36, 32768
    s_add_u32 s34, s34, 16384
    buffer_load_dwordx4 v200, s[16:19], s34 offen offset:1024 lds
    s_add_u32 s30, s30, 1
    s_and_b32 s30, s30, 31
    s_add_u32 s36, s36, 34816
    s_cmp_ge_u32 s36, 139264
    s_cselect_b32 s36, 0, s36
    s_waitcnt vmcnt(17)
    s_barrier
    s_add_u32 s35, s30, s39
    s_and_b32 s35, s35, 15
    s_and_b32 s33, s30, 16
    s_or_b32 s35, s35, s33
    s_lshl_b32 s33, s35, 7
    s_mul_i32 s34, s35, 18432
    s_add_u32 s34, s34, s32
    s_add_u32 m0, s36, 0
    s_nop 0
    buffer_load_dwordx4 v196, s[12:15], s33 offen offset:0 lds
    buffer_load_dwordx4 v197, s[12:15], s33 offen offset:1024 lds
    buffer_load_dwordx4 v198, s[12:15], s33 offen offset:2048 lds
    buffer_load_dwordx4 v199, s[12:15], s33 offen offset:3072 lds
    s_add_u32 m0, s36, 4096
    s_add_u32 s33, s33, 131072
    buffer_load_dwordx4 v196, s[12:15], s33 offen offset:0 lds
    buffer_load_dwordx4 v197, s[12:15], s33 offen offset:1024 lds
    buffer_load_dwordx4 v198, s[12:15], s33 offen offset:2048 lds
    buffer_load_dwordx4 v199, s[12:15], s33 offen offset:3072 lds
    s_add_u32 m0, s36, 8192
    s_add_u32 s33, s33, 131072
    buffer_load_dwordx4 v196, s[12:15], s33 offen offset:0 lds
    buffer_load_dwordx4 v197, s[12:15], s33 offen offset:1024 lds
    buffer_load_dwordx4 v198, s[12:15], s33 offen offset:2048 lds
    buffer_load_dwordx4 v199, s[12:15], s33 offen offset:3072 lds
    s_add_u32 m0, s36, 12288
    s_add_u32 s33, s33, 131072
    buffer_load_dwordx4 v196, s[12:15], s33 offen offset:0 lds
    buffer_load_dwordx4 v197, s[12:15], s33 offen offset:1024 lds
    buffer_load_dwordx4 v198, s[12:15], s33 offen offset:2048 lds
    buffer_load_dwordx4 v199, s[12:15], s33 offen offset:3072 lds
    s_add_u32 m0, s36, 32768
    s_add_u32 s34, s34, 16384
    buffer_load_dwordx4 v200, s[16:19], s34 offen offset:1024 lds
    s_add_u32 s30, s30, 1
    s_and_b32 s30, s30, 31
    s_add_u32 s36, s36, 34816
    s_cmp_ge_u32 s36, 139264
    s_cselect_b32 s36, 0, s36
    s_add_u32 s35, s30, s39
    s_and_b32 s35, s35, 15
    s_and_b32 s33, s30, 16
    s_or_b32 s35, s35, s33
    s_lshl_b32 s33, s35, 7
    s_mul_i32 s34, s35, 18432
    s_add_u32 s34, s34, s32
    s_add_u32 m0, s36, 0
    s_nop 0
    buffer_load_dwordx4 v196, s[12:15], s33 offen offset:0 lds
    buffer_load_dwordx4 v197, s[12:15], s33 offen offset:1024 lds
    buffer_load_dwordx4 v198, s[12:15], s33 offen offset:2048 lds
    buffer_load_dwordx4 v199, s[12:15], s33 offen offset:3072 lds
    s_add_u32 m0, s36, 4096
    s_add_u32 s33, s33, 131072
    buffer_load_dwordx4 v196, s[12:15], s33 offen offset:0 lds
    buffer_load_dwordx4 v197, s[12:15], s33 offen offset:1024 lds
    buffer_load_dwordx4 v198, s[12:15], s33 offen offset:2048 lds
    buffer_load_dwordx4 v199, s[12:15], s33 offen offset:3072 lds
    s_add_u32 m0, s36, 8192
    s_add_u32 s33, s33, 131072
    buffer_load_dwordx4 v196, s[12:15], s33 offen offset:0 lds
    buffer_load_dwordx4 v197, s[12:15], s33 offen offset:1024 lds
    buffer_load_dwordx4 v198, s[12:15], s33 offen offset:2048 lds
    buffer_load_dwordx4 v199, s[12:15], s33 offen offset:3072 lds
    s_add_u32 m0, s36, 12288
    s_add_u32 s33, s33, 131072
    buffer_load_dwordx4 v196, s[12:15], s33 offen offset:0 lds
    buffer_load_dwordx4 v197, s[12:15], s33 offen offset:1024 lds
    buffer_load_dwordx4 v198, s[12:15], s33 offen offset:2048 lds
    buffer_load_dwordx4 v199, s[12:15], s33 offen offset:3072 lds
    s_add_u32 m0, s36, 32768
    s_add_u32 s34, s34, 16384
    buffer_load_dwordx4 v200, s[16:19], s34 offen offset:1024 lds
    s_add_u32 s30, s30, 1
    s_and_b32 s30, s30, 31
    s_add_u32 s36, s36, 34816
    s_cmp_ge_u32 s36, 139264
    s_cselect_b32 s36, 0, s36
    s_mov_b32 s37, 28
k2_kernel_lloop0:
    s_waitcnt vmcnt(34)
    s_barrier
    s_add_u32 s35, s30, s39
    s_and_b32 s35, s35, 15
    s_and_b32 s33, s30, 16
    s_or_b32 s35, s35, s33
    s_lshl_b32 s33, s35, 7
    s_mul_i32 s34, s35, 18432
    s_add_u32 s34, s34, s32
    s_add_u32 m0, s36, 0
    s_nop 0
    buffer_load_dwordx4 v196, s[12:15], s33 offen offset:0 lds
    buffer_load_dwordx4 v197, s[12:15], s33 offen offset:1024 lds
    buffer_load_dwordx4 v198, s[12:15], s33 offen offset:2048 lds
    buffer_load_dwordx4 v199, s[12:15], s33 offen offset:3072 lds
    s_add_u32 m0, s36, 4096
    s_add_u32 s33, s33, 131072
    buffer_load_dwordx4 v196, s[12:15], s33 offen offset:0 lds
    buffer_load_dwordx4 v197, s[12:15], s33 offen offset:1024 lds
    buffer_load_dwordx4 v198, s[12:15], s33 offen offset:2048 lds
    buffer_load_dwordx4 v199, s[12:15], s33 offen offset:3072 lds
    s_add_u32 m0, s36, 8192
    s_add_u32 s33, s33, 131072
    buffer_load_dwordx4 v196, s[12:15], s33 offen offset:0 lds
    buffer_load_dwordx4 v197, s[12:15], s33 offen offset:1024 lds
    buffer_load_dwordx4 v198, s[12:15], s33 offen offset:2048 lds
    buffer_load_dwordx4 v199, s[12:15], s33 offen offset:3072 lds
    s_add_u32 m0, s36, 12288
    s_add_u32 s33, s33, 131072
    buffer_load_dwordx4 v196, s[12:15], s33 offen offset:0 lds
    buffer_load_dwordx4 v197, s[12:15], s33 offen offset:1024 lds
    buffer_load_dwordx4 v198, s[12:15], s33 offen offset:2048 lds
    buffer_load_dwordx4 v199, s[12:15], s33 offen offset:3072 lds
    s_add_u32 m0, s36, 32768
    s_add_u32 s34, s34, 16384
    buffer_load_dwordx4 v200, s[16:19], s34 offen offset:1024 lds
    s_add_u32 s30, s30, 1
    s_and_b32 s30, s30, 31
    s_add_u32 s36, s36, 34816
    s_cmp_ge_u32 s36, 139264
    s_cselect_b32 s36, 0, s36
    s_sub_u32 s37, s37, 1
    s_cmp_lg_u32 s37, 0
    s_cbranch_scc1 k2_kernel_lloop0
    s_waitcnt vmcnt(34)
    s_barrier
    s_branch k2_kernel_ltail
k2_kernel_loader1:
    s_add_u32 s35, s30, s39
    s_and_b32 s35, s35, 15
    s_and_b32 s33, s30, 16
    s_or_b32 s35, s35, s33
    s_lshl_b32 s33, s35, 7
    s_mul_i32 s34, s35, 18432
    s_add_u32 s34, s34, s32
    s_add_u32 m0, s36, 16384
    s_nop 0
    buffer_load_dwordx4 v200, s[16:19], s34 offen offset:0 lds
    buffer_load_dwordx4 v200, s[16:19], s34 offen offset:1024 lds
    buffer_load_dwordx4 v200, s[16:19], s34 offen offset:2048 lds
    buffer_load_dwordx4 v200, s[16:19], s34 offen offset:3072 lds
    s_add_u32 m0, s36, 20480
    s_add_u32 s34, s34, 4096
    buffer_load_dwordx4 v200, s[16:19], s34 offen offset:0 lds
    buffer_load_dwordx4 v200, s[16:19], s34 offen offset:1024 lds
    buffer_load_dwordx4 v200, s[16:19], s34 offen offset:2048 lds
    buffer_load_dwordx4 v200, s[16:19], s34 offen offset:3072 lds
    s_add_u32 m0, s36, 24576
    s_add_u32 s34, s34, 4096
    buffer_load_dwordx4 v200, s[16:19], s34 offen offset:0 lds
    buffer_load_dwordx4 v200, s[16:19], s34 offen offset:1024 lds
    buffer_load_dwordx4 v200, s[16:19], s34 offen offset:2048 lds
    buffer_load_dwordx4 v200, s[16:19], s34 offen offset:3072 lds
    s_add_u32 m0, s36, 28672
    s_add_u32 s34, s34, 4096
    buffer_load_dwordx4 v200, s[16:19], s34 offen offset:0 lds
    buffer_load_dwordx4 v200, s[16:19], s34 offen offset:1024 lds
    buffer_load_dwordx4 v200, s[16:19], s34 offen offset:2048 lds
    buffer_load_dwordx4 v200, s[16:19], s34 offen offset:3072 lds
    s_add_u32 m0, s36, 32768
    s_add_u32 s34, s34, 4096
    buffer_load_dwordx4 v200, s[16:19], s34 offen offset:0 lds
    s_add_u32 s30, s30, 1
    s_and_b32 s30, s30, 31
    s_add_u32 s36, s36, 34816
    s_cmp_ge_u32 s36, 139264
    s_cselect_b32 s36, 0, s36
    s_add_u32 s35, s30, s39
    s_and_b32 s35, s35, 15
    s_and_b32 s33, s30, 16
    s_or_b32 s35, s35, s33
    s_lshl_b32 s33, s35, 7
    s_mul_i32 s34, s35, 18432
    s_add_u32 s34, s34, s32
    s_add_u32 m0, s36, 16384
    s_nop 0
    buffer_load_dwordx4 v200, s[16:19], s34 offen offset:0 lds
    buffer_load_dwordx4 v200, s[16:19], s34 offen offset:1024 lds
    buffer_load_dwordx4 v200, s[16:19], s34 offen offset:2048 lds
    buffer_load_dwordx4 v200, s[16:19], s34 offen offset:3072 lds
    s_add_u32 m0, s36, 20480
    s_add_u32 s34, s34, 4096
    buffer_load_dwordx4 v200, s[16:19], s34 offen offset:0 lds
    buffer_load_dwordx4 v200, s[16:19], s34 offen offset:1024 lds
    buffer_load_dwordx4 v200, s[16:19], s34 offen offset:2048 lds
    buffer_load_dwordx4 v200, s[16:19], s34 offen offset:3072 lds
    s_add_u32 m0, s36, 24576
    s_add_u32 s34, s34, 4096
    buffer_load_dwordx4 v200, s[16:19], s34 offen offset:0 lds
    buffer_load_dwordx4 v200, s[16:19], s34 offen offset:1024 lds
    buffer_load_dwordx4 v200, s[16:19], s34 offen offset:2048 lds
    buffer_load_dwordx4 v200, s[16:19], s34 offen offset:3072 lds
    s_add_u32 m0, s36, 28672
    s_add_u32 s34, s34, 4096
    buffer_load_dwordx4 v200, s[16:19], s34 offen offset:0 lds
    buffer_load_dwordx4 v200, s[16:19], s34 offen offset:1024 lds
    buffer_load_dwordx4 v200, s[16:19], s34 offen offset:2048 lds
    buffer_load_dwordx4 v200, s[16:19], s34 offen offset:3072 lds
    s_add_u32 m0, s36, 32768
    s_add_u32 s34, s34, 4096
    buffer_load_dwordx4 v200, s[16:19], s34 offen offset:0 lds
    s_add_u32 s30, s30, 1
    s_and_b32 s30, s30, 31
    s_add_u32 s36, s36, 34816
    s_cmp_ge_u32 s36, 139264
    s_cselect_b32 s36, 0, s36
    s_waitcnt vmcnt(17)
    s_barrier
    s_add_u32 s35, s30, s39
    s_and_b32 s35, s35, 15
    s_and_b32 s33, s30, 16
    s_or_b32 s35, s35, s33
    s_lshl_b32 s33, s35, 7
    s_mul_i32 s34, s35, 18432
    s_add_u32 s34, s34, s32
    s_add_u32 m0, s36, 16384
    s_nop 0
    buffer_load_dwordx4 v200, s[16:19], s34 offen offset:0 lds
    buffer_load_dwordx4 v200, s[16:19], s34 offen offset:1024 lds
    buffer_load_dwordx4 v200, s[16:19], s34 offen offset:2048 lds
    buffer_load_dwordx4 v200, s[16:19], s34 offen offset:3072 lds
    s_add_u32 m0, s36, 20480
    s_add_u32 s34, s34, 4096
    buffer_load_dwordx4 v200, s[16:19], s34 offen offset:0 lds
    buffer_load_dwordx4 v200, s[16:19], s34 offen offset:1024 lds
    buffer_load_dwordx4 v200, s[16:19], s34 offen offset:2048 lds
    buffer_load_dwordx4 v200, s[16:19], s34 offen offset:3072 lds
    s_add_u32 m0, s36, 24576
    s_add_u32 s34, s34, 4096
    buffer_load_dwordx4 v200, s[16:19], s34 offen offset:0 lds
    buffer_load_dwordx4 v200, s[16:19], s34 offen offset:1024 lds
    buffer_load_dwordx4 v200, s[16:19], s34 offen offset:2048 lds
    buffer_load_dwordx4 v200, s[16:19], s34 offen offset:3072 lds
    s_add_u32 m0, s36, 28672
    s_add_u32 s34, s34, 4096
    buffer_load_dwordx4 v200, s[16:19], s34 offen offset:0 lds
    buffer_load_dwordx4 v200, s[16:19], s34 offen offset:1024 lds
    buffer_load_dwordx4 v200, s[16:19], s34 offen offset:2048 lds
    buffer_load_dwordx4 v200, s[16:19], s34 offen offset:3072 lds
    s_add_u32 m0, s36, 32768
    s_add_u32 s34, s34, 4096
    buffer_load_dwordx4 v200, s[16:19], s34 offen offset:0 lds
    s_add_u32 s30, s30, 1
    s_and_b32 s30, s30, 31
    s_add_u32 s36, s36, 34816
    s_cmp_ge_u32 s36, 139264
    s_cselect_b32 s36, 0, s36
    s_add_u32 s35, s30, s39
    s_and_b32 s35, s35, 15
    s_and_b32 s33, s30, 16
    s_or_b32 s35, s35, s33
    s_lshl_b32 s33, s35, 7
    s_mul_i32 s34, s35, 18432
    s_add_u32 s34, s34, s32
    s_add_u32 m0, s36, 16384
    s_nop 0
    buffer_load_dwordx4 v200, s[16:19], s34 offen offset:0 lds
    buffer_load_dwordx4 v200, s[16:19], s34 offen offset:1024 lds
    buffer_load_dwordx4 v200, s[16:19], s34 offen offset:2048 lds
    buffer_load_dwordx4 v200, s[16:19], s34 offen offset:3072 lds
    s_add_u32 m0, s36, 20480
    s_add_u32 s34, s34, 4096
    buffer_load_dwordx4 v200, s[16:19], s34 offen offset:0 lds
    buffer_load_dwordx4 v200, s[16:19], s34 offen offset:1024 lds
    buffer_load_dwordx4 v200, s[16:19], s34 offen offset:2048 lds
    buffer_load_dwordx4 v200, s[16:19], s34 offen offset:3072 lds
    s_add_u32 m0, s36, 24576
    s_add_u32 s34, s34, 4096
    buffer_load_dwordx4 v200, s[16:19], s34 offen offset:0 lds
    buffer_load_dwordx4 v200, s[16:19], s34 offen offset:1024 lds
    buffer_load_dwordx4 v200, s[16:19], s34 offen offset:2048 lds
    buffer_load_dwordx4 v200, s[16:19], s34 offen offset:3072 lds
    s_add_u32 m0, s36, 28672
    s_add_u32 s34, s34, 4096
    buffer_load_dwordx4 v200, s[16:19], s34 offen offset:0 lds
    buffer_load_dwordx4 v200, s[16:19], s34 offen offset:1024 lds
    buffer_load_dwordx4 v200, s[16:19], s34 offen offset:2048 lds
    buffer_load_dwordx4 v200, s[16:19], s34 offen offset:3072 lds
    s_add_u32 m0, s36, 32768
    s_add_u32 s34, s34, 4096
    buffer_load_dwordx4 v200, s[16:19], s34 offen offset:0 lds
    s_add_u32 s30, s30, 1
    s_and_b32 s30, s30, 31
    s_add_u32 s36, s36, 34816
    s_cmp_ge_u32 s36, 139264
    s_cselect_b32 s36, 0, s36
    s_mov_b32 s37, 28
k2_kernel_lloop1:
    s_waitcnt vmcnt(34)
    s_barrier
    s_add_u32 s35, s30, s39
    s_and_b32 s35, s35, 15
    s_and_b32 s33, s30, 16
    s_or_b32 s35, s35, s33
    s_lshl_b32 s33, s35, 7
    s_mul_i32 s34, s35, 18432
    s_add_u32 s34, s34, s32
    s_add_u32 m0, s36, 16384
    s_nop 0
    buffer_load_dwordx4 v200, s[16:19], s34 offen offset:0 lds
    buffer_load_dwordx4 v200, s[16:19], s34 offen offset:1024 lds
    buffer_load_dwordx4 v200, s[16:19], s34 offen offset:2048 lds
    buffer_load_dwordx4 v200, s[16:19], s34 offen offset:3072 lds
    s_add_u32 m0, s36, 20480
    s_add_u32 s34, s34, 4096
    buffer_load_dwordx4 v200, s[16:19], s34 offen offset:0 lds
    buffer_load_dwordx4 v200, s[16:19], s34 offen offset:1024 lds
    buffer_load_dwordx4 v200, s[16:19], s34 offen offset:2048 lds
    buffer_load_dwordx4 v200, s[16:19], s34 offen offset:3072 lds
    s_add_u32 m0, s36, 24576
    s_add_u32 s34, s34, 4096
    buffer_load_dwordx4 v200, s[16:19], s34 offen offset:0 lds
    buffer_load_dwordx4 v200, s[16:19], s34 offen offset:1024 lds
    buffer_load_dwordx4 v200, s[16:19], s34 offen offset:2048 lds
    buffer_load_dwordx4 v200, s[16:19], s34 offen offset:3072 lds
    s_add_u32 m0, s36, 28672
    s_add_u32 s34, s34, 4096
    buffer_load_dwordx4 v200, s[16:19], s34 offen offset:0 lds
    buffer_load_dwordx4 v200, s[16:19], s34 offen offset:1024 lds
    buffer_load_dwordx4 v200, s[16:19], s34 offen offset:2048 lds
    buffer_load_dwordx4 v200, s[16:19], s34 offen offset:3072 lds
    s_add_u32 m0, s36, 32768
    s_add_u32 s34, s34, 4096
    buffer_load_dwordx4 v200, s[16:19], s34 offen offset:0 lds
    s_add_u32 s30, s30, 1
    s_and_b32 s30, s30, 31
    s_add_u32 s36, s36, 34816
    s_cmp_ge_u32 s36, 139264
    s_cselect_b32 s36, 0, s36
    s_sub_u32 s37, s37, 1
    s_cmp_lg_u32 s37, 0
    s_cbranch_scc1 k2_kernel_lloop1
    s_waitcnt vmcnt(34)
    s_barrier
k2_kernel_ltail:
    s_lshr_b32 s40, s2, 2
    s_and_b32 s41, s2, 3
    s_and_b32 s42, s41, 1
    s_sub_u32 s43, s29, 4
    s_lshl_b32 s44, s43, 2
    s_add_u32 s44, s44, s42
    s_mul_i32 s45, s41, 36864
    s_add_u32 s45, s45, 36200448
    s_mul_i32 s46, s41, 655360
    s_lshl_b32 s47, s40, 11
    s_add_u32 s46, s46, s47
    s_add_u32 s46, s46, 30679040
    v_lshlrev_b32 v196, 4, v208
    v_lshlrev_b32 v197, 6, v209
    v_lshl_add_u32 v197, v210, 4, v197
    s_add_u32 s48, s44, 0
    s_lshl_b32 s49, s48, 12
    s_add_u32 s49, s49, s45
    buffer_load_dwordx4 v[0:3], v196, s[16:19], s49 offen offset:0
    buffer_load_dwordx4 v[4:7], v196, s[16:19], s49 offen offset:1024
    buffer_load_dwordx4 v[8:11], v196, s[16:19], s49 offen offset:2048
    buffer_load_dwordx4 v[12:15], v196, s[16:19], s49 offen offset:3072
    s_lshl_b32 s50, s48, 1
    s_lshr_b32 s50, 0x3e940, s50
    s_and_b32 s50, s50, 3
    s_mul_i32 s50, s50, 131072
    s_add_u32 s50, s50, s46
    buffer_load_dwordx4 v[80:83], v197, s[16:19], s50 offen offset:0
    buffer_load_dwordx4 v[88:91], v197, s[16:19], s50 offen offset:1024
    s_add_u32 s50, s50, 131072
    buffer_load_dwordx4 v[84:87], v197, s[16:19], s50 offen offset:0
    buffer_load_dwordx4 v[92:95], v197, s[16:19], s50 offen offset:1024
    s_waitcnt vmcnt(25)
    s_barrier
    s_add_u32 s48, s44, 1
    s_lshl_b32 s49, s48, 12
    s_add_u32 s49, s49, s45
    buffer_load_dwordx4 v[16:19], v196, s[16:19], s49 offen offset:0
    buffer_load_dwordx4 v[20:23], v196, s[16:19], s49 offen offset:1024
    buffer_load_dwordx4 v[24:27], v196, s[16:19], s49 offen offset:2048
    buffer_load_dwordx4 v[28:31], v196, s[16:19], s49 offen offset:3072
    s_lshl_b32 s50, s48, 1
    s_lshr_b32 s50, 0x3e940, s50
    s_and_b32 s50, s50, 3
    s_mul_i32 s50, s50, 131072
    s_add_u32 s50, s50, s46
    buffer_load_dwordx4 v[96:99], v197, s[16:19], s50 offen offset:0
    buffer_load_dwordx4 v[104:107], v197, s[16:19], s50 offen offset:1024
    s_add_u32 s50, s50, 131072
    buffer_load_dwordx4 v[100:103], v197, s[16:19], s50 offen offset:0
    buffer_load_dwordx4 v[108:111], v197, s[16:19], s50 offen offset:1024
    s_add_u32 s48, s44, 2
    s_lshl_b32 s49, s48, 12
    s_add_u32 s49, s49, s45
    buffer_load_dwordx4 v[32:35], v196, s[16:19], s49 offen offset:0
    buffer_load_dwordx4 v[36:39], v196, s[16:19], s49 offen offset:1024
    buffer_load_dwordx4 v[40:43], v196, s[16:19], s49 offen offset:2048
    buffer_load_dwordx4 v[44:47], v196, s[16:19], s49 offen offset:3072
    s_lshl_b32 s50, s48, 1
    s_lshr_b32 s50, 0x3e940, s50
    s_and_b32 s50, s50, 3
    s_mul_i32 s50, s50, 131072
    s_add_u32 s50, s50, s46
    buffer_load_dwordx4 v[112:115], v197, s[16:19], s50 offen offset:0
    buffer_load_dwordx4 v[120:123], v197, s[16:19], s50 offen offset:1024
    s_add_u32 s50, s50, 131072
    buffer_load_dwordx4 v[116:119], v197, s[16:19], s50 offen offset:0
    buffer_load_dwordx4 v[124:127], v197, s[16:19], s50 offen offset:1024
    s_waitcnt vmcnt(24)
    s_barrier
    s_add_u32 s48, s44, 3
    s_lshl_b32 s49, s48, 12
    s_add_u32 s49, s49, s45
    buffer_load_dwordx4 v[48:51], v196, s[16:19], s49 offen offset:0
    buffer_load_dwordx4 v[52:55], v196, s[16:19], s49 offen offset:1024
    buffer_load_dwordx4 v[56:59], v196, s[16:19], s49 offen offset:2048
    buffer_load_dwordx4 v[60:63], v196, s[16:19], s49 offen offset:3072
    s_lshl_b32 s50, s48, 1
    s_lshr_b32 s50, 0x3e940, s50
    s_and_b32 s50, s50, 3
    s_mul_i32 s50, s50, 131072
    s_add_u32 s50, s50, s46
    buffer_load_dwordx4 v[128:131], v197, s[16:19], s50 offen offset:0
    buffer_load_dwordx4 v[136:139], v197, s[16:19], s50 offen offset:1024
    s_add_u32 s50, s50, 131072
    buffer_load_dwordx4 v[132:135], v197, s[16:19], s50 offen offset:0
    buffer_load_dwordx4 v[140:143], v197, s[16:19], s50 offen offset:1024
    s_cmp_eq_u32 s42, 0
    s_cselect_b32 s48, 8, 0
    s_lshl_b32 s49, s48, 12
    s_add_u32 s49, s49, s45
    buffer_load_dwordx4 v[64:67], v196, s[16:19], s49 offen offset:0
    buffer_load_dwordx4 v[68:71], v196, s[16:19], s49 offen offset:1024
    buffer_load_dwordx4 v[72:75], v196, s[16:19], s49 offen offset:2048
    buffer_load_dwordx4 v[76:79], v196, s[16:19], s49 offen offset:3072
    s_lshl_b32 s50, s48, 1
    s_lshr_b32 s50, 0x3e940, s50
    s_and_b32 s50, s50, 3
    s_mul_i32 s50, s50, 131072
    s_add_u32 s50, s50, s46
    buffer_load_dwordx4 v[144:147], v197, s[16:19], s50 offen offset:0
    buffer_load_dwordx4 v[152:155], v197, s[16:19], s50 offen offset:1024
    s_add_u32 s50, s50, 131072
    buffer_load_dwordx4 v[148:151], v197, s[16:19], s50 offen offset:0
    buffer_load_dwordx4 v[156:159], v197, s[16:19], s50 offen offset:1024
    s_barrier
    s_mul_i32 s51, s41, 9
    s_lshr_b32 s51, s51, 1
    s_add_u32 s51, s51, 72
    s_mul_i32 s51, s51, 131072
    s_add_u32 s51, s51, s47
    s_add_u32 s51, s51, 18874368
    s_lshl_b32 s52, s43, 1
    s_add_u32 s52, s52, s42
    s_mul_i32 s52, s52, 131072
    s_add_u32 s52, s52, s51
    s_mov_b32 s53, 0x358637bd
    s_waitcnt vmcnt(32)
    v_mfma_f32_16x16x32_bf16 v[160:163], v[0:3], v[80:83], 0
    v_mfma_f32_16x16x32_bf16 v[164:167], v[8:11], v[80:83], 0
    v_mfma_f32_16x16x32_bf16 v[168:171], v[0:3], v[88:91], 0
    v_mfma_f32_16x16x32_bf16 v[172:175], v[8:11], v[88:91], 0
    v_mfma_f32_16x16x32_bf16 v[160:163], v[4:7], v[84:87], v[160:163]
    v_mfma_f32_16x16x32_bf16 v[164:167], v[12:15], v[84:87], v[164:167]
    v_mfma_f32_16x16x32_bf16 v[168:171], v[4:7], v[92:95], v[168:171]
    v_mfma_f32_16x16x32_bf16 v[172:175], v[12:15], v[92:95], v[172:175]
    s_nop 7
    v_add_f32 v164, s53, v164
    v_add_f32 v165, s53, v165
    v_add_f32 v166, s53, v166
    v_add_f32 v167, s53, v167
    v_rcp_f32 v164, v164
    v_rcp_f32 v165, v165
    v_rcp_f32 v166, v166
    v_rcp_f32 v167, v167
    s_nop 0
    v_mul_f32 v160, v160, v164
    v_mul_f32 v161, v161, v165
    v_mul_f32 v162, v162, v166
    v_mul_f32 v163, v163, v167
    v_cvt_pk_bf16_f32 v176, v160, v161
    v_cvt_pk_bf16_f32 v177, v162, v163
    v_add_f32 v172, s53, v172
    v_add_f32 v173, s53, v173
    v_add_f32 v174, s53, v174
    v_add_f32 v175, s53, v175
    v_rcp_f32 v172, v172
    v_rcp_f32 v173, v173
    v_rcp_f32 v174, v174
    v_rcp_f32 v175, v175
    s_nop 0
    v_mul_f32 v168, v168, v172
    v_mul_f32 v169, v169, v173
    v_mul_f32 v170, v170, v174
    v_mul_f32 v171, v171, v175
    v_cvt_pk_bf16_f32 v180, v168, v169
    v_cvt_pk_bf16_f32 v181, v170, v171
    s_waitcnt vmcnt(24)
    v_mfma_f32_16x16x32_bf16 v[160:163], v[16:19], v[96:99], 0
    v_mfma_f32_16x16x32_bf16 v[164:167], v[24:27], v[96:99], 0
    v_mfma_f32_16x16x32_bf16 v[168:171], v[16:19], v[104:107], 0
    v_mfma_f32_16x16x32_bf16 v[172:175], v[24:27], v[104:107], 0
    v_mfma_f32_16x16x32_bf16 v[160:163], v[20:23], v[100:103], v[160:163]
    v_mfma_f32_16x16x32_bf16 v[164:167], v[28:31], v[100:103], v[164:167]
    v_mfma_f32_16x16x32_bf16 v[168:171], v[20:23], v[108:111], v[168:171]
    v_mfma_f32_16x16x32_bf16 v[172:175], v[28:31], v[108:111], v[172:175]
    s_nop 7
    v_add_f32 v164, s53, v164
    v_add_f32 v165, s53, v165
    v_add_f32 v166, s53, v166
    v_add_f32 v167, s53, v167
    v_rcp_f32 v164, v164
    v_rcp_f32 v165, v165
    v_rcp_f32 v166, v166
    v_rcp_f32 v167, v167
    s_nop 0
    v_mul_f32 v160, v160, v164
    v_mul_f32 v161, v161, v165
    v_mul_f32 v162, v162, v166
    v_mul_f32 v163, v163, v167
    v_cvt_pk_bf16_f32 v178, v160, v161
    v_cvt_pk_bf16_f32 v179, v162, v163
    v_add_f32 v172, s53, v172
    v_add_f32 v173, s53, v173
    v_add_f32 v174, s53, v174
    v_add_f32 v175, s53, v175
    v_rcp_f32 v172, v172
    v_rcp_f32 v173, v173
    v_rcp_f32 v174, v174
    v_rcp_f32 v175, v175
    s_nop 0
    v_mul_f32 v168, v168, v172
    v_mul_f32 v169, v169, v173
    v_mul_f32 v170, v170, v174
    v_mul_f32 v171, v171, v175
    v_cvt_pk_bf16_f32 v182, v168, v169
    v_cvt_pk_bf16_f32 v183, v170, v171
    s_nop 1
    v_permlane32_swap_b32 v176, v178
    v_permlane32_swap_b32 v177, v179
    s_nop 0
    v_permlane16_swap_b32 v176, v178
    v_permlane16_swap_b32 v177, v179
    buffer_store_dwordx4 v[176:179], v211, s[16:19], s52 offen offset:0 sc1
    s_nop 1
    v_permlane32_swap_b32 v180, v182
    v_permlane32_swap_b32 v181, v183
    s_nop 0
    v_permlane16_swap_b32 v180, v182
    v_permlane16_swap_b32 v181, v183
    buffer_store_dwordx4 v[180:183], v211, s[16:19], s52 offen offset:1024 sc1
    s_add_u32 s52, s52, 131072
    s_waitcnt vmcnt(18)
    v_mfma_f32_16x16x32_bf16 v[160:163], v[32:35], v[112:115], 0
    v_mfma_f32_16x16x32_bf16 v[164:167], v[40:43], v[112:115], 0
    v_mfma_f32_16x16x32_bf16 v[168:171], v[32:35], v[120:123], 0
    v_mfma_f32_16x16x32_bf16 v[172:175], v[40:43], v[120:123], 0
    v_mfma_f32_16x16x32_bf16 v[160:163], v[36:39], v[116:119], v[160:163]
    v_mfma_f32_16x16x32_bf16 v[164:167], v[44:47], v[116:119], v[164:167]
    v_mfma_f32_16x16x32_bf16 v[168:171], v[36:39], v[124:127], v[168:171]
    v_mfma_f32_16x16x32_bf16 v[172:175], v[44:47], v[124:127], v[172:175]
    s_nop 7
    v_add_f32 v164, s53, v164
    v_add_f32 v165, s53, v165
    v_add_f32 v166, s53, v166
    v_add_f32 v167, s53, v167
    v_rcp_f32 v164, v164
    v_rcp_f32 v165, v165
    v_rcp_f32 v166, v166
    v_rcp_f32 v167, v167
    s_nop 0
    v_mul_f32 v160, v160, v164
    v_mul_f32 v161, v161, v165
    v_mul_f32 v162, v162, v166
    v_mul_f32 v163, v163, v167
    v_cvt_pk_bf16_f32 v184, v160, v161
    v_cvt_pk_bf16_f32 v185, v162, v163
    v_add_f32 v172, s53, v172
    v_add_f32 v173, s53, v173
    v_add_f32 v174, s53, v174
    v_add_f32 v175, s53, v175
    v_rcp_f32 v172, v172
    v_rcp_f32 v173, v173
    v_rcp_f32 v174, v174
    v_rcp_f32 v175, v175
    s_nop 0
    v_mul_f32 v168, v168, v172
    v_mul_f32 v169, v169, v173
    v_mul_f32 v170, v170, v174
    v_mul_f32 v171, v171, v175
    v_cvt_pk_bf16_f32 v188, v168, v169
    v_cvt_pk_bf16_f32 v189, v170, v171
    s_waitcnt vmcnt(10)
    v_mfma_f32_16x16x32_bf16 v[160:163], v[48:51], v[128:131], 0
    v_mfma_f32_16x16x32_bf16 v[164:167], v[56:59], v[128:131], 0
    v_mfma_f32_16x16x32_bf16 v[168:171], v[48:51], v[136:139], 0
    v_mfma_f32_16x16x32_bf16 v[172:175], v[56:59], v[136:139], 0
    v_mfma_f32_16x16x32_bf16 v[160:163], v[52:55], v[132:135], v[160:163]
    v_mfma_f32_16x16x32_bf16 v[164:167], v[60:63], v[132:135], v[164:167]
    v_mfma_f32_16x16x32_bf16 v[168:171], v[52:55], v[140:143], v[168:171]
    v_mfma_f32_16x16x32_bf16 v[172:175], v[60:63], v[140:143], v[172:175]
    s_nop 7
    v_add_f32 v164, s53, v164
    v_add_f32 v165, s53, v165
    v_add_f32 v166, s53, v166
    v_add_f32 v167, s53, v167
    v_rcp_f32 v164, v164
    v_rcp_f32 v165, v165
    v_rcp_f32 v166, v166
    v_rcp_f32 v167, v167
    s_nop 0
    v_mul_f32 v160, v160, v164
    v_mul_f32 v161, v161, v165
    v_mul_f32 v162, v162, v166
    v_mul_f32 v163, v163, v167
    v_cvt_pk_bf16_f32 v186, v160, v161
    v_cvt_pk_bf16_f32 v187, v162, v163
    v_add_f32 v172, s53, v172
    v_add_f32 v173, s53, v173
    v_add_f32 v174, s53, v174
    v_add_f32 v175, s53, v175
    v_rcp_f32 v172, v172
    v_rcp_f32 v173, v173
    v_rcp_f32 v174, v174
    v_rcp_f32 v175, v175
    s_nop 0
    v_mul_f32 v168, v168, v172
    v_mul_f32 v169, v169, v173
    v_mul_f32 v170, v170, v174
    v_mul_f32 v171, v171, v175
    v_cvt_pk_bf16_f32 v190, v168, v169
    v_cvt_pk_bf16_f32 v191, v170, v171
    s_nop 1
    v_permlane32_swap_b32 v184, v186
    v_permlane32_swap_b32 v185, v187
    s_nop 0
    v_permlane16_swap_b32 v184, v186
    v_permlane16_swap_b32 v185, v187
    buffer_store_dwordx4 v[184:187], v211, s[16:19], s52 offen offset:0 sc1
    s_nop 1
    v_permlane32_swap_b32 v188, v190
    v_permlane32_swap_b32 v189, v191
    s_nop 0
    v_permlane16_swap_b32 v188, v190
    v_permlane16_swap_b32 v189, v191
    buffer_store_dwordx4 v[188:191], v211, s[16:19], s52 offen offset:1024 sc1
    s_add_u32 s52, s52, 131072
    s_cmp_lg_u32 s43, 0
    s_cbranch_scc1 k2_kernel_o_end
    s_waitcnt vmcnt(4)
    v_mfma_f32_16x16x32_bf16 v[160:163], v[64:67], v[144:147], 0
    v_mfma_f32_16x16x32_bf16 v[164:167], v[72:75], v[144:147], 0
    v_mfma_f32_16x16x32_bf16 v[168:171], v[64:67], v[152:155], 0
    v_mfma_f32_16x16x32_bf16 v[172:175], v[72:75], v[152:155], 0
    v_mfma_f32_16x16x32_bf16 v[160:163], v[68:71], v[148:151], v[160:163]
    v_mfma_f32_16x16x32_bf16 v[164:167], v[76:79], v[148:151], v[164:167]
    v_mfma_f32_16x16x32_bf16 v[168:171], v[68:71], v[156:159], v[168:171]
    v_mfma_f32_16x16x32_bf16 v[172:175], v[76:79], v[156:159], v[172:175]
    s_nop 7
    v_add_f32 v164, s53, v164
    v_add_f32 v165, s53, v165
    v_add_f32 v166, s53, v166
    v_add_f32 v167, s53, v167
    v_rcp_f32 v164, v164
    v_rcp_f32 v165, v165
    v_rcp_f32 v166, v166
    v_rcp_f32 v167, v167
    s_nop 0
    v_mul_f32 v160, v160, v164
    v_mul_f32 v161, v161, v165
    v_mul_f32 v162, v162, v166
    v_mul_f32 v163, v163, v167
    v_cvt_pk_bf16_f32 v192, v160, v161
    v_cvt_pk_bf16_f32 v193, v162, v163
    v_add_f32 v172, s53, v172
    v_add_f32 v173, s53, v173
    v_add_f32 v174, s53, v174
    v_add_f32 v175, s53, v175
    v_rcp_f32 v172, v172
    v_rcp_f32 v173, v173
    v_rcp_f32 v174, v174
    v_rcp_f32 v175, v175
    s_nop 0
    v_mul_f32 v168, v168, v172
    v_mul_f32 v169, v169, v173
    v_mul_f32 v170, v170, v174
    v_mul_f32 v171, v171, v175
    v_cvt_pk_bf16_f32 v196, v168, v169
    v_cvt_pk_bf16_f32 v197, v170, v171
    s_lshl_b32 s54, s42, 5
    v_xor_b32 v212, s54, v212
    s_cmp_eq_u32 s42, 0
    s_cselect_b32 s54, 524288, 0
    s_add_u32 s54, s54, s51
    buffer_store_dwordx2 v[192:193], v212, s[16:19], s54 offen offset:0 sc1
    buffer_store_dwordx2 v[196:197], v212, s[16:19], s54 offen offset:1024 sc1
k2_kernel_o_end:
    s_lshl_b32 s33, s2, 1
    s_add_u32 s33, s33, s43
    s_add_u32 s33, s33, 1024
    s_branch k2_kernel_flag
k2_kernel_end:
    s_endpgm
k3f_entry:
    s_cmp_ge_u32 s2, 240
    s_cbranch_scc1 k3_kernel_end
    s_and_b32 s24, s2, 7
    s_lshr_b32 s25, s2, 3
    s_mul_i32 s26, s24, 30
    s_add_u32 s26, s26, s25
    s_cmp_ge_u32 s26, 234
    s_cbranch_scc1 k3_kernel_end
    s_load_dwordx2 s[4:5], s[0:1], 0
    s_load_dwordx2 s[6:7], s[0:1], 16
    s_load_dwordx4 s[8:11], s[0:1], 56
    s_load_dwordx2 s[40:41], s[0:1], 80
    v_mbcnt_lo_u32_b32 v86, -1, 0
    v_mbcnt_hi_u32_b32 v86, -1, v86
    s_mul_hi_u32 s27, s26, 477218589
    s_mul_i32 s28, s27, 9
    s_sub_u32 s28, s26, s28
    s_mul_i32 s27, s27, 80
    s_mul_i32 s30, s24, 5
    v_and_b32 v87, 15, v86
    v_lshrrev_b32 v88, 4, v86
    s_waitcnt lgkmcnt(0)
    s_mov_b32 s12, s4
    s_and_b32 s13, s5, 0xffff
    s_mov_b32 s14, 2359296
    s_mov_b32 s15, 0x00020000
    s_mov_b32 s16, s40
    s_and_b32 s17, s41, 0xffff
    s_mov_b32 s18, 41263360
    s_mov_b32 s19, 0x00020000
    s_mov_b32 s20, s10
    s_and_b32 s21, s11, 0xffff
    s_mov_b32 s22, 2359296
    s_mov_b32 s23, 0x00020000
    s_cmp_ge_u32 s29, 4
    s_cbranch_scc1 k3_kernel_loader
    s_and_b32 s31, s29, 1
    s_lshr_b32 s32, s29, 1
    s_mul_i32 s33, s31, 48
    s_add_u32 s33, s33, s27
    v_add_u32 v82, s33, v87
    v_mul_u32_u24 v82, 1152, v82
    s_lshl_b32 s34, s28, 7
    s_lshl_b32 s35, s32, 6
    s_add_u32 s34, s34, s35
    v_lshl_add_u32 v89, v88, 4, v82
    v_add_u32 v89, s34, v89
    v_lshl_add_u32 v83, v88, 3, v82
    v_add_u32 v83, s34, v83
    buffer_load_dwordx2 v[64:65], v83, s[12:15], 0 offen offset:0
    buffer_load_dwordx2 v[66:67], v83, s[12:15], 0 offen offset:32
    v_add_u32 v83, 18432, v83
    buffer_load_dwordx2 v[68:69], v83, s[12:15], 0 offen offset:0
    buffer_load_dwordx2 v[70:71], v83, s[12:15], 0 offen offset:32
    v_add_u32 v83, 18432, v83
    buffer_load_dwordx2 v[72:73], v83, s[12:15], 0 offen offset:0
    buffer_load_dwordx2 v[74:75], v83, s[12:15], 0 offen offset:32
    v_lshrrev_b32 v82, 2, v87
    v_sub_u32 v84, 0, v82
    v_and_b32 v84, 3, v84
    v_xor_b32 v84, v84, v88
    v_lshlrev_b32 v84, 4, v84
    v_lshl_add_u32 v84, v87, 6, v84
    s_mul_i32 s33, s31, 3072
    v_add_u32 v79, s33, v84
    v_lshl_add_u32 v84, v88, 3, v82
    v_lshlrev_b32 v84, 7, v84
    v_bfe_u32 v82, v87, 1, 1
    s_lshl_b32 s33, s32, 2
    v_or_b32 v82, s33, v82
    v_bfe_u32 v85, v87, 3, 1
    v_lshlrev_b32 v85, 1, v85
    v_xor_b32 v82, v82, v85
    v_and_b32 v85, 1, v88
    v_lshlrev_b32 v85, 2, v85
    v_xor_b32 v82, v82, v85
    v_lshl_add_u32 v84, v82, 4, v84
    v_and_b32 v85, 1, v87
    v_lshl_add_u32 v84, v85, 3, v84
    v_add_u32 v80, 10240, v84
    v_xor_b32 v81, 32, v80
    s_waitcnt vmcnt(0)
    v_lshlrev_b32 v0, 16, v64
    v_and_b32 v1, 0xffff0000, v64
    v_lshlrev_b32 v2, 16, v65
    v_and_b32 v3, 0xffff0000, v65
    v_lshlrev_b32 v4, 16, v66
    v_and_b32 v5, 0xffff0000, v66
    v_lshlrev_b32 v6, 16, v67
    v_and_b32 v7, 0xffff0000, v67
    v_lshlrev_b32 v8, 16, v68
    v_and_b32 v9, 0xffff0000, v68
    v_lshlrev_b32 v10, 16, v69
    v_and_b32 v11, 0xffff0000, v69
    v_lshlrev_b32 v12, 16, v70
    v_and_b32 v13, 0xffff0000, v70
    v_lshlrev_b32 v14, 16, v71
    v_and_b32 v15, 0xffff0000, v71
    v_lshlrev_b32 v16, 16, v72
    v_and_b32 v17, 0xffff0000, v72
    v_lshlrev_b32 v18, 16, v73
    v_and_b32 v19, 0xffff0000, v73
    v_lshlrev_b32 v20, 16, v74
    v_and_b32 v21, 0xffff0000, v74
    v_lshlrev_b32 v22, 16, v75
    v_and_b32 v23, 0xffff0000, v75
    s_mov_b32 s36, 0
    s_barrier
    s_barrier
    ds_read_b64_tr_b16 v[36:37], v80 offset:0
    ds_read_b64_tr_b16 v[38:39], v80 offset:512
    ds_read_b64_tr_b16 v[40:41], v81 offset:0
    ds_read_b64_tr_b16 v[42:43], v81 offset:512
    ds_read_b128 v[24:27], v79 offset:0
    ds_read_b128 v[28:31], v79 offset:1024
    ds_read_b128 v[32:35], v79 offset:2048
    s_mov_b32 s37, 9
    v_mov_b32 v76, v79
    v_mov_b32 v77, v80
    v_mov_b32 v78, v81
.p2align 6
k3_kernel_loop:
    s_waitcnt lgkmcnt(2)
    v_mfma_f32_16x16x32_bf16 v[0:3], v[36:39], v[24:27], v[0:3]
    ds_read_b64_tr_b16 v[56:57], v77 offset:4096
    ds_read_b64_tr_b16 v[58:59], v77 offset:4608
    v_mfma_f32_16x16x32_bf16 v[4:7], v[40:43], v[24:27], v[4:7]
    ds_read_b64_tr_b16 v[60:61], v78 offset:4096
    s_waitcnt lgkmcnt(4)
    v_mfma_f32_16x16x32_bf16 v[8:11], v[36:39], v[28:31], v[8:11]
    ds_read_b64_tr_b16 v[62:63], v78 offset:4608
    v_mfma_f32_16x16x32_bf16 v[12:15], v[40:43], v[28:31], v[12:15]
    ds_read_b128 v[44:47], v76 offset:5120
    s_waitcnt lgkmcnt(5)
    v_mfma_f32_16x16x32_bf16 v[16:19], v[36:39], v[32:35], v[16:19]
    ds_read_b128 v[48:51], v76 offset:6144
    v_mfma_f32_16x16x32_bf16 v[20:23], v[40:43], v[32:35], v[20:23]
    ds_read_b128 v[52:55], v76 offset:7168
    s_add_u32 s36, s36, 18432
    s_cmp_ge_u32 s36, 110592
    s_cselect_b32 s36, 0, s36
    v_add_u32 v76, s36, v79
    v_add_u32 v77, s36, v80
    v_add_u32 v78, s36, v81
    s_barrier
    s_waitcnt lgkmcnt(2)
    v_mfma_f32_16x16x32_bf16 v[0:3], v[56:59], v[44:47], v[0:3]
    ds_read_b64_tr_b16 v[36:37], v77 offset:0
    ds_read_b64_tr_b16 v[38:39], v77 offset:512
    v_mfma_f32_16x16x32_bf16 v[4:7], v[60:63], v[44:47], v[4:7]
    ds_read_b64_tr_b16 v[40:41], v78 offset:0
    s_waitcnt lgkmcnt(4)
    v_mfma_f32_16x16x32_bf16 v[8:11], v[56:59], v[48:51], v[8:11]
    ds_read_b64_tr_b16 v[42:43], v78 offset:512
    v_mfma_f32_16x16x32_bf16 v[12:15], v[60:63], v[48:51], v[12:15]
    ds_read_b128 v[24:27], v76 offset:0
    s_waitcnt lgkmcnt(5)
    v_mfma_f32_16x16x32_bf16 v[16:19], v[56:59], v[52:55], v[16:19]
    ds_read_b128 v[28:31], v76 offset:1024
    v_mfma_f32_16x16x32_bf16 v[20:23], v[60:63], v[52:55], v[20:23]
    ds_read_b128 v[32:35], v76 offset:2048
    s_waitcnt lgkmcnt(2)
    v_mfma_f32_16x16x32_bf16 v[0:3], v[36:39], v[24:27], v[0:3]
    ds_read_b64_tr_b16 v[56:57], v77 offset:4096
    ds_read_b64_tr_b16 v[58:59], v77 offset:4608
    v_mfma_f32_16x16x32_bf16 v[4:7], v[40:43], v[24:27], v[4:7]
    ds_read_b64_tr_b16 v[60:61], v78 offset:4096
    s_waitcnt lgkmcnt(4)
    v_mfma_f32_16x16x32_bf16 v[8:11], v[36:39], v[28:31], v[8:11]
    ds_read_b64_tr_b16 v[62:63], v78 offset:4608
    v_mfma_f32_16x16x32_bf16 v[12:15], v[40:43], v[28:31], v[12:15]
    ds_read_b128 v[44:47], v76 offset:5120
    s_waitcnt lgkmcnt(5)
    v_mfma_f32_16x16x32_bf16 v[16:19], v[36:39], v[32:35], v[16:19]
    ds_read_b128 v[48:51], v76 offset:6144
    v_mfma_f32_16x16x32_bf16 v[20:23], v[40:43], v[32:35], v[20:23]
    ds_read_b128 v[52:55], v76 offset:7168
    s_add_u32 s36, s36, 18432
    s_cmp_ge_u32 s36, 110592
    s_cselect_b32 s36, 0, s36
    v_add_u32 v76, s36, v79
    v_add_u32 v77, s36, v80
    v_add_u32 v78, s36, v81
    s_barrier
    s_waitcnt lgkmcnt(2)
    v_mfma_f32_16x16x32_bf16 v[0:3], v[56:59], v[44:47], v[0:3]
    ds_read_b64_tr_b16 v[36:37], v77 offset:0
    ds_read_b64_tr_b16 v[38:39], v77 offset:512
    v_mfma_f32_16x16x32_bf16 v[4:7], v[60:63], v[44:47], v[4:7]
    ds_read_b64_tr_b16 v[40:41], v78 offset:0
    s_waitcnt lgkmcnt(4)
    v_mfma_f32_16x16x32_bf16 v[8:11], v[56:59], v[48:51], v[8:11]
    ds_read_b64_tr_b16 v[42:43], v78 offset:512
    v_mfma_f32_16x16x32_bf16 v[12:15], v[60:63], v[48:51], v[12:15]
    ds_read_b128 v[24:27], v76 offset:0
    s_waitcnt lgkmcnt(5)
    v_mfma_f32_16x16x32_bf16 v[16:19], v[56:59], v[52:55], v[16:19]
    ds_read_b128 v[28:31], v76 offset:1024
    v_mfma_f32_16x16x32_bf16 v[20:23], v[60:63], v[52:55], v[20:23]
    ds_read_b128 v[32:35], v76 offset:2048
    s_waitcnt lgkmcnt(2)
    v_mfma_f32_16x16x32_bf16 v[0:3], v[36:39], v[24:27], v[0:3]
    ds_read_b64_tr_b16 v[56:57], v77 offset:4096
    ds_read_b64_tr_b16 v[58:59], v77 offset:4608
    v_mfma_f32_16x16x32_bf16 v[4:7], v[40:43], v[24:27], v[4:7]
    ds_read_b64_tr_b16 v[60:61], v78 offset:4096
    s_waitcnt lgkmcnt(4)
    v_mfma_f32_16x16x32_bf16 v[8:11], v[36:39], v[28:31], v[8:11]
    ds_read_b64_tr_b16 v[62:63], v78 offset:4608
    v_mfma_f32_16x16x32_bf16 v[12:15], v[40:43], v[28:31], v[12:15]
    ds_read_b128 v[44:47], v76 offset:5120
    s_waitcnt lgkmcnt(5)
    v_mfma_f32_16x16x32_bf16 v[16:19], v[36:39], v[32:35], v[16:19]
    ds_read_b128 v[48:51], v76 offset:6144
    v_mfma_f32_16x16x32_bf16 v[20:23], v[40:43], v[32:35], v[20:23]
    ds_read_b128 v[52:55], v76 offset:7168
    s_add_u32 s36, s36, 18432
    s_cmp_ge_u32 s36, 110592
    s_cselect_b32 s36, 0, s36
    v_add_u32 v76, s36, v79
    v_add_u32 v77, s36, v80
    v_add_u32 v78, s36, v81
    s_barrier
    s_waitcnt lgkmcnt(2)
    v_mfma_f32_16x16x32_bf16 v[0:3], v[56:59], v[44:47], v[0:3]
    ds_read_b64_tr_b16 v[36:37], v77 offset:0
    ds_read_b64_tr_b16 v[38:39], v77 offset:512
    v_mfma_f32_16x16x32_bf16 v[4:7], v[60:63], v[44:47], v[4:7]
    ds_read_b64_tr_b16 v[40:41], v78 offset:0
    s_waitcnt lgkmcnt(4)
    v_mfma_f32_16x16x32_bf16 v[8:11], v[56:59], v[48:51], v[8:11]
    ds_read_b64_tr_b16 v[42:43], v78 offset:512
    v_mfma_f32_16x16x32_bf16 v[12:15], v[60:63], v[48:51], v[12:15]
    ds_read_b128 v[24:27], v76 offset:0
    s_waitcnt lgkmcnt(5)
    v_mfma_f32_16x16x32_bf16 v[16:19], v[56:59], v[52:55], v[16:19]
    ds_read_b128 v[28:31], v76 offset:1024
    v_mfma_f32_16x16x32_bf16 v[20:23], v[60:63], v[52:55], v[20:23]
    ds_read_b128 v[32:35], v76 offset:2048
    s_waitcnt lgkmcnt(2)
    v_mfma_f32_16x16x32_bf16 v[0:3], v[36:39], v[24:27], v[0:3]
    ds_read_b64_tr_b16 v[56:57], v77 offset:4096
    ds_read_b64_tr_b16 v[58:59], v77 offset:4608
    v_mfma_f32_16x16x32_bf16 v[4:7], v[40:43], v[24:27], v[4:7]
    ds_read_b64_tr_b16 v[60:61], v78 offset:4096
    s_waitcnt lgkmcnt(4)
    v_mfma_f32_16x16x32_bf16 v[8:11], v[36:39], v[28:31], v[8:11]
    ds_read_b64_tr_b16 v[62:63], v78 offset:4608
    v_mfma_f32_16x16x32_bf16 v[12:15], v[40:43], v[28:31], v[12:15]
    ds_read_b128 v[44:47], v76 offset:5120
    s_waitcnt lgkmcnt(5)
    v_mfma_f32_16x16x32_bf16 v[16:19], v[36:39], v[32:35], v[16:19]
    ds_read_b128 v[48:51], v76 offset:6144
    v_mfma_f32_16x16x32_bf16 v[20:23], v[40:43], v[32:35], v[20:23]
    ds_read_b128 v[52:55], v76 offset:7168
    s_add_u32 s36, s36, 18432
    s_cmp_ge_u32 s36, 110592
    s_cselect_b32 s36, 0, s36
    v_add_u32 v76, s36, v79
    v_add_u32 v77, s36, v80
    v_add_u32 v78, s36, v81
    s_barrier
    s_waitcnt lgkmcnt(2)
    v_mfma_f32_16x16x32_bf16 v[0:3], v[56:59], v[44:47], v[0:3]
    ds_read_b64_tr_b16 v[36:37], v77 offset:0
    ds_read_b64_tr_b16 v[38:39], v77 offset:512
    v_mfma_f32_16x16x32_bf16 v[4:7], v[60:63], v[44:47], v[4:7]
    ds_read_b64_tr_b16 v[40:41], v78 offset:0
    s_waitcnt lgkmcnt(4)
    v_mfma_f32_16x16x32_bf16 v[8:11], v[56:59], v[48:51], v[8:11]
    ds_read_b64_tr_b16 v[42:43], v78 offset:512
    v_mfma_f32_16x16x32_bf16 v[12:15], v[60:63], v[48:51], v[12:15]
    ds_read_b128 v[24:27], v76 offset:0
    s_waitcnt lgkmcnt(5)
    v_mfma_f32_16x16x32_bf16 v[16:19], v[56:59], v[52:55], v[16:19]
    ds_read_b128 v[28:31], v76 offset:1024
    v_mfma_f32_16x16x32_bf16 v[20:23], v[60:63], v[52:55], v[20:23]
    ds_read_b128 v[32:35], v76 offset:2048
    s_waitcnt lgkmcnt(2)
    v_mfma_f32_16x16x32_bf16 v[0:3], v[36:39], v[24:27], v[0:3]
    ds_read_b64_tr_b16 v[56:57], v77 offset:4096
    ds_read_b64_tr_b16 v[58:59], v77 offset:4608
    v_mfma_f32_16x16x32_bf16 v[4:7], v[40:43], v[24:27], v[4:7]
    ds_read_b64_tr_b16 v[60:61], v78 offset:4096
    s_waitcnt lgkmcnt(4)
    v_mfma_f32_16x16x32_bf16 v[8:11], v[36:39], v[28:31], v[8:11]
    ds_read_b64_tr_b16 v[62:63], v78 offset:4608
    v_mfma_f32_16x16x32_bf16 v[12:15], v[40:43], v[28:31], v[12:15]
    ds_read_b128 v[44:47], v76 offset:5120
    s_waitcnt lgkmcnt(5)
    v_mfma_f32_16x16x32_bf16 v[16:19], v[36:39], v[32:35], v[16:19]
    ds_read_b128 v[48:51], v76 offset:6144
    v_mfma_f32_16x16x32_bf16 v[20:23], v[40:43], v[32:35], v[20:23]
    ds_read_b128 v[52:55], v76 offset:7168
    s_add_u32 s36, s36, 18432
    s_cmp_ge_u32 s36, 110592
    s_cselect_b32 s36, 0, s36
    v_add_u32 v76, s36, v79
    v_add_u32 v77, s36, v80
    v_add_u32 v78, s36, v81
    s_barrier
    s_waitcnt lgkmcnt(2)
    v_mfma_f32_16x16x32_bf16 v[0:3], v[56:59], v[44:47], v[0:3]
    ds_read_b64_tr_b16 v[36:37], v77 offset:0
    ds_read_b64_tr_b16 v[38:39], v77 offset:512
    v_mfma_f32_16x16x32_bf16 v[4:7], v[60:63], v[44:47], v[4:7]
    ds_read_b64_tr_b16 v[40:41], v78 offset:0
    s_waitcnt lgkmcnt(4)
    v_mfma_f32_16x16x32_bf16 v[8:11], v[56:59], v[48:51], v[8:11]
    ds_read_b64_tr_b16 v[42:43], v78 offset:512
    v_mfma_f32_16x16x32_bf16 v[12:15], v[60:63], v[48:51], v[12:15]
    ds_read_b128 v[24:27], v76 offset:0
    s_waitcnt lgkmcnt(5)
    v_mfma_f32_16x16x32_bf16 v[16:19], v[56:59], v[52:55], v[16:19]
    ds_read_b128 v[28:31], v76 offset:1024
    v_mfma_f32_16x16x32_bf16 v[20:23], v[60:63], v[52:55], v[20:23]
    ds_read_b128 v[32:35], v76 offset:2048
    s_sub_u32 s37, s37, 1
    s_cmp_lg_u32 s37, 0
    s_cbranch_scc1 k3_kernel_loop
    s_waitcnt lgkmcnt(0)
    s_nop 7
    v_cvt_pk_bf16_f32 v64, v0, v1
    v_cvt_pk_bf16_f32 v65, v2, v3
    v_cvt_pk_bf16_f32 v66, v4, v5
    v_cvt_pk_bf16_f32 v67, v6, v7
    s_nop 1
    v_permlane32_swap_b32 v64, v66
    v_permlane32_swap_b32 v65, v67
    s_nop 1
    v_permlane16_swap_b32 v64, v66
    v_permlane16_swap_b32 v65, v67
    s_nop 1
    buffer_store_dwordx4 v[64:67], v89, s[20:23], 0 offen sc1
    v_add_u32 v89, 18432, v89
    v_cvt_pk_bf16_f32 v68, v8, v9
    v_cvt_pk_bf16_f32 v69, v10, v11
    v_cvt_pk_bf16_f32 v70, v12, v13
    v_cvt_pk_bf16_f32 v71, v14, v15
    s_nop 1
    v_permlane32_swap_b32 v68, v70
    v_permlane32_swap_b32 v69, v71
    s_nop 1
    v_permlane16_swap_b32 v68, v70
    v_permlane16_swap_b32 v69, v71
    s_nop 1
    buffer_store_dwordx4 v[68:71], v89, s[20:23], 0 offen sc1
    v_add_u32 v89, 18432, v89
    s_cmp_eq_u32 s31, 1
    s_cbranch_scc1 k3_kernel_fin
    v_cvt_pk_bf16_f32 v72, v16, v17
    v_cvt_pk_bf16_f32 v73, v18, v19
    v_cvt_pk_bf16_f32 v74, v20, v21
    v_cvt_pk_bf16_f32 v75, v22, v23
    s_nop 1
    v_permlane32_swap_b32 v72, v74
    v_permlane32_swap_b32 v73, v75
    s_nop 1
    v_permlane16_swap_b32 v72, v74
    v_permlane16_swap_b32 v73, v75
    s_nop 1
    buffer_store_dwordx4 v[72:75], v89, s[20:23], 0 offen sc1
k3_kernel_fin:
    s_endpgm
k3_kernel_loader:
    s_sub_u32 s31, s29, 4
    v_lshrrev_b32 v82, 3, v86
    v_mul_u32_u24 v82, 1152, v82
    v_bfe_u32 v83, v86, 4, 1
    v_lshlrev_b32 v83, 1, v83
    v_and_b32 v84, 7, v86
    v_xor_b32 v83, v83, v84
    v_lshlrev_b32 v83, 4, v83
    v_xor_b32 v84, 64, v83
    s_lshl_b32 s32, s28, 7
    s_mul_i32 s33, s31, 36864
    s_add_u32 s32, s32, s33
    v_add_u32 v82, s32, v82
    v_add_u32 v1, v82, v83
    v_add_u32 v2, v82, v84
    v_add_u32 v2, 8192, v2
    v_add_u32 v3, v82, v83
    v_add_u32 v3, 16384, v3
    v_add_u32 v4, v82, v84
    v_add_u32 v4, 24576, v4
    v_lshlrev_b32 v5, 4, v86
    s_lshl_b32 s32, s27, 6
    s_mul_i32 s33, s31, 131072
    s_add_u32 s32, s32, s33
    s_add_u32 s32, s32, 18874368
    s_mul_i32 s38, s31, 5120
    s_lshl_b32 s39, s31, 12
    s_add_u32 s39, s39, 10240
    s_and_b32 s9, s9, 0xffff
    s_and_b32 s7, s7, 0xffff
    s_mov_b32 s47, 0x00020000
    s_mov_b32 s42, 2654208
    s_mov_b32 s43, 663552
    s_mov_b32 s36, 0
    s_lshr_b32 s48, s27, 5
    s_add_u32 s49, s27, 79
    s_lshr_b32 s49, s49, 5
    s_min_u32 s49, s49, 63
    s_cmp_eq_u32 s31, 0
    s_cselect_b32 s50, 4, 3
    v_lshrrev_b32 v82, s50, v86
    v_add_u32 v82, s48, v82
    v_min_u32 v82, s49, v82
    v_lshrrev_b32 v83, 2, v82
    v_lshl_add_u32 v83, v83, 4, v87
    v_and_b32 v84, 3, v82
    v_lshl_add_u32 v83, v83, 2, v84
    v_and_b32 v84, 7, v86
    v_lshl_add_u32 v84, v82, 3, v84
    v_add_u32 v84, 1024, v84
    s_cselect_b64 vcc, -1, 0
    v_cndmask_b32 v83, v84, v83, vcc
    v_lshlrev_b32 v83, 7, v83
    s_mov_b32 s51, 41066752
    s_mov_b32 s52, 0
k3_kernel_poll:
    buffer_load_dword v84, v83, s[16:19], s51 offen sc1
    s_add_u32 s52, s52, 1
    s_waitcnt vmcnt(0)
    v_cmp_ne_u32 vcc, s62, v84
    s_cmp_gt_u32 s52, 0x20000
    s_cbranch_scc1 k3_kernel_go
    s_nop 2
    s_cmp_eq_u64 vcc, 0
    s_cbranch_scc1 k3_kernel_go
    s_sleep 4
    s_branch k3_kernel_poll
k3_kernel_go:
    s_barrier
    s_mul_i32 s33, s30, 262144
    s_add_u32 s33, s33, s32
    s_add_u32 m0, s36, s38
    s_cmp_lt_u32 s30, 36
    s_cselect_b32 s44, s8, s6
    s_cselect_b32 s45, s9, s7
    s_cselect_b32 s46, s42, s43
    s_cselect_b32 s34, 0, 36
    buffer_load_dwordx4 v5, s[16:19], s33 offen offset:0 sc1 lds
    buffer_load_dwordx4 v5, s[16:19], s33 offen offset:1024 sc1 lds
    buffer_load_dwordx4 v5, s[16:19], s33 offen offset:2048 sc1 lds
    buffer_load_dwordx4 v5, s[16:19], s33 offen offset:3072 sc1 lds
    s_add_u32 m0, m0, 4096
    s_add_u32 s33, s33, 4096
    s_sub_u32 s34, s30, s34
    buffer_load_dwordx4 v5, s[16:19], s33 offen sc1 lds
    s_add_u32 m0, s36, s39
    s_mul_i32 s34, s34, 73728
    buffer_load_dwordx4 v1, s[44:47], s34 offen offset:0 lds
    buffer_load_dwordx4 v2, s[44:47], s34 offen offset:1024 lds
    buffer_load_dwordx4 v3, s[44:47], s34 offen offset:2048 lds
    buffer_load_dwordx4 v4, s[44:47], s34 offen offset:3072 lds
    s_add_u32 s30, s30, 1
    s_cmp_ge_u32 s30, 45
    s_cselect_b32 s30, 0, s30
    s_add_u32 s36, s36, 18432
    s_cmp_ge_u32 s36, 110592
    s_cselect_b32 s36, 0, s36
    s_mul_i32 s33, s30, 262144
    s_add_u32 s33, s33, s32
    s_add_u32 m0, s36, s38
    s_cmp_lt_u32 s30, 36
    s_cselect_b32 s44, s8, s6
    s_cselect_b32 s45, s9, s7
    s_cselect_b32 s46, s42, s43
    s_cselect_b32 s34, 0, 36
    buffer_load_dwordx4 v5, s[16:19], s33 offen offset:0 sc1 lds
    buffer_load_dwordx4 v5, s[16:19], s33 offen offset:1024 sc1 lds
    buffer_load_dwordx4 v5, s[16:19], s33 offen offset:2048 sc1 lds
    buffer_load_dwordx4 v5, s[16:19], s33 offen offset:3072 sc1 lds
    s_add_u32 m0, m0, 4096
    s_add_u32 s33, s33, 4096
    s_sub_u32 s34, s30, s34
    buffer_load_dwordx4 v5, s[16:19], s33 offen sc1 lds
    s_add_u32 m0, s36, s39
    s_mul_i32 s34, s34, 73728
    buffer_load_dwordx4 v1, s[44:47], s34 offen offset:0 lds
    buffer_load_dwordx4 v2, s[44:47], s34 offen offset:1024 lds
    buffer_load_dwordx4 v3, s[44:47], s34 offen offset:2048 lds
    buffer_load_dwordx4 v4, s[44:47], s34 offen offset:3072 lds
    s_add_u32 s30, s30, 1
    s_cmp_ge_u32 s30, 45
    s_cselect_b32 s30, 0, s30
    s_add_u32 s36, s36, 18432
    s_cmp_ge_u32 s36, 110592
    s_cselect_b32 s36, 0, s36
    s_waitcnt vmcnt(9)
    s_barrier
    s_mul_i32 s33, s30, 262144
    s_add_u32 s33, s33, s32
    s_add_u32 m0, s36, s38
    s_cmp_lt_u32 s30, 36
    s_cselect_b32 s44, s8, s6
    s_cselect_b32 s45, s9, s7
    s_cselect_b32 s46, s42, s43
    s_cselect_b32 s34, 0, 36
    buffer_load_dwordx4 v5, s[16:19], s33 offen offset:0 sc1 lds
    buffer_load_dwordx4 v5, s[16:19], s33 offen offset:1024 sc1 lds
    buffer_load_dwordx4 v5, s[16:19], s33 offen offset:2048 sc1 lds
    buffer_load_dwordx4 v5, s[16:19], s33 offen offset:3072 sc1 lds
    s_add_u32 m0, m0, 4096
    s_add_u32 s33, s33, 4096
    s_sub_u32 s34, s30, s34
    buffer_load_dwordx4 v5, s[16:19], s33 offen sc1 lds
    s_add_u32 m0, s36, s39
    s_mul_i32 s34, s34, 73728
    buffer_load_dwordx4 v1, s[44:47], s34 offen offset:0 lds
    buffer_load_dwordx4 v2, s[44:47], s34 offen offset:1024 lds
    buffer_load_dwordx4 v3, s[44:47], s34 offen offset:2048 lds
    buffer_load_dwordx4 v4, s[44:47], s34 offen offset:3072 lds
    s_add_u32 s30, s30, 1
    s_cmp_ge_u32 s30, 45
    s_cselect_b32 s30, 0, s30
    s_add_u32 s36, s36, 18432
    s_cmp_ge_u32 s36, 110592
    s_cselect_b32 s36, 0, s36
    s_mul_i32 s33, s30, 262144
    s_add_u32 s33, s33, s32
    s_add_u32 m0, s36, s38
    s_cmp_lt_u32 s30, 36
    s_cselect_b32 s44, s8, s6
    s_cselect_b32 s45, s9, s7
    s_cselect_b32 s46, s42, s43
    s_cselect_b32 s34, 0, 36
    buffer_load_dwordx4 v5, s[16:19], s33 offen offset:0 sc1 lds
    buffer_load_dwordx4 v5, s[16:19], s33 offen offset:1024 sc1 lds
    buffer_load_dwordx4 v5, s[16:19], s33 offen offset:2048 sc1 lds
    buffer_load_dwordx4 v5, s[16:19], s33 offen offset:3072 sc1 lds
    s_add_u32 m0, m0, 4096
    s_add_u32 s33, s33, 4096
    s_sub_u32 s34, s30, s34
    buffer_load_dwordx4 v5, s[16:19], s33 offen sc1 lds
    s_add_u32 m0, s36, s39
    s_mul_i32 s34, s34, 73728
    buffer_load_dwordx4 v1, s[44:47], s34 offen offset:0 lds
    buffer_load_dwordx4 v2, s[44:47], s34 offen offset:1024 lds
    buffer_load_dwordx4 v3, s[44:47], s34 offen offset:2048 lds
    buffer_load_dwordx4 v4, s[44:47], s34 offen offset:3072 lds
    s_add_u32 s30, s30, 1
    s_cmp_ge_u32 s30, 45
    s_cselect_b32 s30, 0, s30
    s_add_u32 s36, s36, 18432
    s_cmp_ge_u32 s36, 110592
    s_cselect_b32 s36, 0, s36
    s_mul_i32 s33, s30, 262144
    s_add_u32 s33, s33, s32
    s_add_u32 m0, s36, s38
    s_cmp_lt_u32 s30, 36
    s_cselect_b32 s44, s8, s6
    s_cselect_b32 s45, s9, s7
    s_cselect_b32 s46, s42, s43
    s_cselect_b32 s34, 0, 36
    buffer_load_dwordx4 v5, s[16:19], s33 offen offset:0 sc1 lds
    buffer_load_dwordx4 v5, s[16:19], s33 offen offset:1024 sc1 lds
    buffer_load_dwordx4 v5, s[16:19], s33 offen offset:2048 sc1 lds
    buffer_load_dwordx4 v5, s[16:19], s33 offen offset:3072 sc1 lds
    s_add_u32 m0, m0, 4096
    s_add_u32 s33, s33, 4096
    s_sub_u32 s34, s30, s34
    buffer_load_dwordx4 v5, s[16:19], s33 offen sc1 lds
    s_add_u32 m0, s36, s39
    s_mul_i32 s34, s34, 73728
    buffer_load_dwordx4 v1, s[44:47], s34 offen offset:0 lds
    buffer_load_dwordx4 v2, s[44:47], s34 offen offset:1024 lds
    buffer_load_dwordx4 v3, s[44:47], s34 offen offset:2048 lds
    buffer_load_dwordx4 v4, s[44:47], s34 offen offset:3072 lds
    s_add_u32 s30, s30, 1
    s_cmp_ge_u32 s30, 45
    s_cselect_b32 s30, 0, s30
    s_add_u32 s36, s36, 18432
    s_cmp_ge_u32 s36, 110592
    s_cselect_b32 s36, 0, s36
    s_mov_b32 s37, 40
k3_kernel_lloop:
    s_waitcnt vmcnt(27)
    s_barrier
    s_mul_i32 s33, s30, 262144
    s_add_u32 s33, s33, s32
    s_add_u32 m0, s36, s38
    s_cmp_lt_u32 s30, 36
    s_cselect_b32 s44, s8, s6
    s_cselect_b32 s45, s9, s7
    s_cselect_b32 s46, s42, s43
    s_cselect_b32 s34, 0, 36
    buffer_load_dwordx4 v5, s[16:19], s33 offen offset:0 sc1 lds
    buffer_load_dwordx4 v5, s[16:19], s33 offen offset:1024 sc1 lds
    buffer_load_dwordx4 v5, s[16:19], s33 offen offset:2048 sc1 lds
    buffer_load_dwordx4 v5, s[16:19], s33 offen offset:3072 sc1 lds
    s_add_u32 m0, m0, 4096
    s_add_u32 s33, s33, 4096
    s_sub_u32 s34, s30, s34
    buffer_load_dwordx4 v5, s[16:19], s33 offen sc1 lds
    s_add_u32 m0, s36, s39
    s_mul_i32 s34, s34, 73728
    buffer_load_dwordx4 v1, s[44:47], s34 offen offset:0 lds
    buffer_load_dwordx4 v2, s[44:47], s34 offen offset:1024 lds
    buffer_load_dwordx4 v3, s[44:47], s34 offen offset:2048 lds
    buffer_load_dwordx4 v4, s[44:47], s34 offen offset:3072 lds
    s_add_u32 s30, s30, 1
    s_cmp_ge_u32 s30, 45
    s_cselect_b32 s30, 0, s30
    s_add_u32 s36, s36, 18432
    s_cmp_ge_u32 s36, 110592
    s_cselect_b32 s36, 0, s36
    s_sub_u32 s37, s37, 1
    s_cmp_lg_u32 s37, 0
    s_cbranch_scc1 k3_kernel_lloop
    s_waitcnt vmcnt(27)
    s_barrier
    s_waitcnt vmcnt(18)
    s_barrier
    s_waitcnt vmcnt(9)
    s_barrier
    s_waitcnt vmcnt(0)
    s_barrier
    s_waitcnt vmcnt(0)
    s_barrier
    s_endpgm
k3_kernel_end:
    s_endpgm
code_end:
.section .rodata,"a"
.p2align 6
.amdhsa_kernel k1_kernel
  .amdhsa_next_free_vgpr 256
  .amdhsa_next_free_sgpr 102
  .amdhsa_accum_offset 256
  .amdhsa_group_segment_fixed_size 0
  .amdhsa_kernarg_size 88
  .amdhsa_user_sgpr_count 2
  .amdhsa_user_sgpr_kernarg_segment_ptr 1
  .amdhsa_system_sgpr_workgroup_id_x 1
.end_amdhsa_kernel

.p2align 6
.amdhsa_kernel k2_kernel
  .amdhsa_next_free_vgpr 216
  .amdhsa_next_free_sgpr 80
  .amdhsa_accum_offset 216
  .amdhsa_group_segment_fixed_size 0
  .amdhsa_kernarg_size 88
  .amdhsa_user_sgpr_count 2
  .amdhsa_user_sgpr_kernarg_segment_ptr 1
  .amdhsa_system_sgpr_workgroup_id_x 1
.end_amdhsa_kernel
```
